```python
import torch

def _softmax(x, axis=-1):
    return torch.softmax(x, dim=axis)
def _gelu(x):
    return torch.nn.functional.gelu(x, approximate="tanh")
def _silu(x):
    return torch.nn.functional.silu(x)
def _sigmoid(x):
    return torch.sigmoid(x)
def _layernorm(x, axis=-1, eps=1e-5):
    m = x.mean(dim=axis, keepdim=True)
    v = x.var(dim=axis, keepdim=True, unbiased=False)
    return (x - m) / torch.sqrt(v + eps)
def _scatter_add(tgt, idx, src, axis=0):
    return tgt.clone().index_add_(axis, idx, src)
def _segment_sum(src, seg, n):
    out = torch.zeros((n,) + src.shape[1:], dtype=src.dtype)
    return out.index_add_(0, seg, src)
def _pad(x, pw):
    flat = tuple(v for pair in reversed(pw) for v in pair)
    return torch.nn.functional.pad(x, flat)

kernel_name = 'recurrent_scan__sliding_block_cached__glu_gated_swiglu__prompt'

def setup_inputs():

    _w = (lambda a: (lambda t: t.to(torch.bfloat16) if t.is_floating_point() else t)(torch.as_tensor(a)))
    def _A_setup():
        B, Sq, D = 1, 2048, 640
        Hq, Hkv, Sk, Dh = 32, 32, 2048, 128
        assert Hq % Hkv == 0, (Hq, Hkv)
        return {
            "x": _w((lambda *s: torch.randn(*s, dtype=torch.bfloat16) * 0.05)(B, Sq, D)),
            "k_cache": _w((lambda *s: torch.randn(*s, dtype=torch.bfloat16) * 1.6)(B, Hkv, Sk, Dh)),
            "v_cache": _w((lambda *s: torch.randn(*s, dtype=torch.bfloat16) * 1.6)(B, Hkv, Sk, Dh)),
            "wq": _w((lambda *s: torch.randn(*s, dtype=torch.bfloat16) * 1.6)(D, Hq * Dh) * (D ** -0.5)),
            "wo": _w((lambda *s: torch.randn(*s, dtype=torch.bfloat16) * 1.6)(Hq * Dh, D) * ((Hq * Dh) ** -0.5)),
        }
    _A_in = _A_setup()

    def _B_setup():
        B, S, D, F = 1, 2048, 640, 1728
        return {
            "x": _w((lambda *s: torch.randn(*s, dtype=torch.bfloat16) * 0.05)(B, S, D)),
            "w1": _w((lambda *s: torch.randn(*s, dtype=torch.bfloat16) * 0.2)(D, F) * (2.0 / D) ** 0.5),
            "w3": _w((lambda *s: torch.randn(*s, dtype=torch.bfloat16) * 0.2)(D, F) * (2.0 / D) ** 0.5),
            "w2": _w((lambda *s: torch.randn(*s, dtype=torch.bfloat16) * 0.2)(F, D) * (2.0 / F) ** 0.5),
        }
    _B_in = _B_setup()

    return {
        "A_x": _A_in["x"],
        "A_k_cache": _A_in["k_cache"],
        "A_v_cache": _A_in["v_cache"],
        "A_wq": _A_in["wq"],
        "A_wo": _A_in["wo"],
        "B_x": _B_in["x"],
        "B_w1": _B_in["w1"],
        "B_w3": _B_in["w3"],
        "B_w2": _B_in["w2"],
    }

def reference(A_x, A_k_cache, A_v_cache, A_wq, A_wo, B_x, B_w1, B_w3, B_w2):
    def _A_ref(x, k_cache, v_cache, wq, wo):
        B, Sq, D = x.shape
        Hq, Dh = 32, 128
        Hkv, Sk = k_cache.shape[1], k_cache.shape[2]
        W = min(4096, max(256, Sk // 4))
        rep = Hq // Hkv
        q = (lambda x, *d: x.permute(*d))((x @ wq).reshape(B, Sq, Hq, Dh), 0, 2, 1, 3)
        k = (lambda x, n, axis: torch.repeat_interleave(x, n, dim=axis))(k_cache[:, :, Sk - W:, :], rep, axis=1)
        v = (lambda x, n, axis: torch.repeat_interleave(x, n, dim=axis))(v_cache[:, :, Sk - W:, :], rep, axis=1)
        scores = torch.einsum("bhqd,bhkd->bhqk", q, k) * (Dh ** -0.5)
        p = _softmax(scores, axis=-1)
        o = torch.einsum("bhqk,bhkd->bhqd", p, v)
        return (lambda x, *d: x.permute(*d))(o, 0, 2, 1, 3).reshape(B, Sq, Hq * Dh) @ wo

    def _B_ref(x, w1, w3, w2):
        gate = torch.einsum("bsd,df->bsf", x, w1)
        up = torch.einsum("bsd,df->bsf", x, w3)
        h = _silu(gate) * up
        out = torch.einsum("bsf,fd->bsd", h, w2)
        return out

    x = A_x
    xn = _layernorm(x, axis=-1)
    s = _A_ref(xn, A_k_cache, A_v_cache, A_wq, A_wo)
    g = _silu(_B_ref(xn, B_w1, B_w3, B_w2))
    return x + s * g
```

```asm
; @launch grid=(256,1,1) block=(256,1,1) lds=163840
.amdgcn_target "amdgcn-amd-amdhsa--gfx950"
.text
.globl recurrent_scan__sliding_block_cached__glu_gated_swiglu__prompt_kernel
.p2align 8
.type recurrent_scan__sliding_block_cached__glu_gated_swiglu__prompt_kernel,@function
recurrent_scan__sliding_block_cached__glu_gated_swiglu__prompt_kernel:
s_cmp_ge_u32 s2, 256
s_cbranch_scc1 L1_end
s_load_dwordx2 s[28:29], s[0:1], 0
s_load_dwordx16 s[64:79], s[0:1], 0
s_load_dwordx8 s[80:87], s[0:1], 64
s_getpc_b64 s[20:21]
Lcode0:
s_or_b32 s21, s21, 8388608
s_bitcmp1_b32 s2, 3
s_cselect_b32 s22, 128, 0
s_mov_b32 s23, 0x20000
buffer_load_dword v38, v0, s[20:23], 0 idxen
s_lshr_b32 s3, s2, 5
s_mul_i32 s3, s3, ((Lcode1-Lcode0-16384)/1024)*128
s_add_u32 s3, s3, 16384
s_min_u32 s22, s22, ((Lcode1-Lcode0-16384)/1024)
buffer_load_dword v39, v0, s[20:23], s3 idxen
v_and_b32 v40, 15, v0
v_mul_u32_u24 v41, 1280, v40
v_bfe_u32 v42, v0, 4, 2
v_lshl_add_u32 v41, v42, 4, v41
v_lshrrev_b32 v42, 6, v0
v_mul_u32_u24 v42, 320, v42
v_add_u32 v41, v41, v42
s_and_b32 s41, s2, 7
s_lshl_b32 s41, s41, 1
s_bfe_u32 s55, s2, 0x10004
s_add_u32 s41, s41, s55
s_lshr_b32 s55, s2, 5
s_lshl_b32 s55, s55, 4
s_add_u32 s41, s41, s55
s_mul_i32 s41, s41, 20480
s_bitcmp1_b32 s2, 3
s_cselect_b32 s30, 0, 2621440
s_mov_b32 s31, 0x20000
s_waitcnt lgkmcnt(0)
buffer_load_dwordx4 v[44:47], v41, s[28:31], s41 offen offset:0
buffer_load_dwordx4 v[48:51], v41, s[28:31], s41 offen offset:64
buffer_load_dwordx4 v[52:55], v41, s[28:31], s41 offen offset:128
buffer_load_dwordx4 v[56:59], v41, s[28:31], s41 offen offset:192
buffer_load_dwordx4 v[60:63], v41, s[28:31], s41 offen offset:256
s_mov_b32 s4, s86
s_mov_b32 s5, s87
s_mov_b32 s6, 67108864
s_mov_b32 s7, 0x20000
v_mov_b32 v34, 0
s_mov_b32 s55, 60923904
buffer_load_dwordx2 v[36:37], v34, s[4:7], s55 offen sc1
v_lshrrev_b32 v29, 6, v0
s_and_b32 s56, s2, 7
v_readfirstlane_b32 s36, v29
s_lshr_b32 s57, s2, 3
s_lshr_b32 s61, s57, 2
s_and_b32 s57, s57, 3
s_lshl_b32 s60, s56, 2
s_add_u32 s60, s60, s57
v_and_b32 v27, 63, v0
v_lshlrev_b32 v5, 4, v27
v_lshrrev_b32 v29, 3, v27
v_and_b32 v30, 6, v29
v_and_b32 v31, 7, v27
v_xor_b32 v30, v30, v31
v_lshlrev_b32 v30, 4, v30
v_mul_u32_u24 v8, 1280, v29
v_add_u32 v8, v8, v30
s_lshl_b32 s58, s36, 5
v_add_u32 v29, s58, v29
v_lshl_add_u32 v6, v29, 13, v30
v_mul_u32_u24 v7, 3456, v29
v_add_u32 v7, v7, v30
s_lshl_b32 s37, s36, 12
s_lshl_b32 s59, s61, 2
s_add_u32 s59, s59, s36
s_mul_i32 s42, s59, 81920
s_add_u32 s42, s42, 0
s_lshl_b32 s58, s60, 8
s_add_u32 s8, s70, s58
s_addc_u32 s9, s71, 0
s_sub_u32 s10, 5242880, s58
s_mov_b32 s11, 0x20000
s_mul_i32 s51, s56, 3
s_add_u32 s51, s51, s57
s_sub_u32 s58, s61, s56
s_and_b32 s58, s58, 7
s_add_u32 s58, s58, 24
s_cmp_eq_u32 s57, 3
s_cselect_b32 s51, s58, s51
s_min_u32 s58, s51, 26
s_lshl_b32 s58, s58, 7
s_add_u32 s12, s76, s58
s_addc_u32 s13, s77, 0
s_sub_u32 s14, 2211840, s58
s_mov_b32 s15, 0x20000
s_add_u32 s16, s78, s58
s_addc_u32 s17, s79, 0
s_sub_u32 s18, 2211840, s58
s_mov_b32 s19, 0x20000
s_mul_i32 s44, s59, 532992
s_add_u32 s44, s44, 3145728
s_mul_i32 s43, s36, 221184
s_mul_i32 s58, s61, 884736
s_add_u32 s43, s43, s58
s_lshl_b32 s58, s51, 12
s_add_u32 s43, s43, s58
s_add_u32 s43, s43, 22020096
s_cmp_ge_u32 s51, 27
s_cselect_b32 s14, 0, s14
s_cselect_b32 s18, 0, s18
s_cselect_b32 s43, 67108864, s43
s_mul_i32 s58, s60, 8192
s_add_u32 s44, s44, s58
s_lshl_b32 s58, s60, 19
s_add_u32 s58, s58, 393216
s_add_u32 s20, s66, s58
s_addc_u32 s21, s67, 0
s_mov_b32 s22, 131072
s_mov_b32 s23, 0x20000
s_add_u32 s24, s68, s58
s_addc_u32 s25, s69, 0
s_mov_b32 s26, 131072
s_mov_b32 s27, 0x20000
s_lshl_b32 s55, s2, 2
s_add_u32 s55, s55, s36
s_mov_b32 s28, s72
s_mov_b32 s29, s73
s_mov_b32 s30, 5242880
s_mov_b32 s31, 0x20000
s_mul_i32 s38, s55, 52429
s_lshr_b32 s38, s38, 19
s_mul_i32 s58, s38, 10
s_sub_u32 s58, s55, s58
s_mul_i32 s47, s38, 40960
s_cmp_ge_u32 s38, 128
s_cselect_b32 s39, 12, 11
s_lshl_b32 s39, s58, s39
s_add_u32 s47, s47, s39
s_add_u32 s47, s47, 30408704
s_mul_i32 s45, s38, 40960
s_lshl_b32 s58, s58, 7
s_add_u32 s45, s45, s58
s_add_u32 s55, s55, 1024
s_mul_i32 s38, s55, 52429
s_lshr_b32 s38, s38, 19
s_mul_i32 s58, s38, 10
s_sub_u32 s58, s55, s58
s_mul_i32 s48, s38, 40960
s_cmp_ge_u32 s38, 128
s_cselect_b32 s39, 12, 11
s_lshl_b32 s39, s58, s39
s_add_u32 s48, s48, s39
s_add_u32 s48, s48, 30408704
s_cmp_ge_u32 s38, 128
s_mov_b32 s3, 20480
s_cselect_b32 s3, 2048, s3
s_cselect_b64 vcc, -1, 0
s_cselect_b32 s32, s80, s72
s_cselect_b32 s33, s81, s73
s_mov_b32 s34, 5242880
s_cselect_b32 s34, 2211840, s34
s_mov_b32 s35, 0x20000
s_cselect_b32 s39, 128, 0
s_sub_u32 s38, s38, s39
s_add_u32 s3, s3, s48
s_mul_i32 s46, s38, 40960
s_lshl_b32 s58, s58, 7
s_add_u32 s46, s46, s58
s_lshl_b32 s52, s36, 13
s_add_u32 s52, s52, 131072
s_mov_b32 s49, 0xbfb8aa3b
s_mov_b32 s50, 0x3e0293ee
s_lshr_b32 s39, s56, 1
s_and_b32 s38, s56, 1
s_lshl_b32 s58, s61, 1
s_add_u32 s58, s58, s38
s_lshl_b32 s59, s58, 1
s_lshr_b32 s55, s39, 1
s_add_u32 s59, s59, s55
s_mul_i32 s55, s59, 81920
s_add_u32 s72, s64, s55
s_addc_u32 s73, s65, 0
s_sub_u32 s74, 2621440, s55
s_mov_b32 s75, 0x20000
s_add_u32 s76, s82, s55
s_addc_u32 s77, s83, 0
s_sub_u32 s78, 2621440, s55
s_mov_b32 s79, 0x20000
s_mov_b32 s65, s39
s_mul_i32 s40, s57, 10
s_and_b32 s41, s39, 1
s_mul_i32 s41, s41, 5
s_add_u32 s63, s40, s41
s_lshl_b32 s64, s63, 5
s_mul_i32 s55, s36, 14
s_cmp_eq_u32 s36, 3
s_cselect_b32 s55, 41, s55
s_mul_i32 s81, s55, 40960
s_lshl_b32 s63, s63, 10
s_add_u32 s81, s81, s63
s_add_u32 s81, s81, 35651584
s_and_b32 s80, s59, 3
s_mul_i32 s80, s80, 221184
s_mul_i32 s70, s61, 884736
s_add_u32 s80, s80, s70
s_lshl_b32 s55, s55, 11
s_add_u32 s80, s80, s55
s_add_u32 s80, s80, 22020096
s_lshr_b32 s55, s36, 1
s_mul_i32 s71, s55, 40960
s_sub_u32 s71, s81, s71
s_lshl_b32 s70, s55, 11
s_sub_u32 s70, s80, s70
s_lshl_b32 s55, s58, 2
s_add_u32 s55, s55, s36
s_mul_i32 s66, s55, 266496
s_mul_i32 s55, s39, 65536
s_add_u32 s66, s66, s55
s_add_u32 s66, s66, 3145728
s_lshl_b32 s55, s39, 6
s_add_u32 s55, s55, s36
s_mul_i32 s67, s55, 20480
s_mul_i32 s63, s57, 5120
s_add_u32 s67, s67, s63
s_add_u32 s67, s67, 30408704
s_mul_i32 s54, s36, 5120
s_lshl_b32 s55, s58, 2
s_add_u32 s55, s55, s57
s_and_b32 s55, s55, 7
s_mul_i32 s83, s55, 163840
s_mul_i32 s55, s61, 1310720
s_add_u32 s83, s83, s55
s_add_u32 s83, s83, 39845888
s_mul_i32 s55, s39, 40960
s_add_u32 s82, s83, s55
s_mul_i32 s55, s36, 10240
s_add_u32 s82, s82, s55
s_lshr_b32 s55, s39, 1
s_lshl_b32 s55, s55, 2
s_add_u32 s55, s55, s36
s_mul_i32 s55, s55, 5120
s_add_u32 s83, s83, s55
s_lshl_b32 s41, s41, 9
s_add_u32 s83, s83, s41
s_add_u32 s100, s82, 2560
s_and_b32 s55, s36, 2
s_cmp_eq_u32 s55, s39
s_cselect_b32 s82, 67108864, s82
s_or_b32 s55, s55, 1
s_cmp_eq_u32 s55, s39
s_cselect_b32 s100, 67108864, s100
s_lshl_b32 s55, s61, 12
s_add_u32 s55, s55, 60817408
s_lshl_b32 s63, s60, 7
s_add_u32 s84, s55, s63
s_cmp_eq_u32 s36, 0
s_cselect_b32 s84, s84, 67108864
s_cselect_b32 s62, 0, 67108864
s_lshl_b32 s63, s39, 10
s_add_u32 s85, s55, s63
s_add_u32 s59, s55, 65536
s_lshl_b32 s86, s61, 9
s_add_u32 s86, s86, 60948480
s_lshl_b32 s38, s38, 2
s_add_u32 s38, s38, s57
s_lshl_b32 s38, s38, 7
s_add_u32 s87, s55, s38
s_add_u32 s87, s87, 32768
v_lshrrev_b32 v29, 2, v27
v_bfe_u32 v30, v27, 3, 2
v_lshlrev_b32 v30, 5, v30
v_lshl_add_u32 v30, v29, 7, v30
v_and_b32 v31, 3, v27
v_lshl_add_u32 v30, v31, 3, v30
v_xor_b32 v1, 0, v30
v_xor_b32 v2, 32, v30
v_xor_b32 v3, 64, v30
v_xor_b32 v4, 96, v30
v_lshrrev_b32 v29, 5, v27
v_bfe_u32 v30, v27, 2, 2
v_lshl_add_u32 v29, v29, 2, v30
v_lshrrev_b32 v30, 1, v29
v_bfe_u32 v170, v27, 4, 1
v_xor_b32 v30, v30, v170
v_lshlrev_b32 v30, 5, v30
v_lshl_add_u32 v30, v29, 7, v30
v_lshl_add_u32 v30, v31, 3, v30
v_add_u32 v160, s52, v30
v_xor_b32 v161, 64, v160
v_add_u32 v29, 0, v160
v_add_u32 v30, s52, v1
v_cndmask_b32 v162, v29, v30, vcc
v_add_u32 v29, 1024, v160
v_add_u32 v30, s52, v1
v_add_u32 v30, 2048, v30
v_cndmask_b32 v163, v29, v30, vcc
v_add_u32 v29, 0, v161
v_add_u32 v30, s52, v2
v_cndmask_b32 v164, v29, v30, vcc
v_add_u32 v29, 1024, v161
v_add_u32 v30, s52, v2
v_add_u32 v30, 2048, v30
v_cndmask_b32 v165, v29, v30, vcc
v_add_u32 v29, 2048, v160
v_add_u32 v30, s52, v3
v_cndmask_b32 v166, v29, v30, vcc
v_add_u32 v29, 3072, v160
v_add_u32 v30, s52, v3
v_add_u32 v30, 2048, v30
v_cndmask_b32 v167, v29, v30, vcc
v_add_u32 v29, 2048, v161
v_add_u32 v30, s52, v4
v_cndmask_b32 v168, v29, v30, vcc
v_add_u32 v29, 3072, v161
v_add_u32 v30, s52, v4
v_add_u32 v30, 2048, v30
v_cndmask_b32 v169, v29, v30, vcc
v_or_b32 v1, 0x10000, v1
v_or_b32 v2, 0x10000, v2
v_or_b32 v3, 0x10000, v3
v_or_b32 v4, 0x10000, v4
v_lshrrev_b32 v29, 4, v27
v_and_b32 v30, 15, v27
s_lshl_b32 s58, s36, 4
v_add_u32 v31, s58, v29
v_lshlrev_b32 v31, 8, v31
v_xor_b32 v9, v29, v30
v_lshl_add_u32 v9, v9, 4, v31
v_xor_b32 v10, 64, v9
v_xor_b32 v11, 128, v9
v_xor_b32 v12, 192, v9
v_lshlrev_b32 v29, 2, v29
v_xor_b32 v13, v29, v30
v_lshl_add_u32 v13, v13, 4, v31
v_bfe_u32 v29, v27, 2, 2
v_lshrrev_b32 v30, 5, v27
v_lshl_add_u32 v30, v30, 2, v29
v_lshlrev_b32 v30, 8, v30
v_lshl_add_u32 v30, v29, 6, v30
v_bfe_u32 v29, v27, 4, 1
v_lshl_add_u32 v30, v29, 5, v30
v_and_b32 v29, 3, v27
v_lshl_add_u32 v30, v29, 3, v30
v_xor_b32 v22, 0, v30
v_xor_b32 v23, 64, v30
v_xor_b32 v24, 128, v30
v_xor_b32 v25, 192, v30
v_and_b32 v29, 31, v27
v_lshrrev_b32 v30, 5, v27
v_and_b32 v31, 15, v27
v_xor_b32 v30, v30, v31
v_lshlrev_b32 v30, 4, v30
v_lshl_add_u32 v29, v29, 8, v30
v_xor_b32 v14, 0, v29
v_xor_b32 v15, 32, v29
v_xor_b32 v16, 64, v29
v_xor_b32 v17, 96, v29
v_xor_b32 v18, 128, v29
v_xor_b32 v19, 160, v29
v_xor_b32 v20, 192, v29
v_xor_b32 v21, 224, v29
v_mov_b32 v26, 0
v_mov_b32 v28, 0
s_add_u32 m0, s37, 98304
s_mov_b32 s39, 0
buffer_load_dwordx4 v6, s[8:11], s39 offen offset:0  lds
s_mov_b32 s38, 64512
buffer_load_dwordx4 v6, s[8:11], s38 offen offset:1024  lds
s_mov_b32 s39, 129024
buffer_load_dwordx4 v6, s[8:11], s39 offen offset:2048  lds
s_mov_b32 s38, 193536
buffer_load_dwordx4 v6, s[8:11], s38 offen offset:3072  lds
s_add_u32 m0, s37, 114688
s_mov_b32 s39, 128
buffer_load_dwordx4 v6, s[8:11], s39 offen offset:0  lds
s_mov_b32 s38, 64640
buffer_load_dwordx4 v6, s[8:11], s38 offen offset:1024  lds
s_mov_b32 s39, 129152
buffer_load_dwordx4 v6, s[8:11], s39 offen offset:2048  lds
s_mov_b32 s38, 193664
buffer_load_dwordx4 v6, s[8:11], s38 offen offset:3072  lds
s_bitcmp1_b32 s60, 0
s_cbranch_scc1 Ltouch
v_mul_u32_u24 v40, 48, v40
v_add_u32 v40, 131072, v40
v_lshrrev_b32 v43, 6, v0
v_lshl_add_u32 v43, v43, 3, v40
s_mov_b32 s53, 0xffff0000
v_and_b32 v41, 15, v0
v_bfe_u32 v42, v0, 4, 1
v_lshl_add_u32 v41, v42, 5, v41
v_bfe_u32 v42, v0, 5, 1
v_lshl_add_u32 v41, v42, 4, v41
v_lshlrev_b32 v41, 4, v41
s_lshr_b32 s55, s60, 1
s_lshl_b32 s41, s61, 4
s_add_u32 s55, s55, s41
s_lshr_b32 s41, s55, 2
s_mul_i32 s41, s41, 81920
s_add_u32 s41, s41, 0
s_and_b32 s55, s55, 3
s_lshl_b32 s55, s55, 12
s_add_u32 s41, s41, s55
s_mul_i32 s55, s36, 5
s_add_u32 s40, s55, 0
s_lshr_b32 s63, s40, 2
s_lshl_b32 s63, s63, 14
s_and_b32 s40, s40, 3
s_lshl_b32 s40, s40, 10
s_add_u32 s40, s40, s63
s_add_u32 s88, s40, s41
s_add_u32 s40, s55, 1
s_lshr_b32 s63, s40, 2
s_lshl_b32 s63, s63, 14
s_and_b32 s40, s40, 3
s_lshl_b32 s40, s40, 10
s_add_u32 s40, s40, s63
s_add_u32 s89, s40, s41
s_add_u32 s40, s55, 2
s_lshr_b32 s63, s40, 2
s_lshl_b32 s63, s63, 14
s_and_b32 s40, s40, 3
s_lshl_b32 s40, s40, 10
s_add_u32 s40, s40, s63
s_add_u32 s90, s40, s41
s_add_u32 s40, s55, 3
s_lshr_b32 s63, s40, 2
s_lshl_b32 s63, s63, 14
s_and_b32 s40, s40, 3
s_lshl_b32 s40, s40, 10
s_add_u32 s40, s40, s63
s_add_u32 s91, s40, s41
s_add_u32 s40, s55, 4
s_lshr_b32 s63, s40, 2
s_lshl_b32 s63, s63, 14
s_and_b32 s40, s40, 3
s_lshl_b32 s40, s40, 10
s_add_u32 s40, s40, s63
s_add_u32 s92, s40, s41
s_waitcnt vmcnt(13)
v_lshlrev_b32 v64, 16, v44
v_and_b32 v65, s53, v44
v_lshlrev_b32 v66, 16, v45
v_and_b32 v67, s53, v45
v_lshlrev_b32 v68, 16, v46
v_and_b32 v69, s53, v46
v_lshlrev_b32 v70, 16, v47
v_and_b32 v71, s53, v47
s_waitcnt vmcnt(12)
v_lshlrev_b32 v72, 16, v48
v_and_b32 v73, s53, v48
v_lshlrev_b32 v74, 16, v49
v_and_b32 v75, s53, v49
v_lshlrev_b32 v76, 16, v50
v_and_b32 v77, s53, v50
v_lshlrev_b32 v78, 16, v51
v_and_b32 v79, s53, v51
s_waitcnt vmcnt(11)
v_lshlrev_b32 v80, 16, v52
v_and_b32 v81, s53, v52
v_lshlrev_b32 v82, 16, v53
v_and_b32 v83, s53, v53
v_lshlrev_b32 v84, 16, v54
v_and_b32 v85, s53, v54
v_lshlrev_b32 v86, 16, v55
v_and_b32 v87, s53, v55
s_waitcnt vmcnt(10)
v_lshlrev_b32 v88, 16, v56
v_and_b32 v89, s53, v56
v_lshlrev_b32 v90, 16, v57
v_and_b32 v91, s53, v57
v_lshlrev_b32 v92, 16, v58
v_and_b32 v93, s53, v58
v_lshlrev_b32 v94, 16, v59
v_and_b32 v95, s53, v59
s_waitcnt vmcnt(9)
v_lshlrev_b32 v96, 16, v60
v_and_b32 v97, s53, v60
v_lshlrev_b32 v98, 16, v61
v_and_b32 v99, s53, v61
v_lshlrev_b32 v100, 16, v62
v_and_b32 v101, s53, v62
v_lshlrev_b32 v102, 16, v63
v_and_b32 v103, s53, v63
v_pk_add_f32 v[104:105], v[64:65], v[66:67]
v_pk_add_f32 v[106:107], v[68:69], v[70:71]
v_pk_add_f32 v[104:105], v[104:105], v[72:73]
v_pk_add_f32 v[106:107], v[106:107], v[74:75]
v_pk_add_f32 v[104:105], v[104:105], v[76:77]
v_pk_add_f32 v[106:107], v[106:107], v[78:79]
v_pk_add_f32 v[104:105], v[104:105], v[80:81]
v_pk_add_f32 v[106:107], v[106:107], v[82:83]
v_pk_add_f32 v[104:105], v[104:105], v[84:85]
v_pk_add_f32 v[106:107], v[106:107], v[86:87]
v_pk_add_f32 v[104:105], v[104:105], v[88:89]
v_pk_add_f32 v[106:107], v[106:107], v[90:91]
v_pk_add_f32 v[104:105], v[104:105], v[92:93]
v_pk_add_f32 v[106:107], v[106:107], v[94:95]
v_pk_add_f32 v[104:105], v[104:105], v[96:97]
v_pk_add_f32 v[106:107], v[106:107], v[98:99]
v_pk_add_f32 v[104:105], v[104:105], v[100:101]
v_pk_add_f32 v[106:107], v[106:107], v[102:103]
v_pk_add_f32 v[104:105], v[104:105], v[106:107]
v_add_f32 v104, v104, v105
v_mov_b32 v105, v104
s_nop 1
v_permlane32_swap_b32 v104, v105
v_add_f32 v104, v104, v105
v_mov_b32 v105, v104
s_nop 1
v_permlane16_swap_b32 v104, v105
v_add_f32 v104, v104, v105
v_mul_f32 v108, 0xbbcccccd, v104
v_pk_add_f32 v[64:65], v[64:65], v[108:109] op_sel_hi:[1,0]
v_pk_add_f32 v[66:67], v[66:67], v[108:109] op_sel_hi:[1,0]
v_pk_add_f32 v[68:69], v[68:69], v[108:109] op_sel_hi:[1,0]
v_pk_add_f32 v[70:71], v[70:71], v[108:109] op_sel_hi:[1,0]
v_pk_add_f32 v[72:73], v[72:73], v[108:109] op_sel_hi:[1,0]
v_pk_add_f32 v[74:75], v[74:75], v[108:109] op_sel_hi:[1,0]
v_pk_add_f32 v[76:77], v[76:77], v[108:109] op_sel_hi:[1,0]
v_pk_add_f32 v[78:79], v[78:79], v[108:109] op_sel_hi:[1,0]
v_pk_add_f32 v[80:81], v[80:81], v[108:109] op_sel_hi:[1,0]
v_pk_add_f32 v[82:83], v[82:83], v[108:109] op_sel_hi:[1,0]
v_pk_add_f32 v[84:85], v[84:85], v[108:109] op_sel_hi:[1,0]
v_pk_add_f32 v[86:87], v[86:87], v[108:109] op_sel_hi:[1,0]
v_pk_add_f32 v[88:89], v[88:89], v[108:109] op_sel_hi:[1,0]
v_pk_add_f32 v[90:91], v[90:91], v[108:109] op_sel_hi:[1,0]
v_pk_add_f32 v[92:93], v[92:93], v[108:109] op_sel_hi:[1,0]
v_pk_add_f32 v[94:95], v[94:95], v[108:109] op_sel_hi:[1,0]
v_pk_add_f32 v[96:97], v[96:97], v[108:109] op_sel_hi:[1,0]
v_pk_add_f32 v[98:99], v[98:99], v[108:109] op_sel_hi:[1,0]
v_pk_add_f32 v[100:101], v[100:101], v[108:109] op_sel_hi:[1,0]
v_pk_add_f32 v[102:103], v[102:103], v[108:109] op_sel_hi:[1,0]
v_pk_mul_f32 v[104:105], v[64:65], v[64:65]
v_pk_mul_f32 v[106:107], v[66:67], v[66:67]
v_pk_fma_f32 v[104:105], v[68:69], v[68:69], v[104:105]
v_pk_fma_f32 v[106:107], v[70:71], v[70:71], v[106:107]
v_pk_fma_f32 v[104:105], v[72:73], v[72:73], v[104:105]
v_pk_fma_f32 v[106:107], v[74:75], v[74:75], v[106:107]
v_pk_fma_f32 v[104:105], v[76:77], v[76:77], v[104:105]
v_pk_fma_f32 v[106:107], v[78:79], v[78:79], v[106:107]
v_pk_fma_f32 v[104:105], v[80:81], v[80:81], v[104:105]
v_pk_fma_f32 v[106:107], v[82:83], v[82:83], v[106:107]
v_pk_fma_f32 v[104:105], v[84:85], v[84:85], v[104:105]
v_pk_fma_f32 v[106:107], v[86:87], v[86:87], v[106:107]
v_pk_fma_f32 v[104:105], v[88:89], v[88:89], v[104:105]
v_pk_fma_f32 v[106:107], v[90:91], v[90:91], v[106:107]
v_pk_fma_f32 v[104:105], v[92:93], v[92:93], v[104:105]
v_pk_fma_f32 v[106:107], v[94:95], v[94:95], v[106:107]
v_pk_fma_f32 v[104:105], v[96:97], v[96:97], v[104:105]
v_pk_fma_f32 v[106:107], v[98:99], v[98:99], v[106:107]
v_pk_fma_f32 v[104:105], v[100:101], v[100:101], v[104:105]
v_pk_fma_f32 v[106:107], v[102:103], v[102:103], v[106:107]
v_pk_add_f32 v[104:105], v[104:105], v[106:107]
v_add_f32 v104, v104, v105
v_mov_b32 v105, v104
s_nop 1
v_permlane32_swap_b32 v104, v105
v_add_f32 v104, v104, v105
v_mov_b32 v105, v104
s_nop 1
v_permlane16_swap_b32 v104, v105
v_add_f32 v104, v104, v105
v_mov_b32 v109, v104
ds_write_b64 v43, v[108:109]
s_waitcnt lgkmcnt(0)
s_barrier
ds_read_b128 v[112:115], v40 offset:0
ds_read_b128 v[116:119], v40 offset:16
s_waitcnt lgkmcnt(1)
v_pk_add_f32 v[104:105], v[112:113], v[114:115]
s_waitcnt lgkmcnt(0)
v_pk_add_f32 v[106:107], v[116:117], v[118:119]
v_pk_add_f32 v[104:105], v[104:105], v[106:107]
v_mul_f32 v104, 0x3e800000, v104
v_sub_f32 v112, v112, v104
v_sub_f32 v114, v114, v104
v_sub_f32 v116, v116, v104
v_sub_f32 v118, v118, v104
v_mul_f32 v106, v112, v112
v_fmac_f32 v106, v114, v114
v_fmac_f32 v106, v116, v116
v_fmac_f32 v106, v118, v118
v_fmac_f32 v105, 0x43200000, v106
v_mov_b32 v106, 0x3727c5ac
v_fmac_f32 v106, 0x3acccccd, v105
v_rsq_f32 v106, v106
v_sub_f32 v110, v104, v108
v_mul_f32 v110, v110, v106
v_pk_fma_f32 v[64:65], v[64:65], v[106:107], v[110:111] op_sel_hi:[1,0,0]
v_pk_fma_f32 v[66:67], v[66:67], v[106:107], v[110:111] op_sel_hi:[1,0,0]
v_pk_fma_f32 v[68:69], v[68:69], v[106:107], v[110:111] op_sel_hi:[1,0,0]
v_pk_fma_f32 v[70:71], v[70:71], v[106:107], v[110:111] op_sel_hi:[1,0,0]
v_cvt_pk_bf16_f32 v44, v64, v65
v_cvt_pk_bf16_f32 v45, v66, v67
v_cvt_pk_bf16_f32 v46, v68, v69
v_cvt_pk_bf16_f32 v47, v70, v71
s_nop 0
v_permlane32_swap_b32 v44, v46
v_permlane32_swap_b32 v45, v47
buffer_store_dwordx4 v[44:47], v41, s[4:7], s88 offen sc1
v_pk_fma_f32 v[72:73], v[72:73], v[106:107], v[110:111] op_sel_hi:[1,0,0]
v_pk_fma_f32 v[74:75], v[74:75], v[106:107], v[110:111] op_sel_hi:[1,0,0]
v_pk_fma_f32 v[76:77], v[76:77], v[106:107], v[110:111] op_sel_hi:[1,0,0]
v_pk_fma_f32 v[78:79], v[78:79], v[106:107], v[110:111] op_sel_hi:[1,0,0]
v_cvt_pk_bf16_f32 v48, v72, v73
v_cvt_pk_bf16_f32 v49, v74, v75
v_cvt_pk_bf16_f32 v50, v76, v77
v_cvt_pk_bf16_f32 v51, v78, v79
s_nop 0
v_permlane32_swap_b32 v48, v50
v_permlane32_swap_b32 v49, v51
buffer_store_dwordx4 v[48:51], v41, s[4:7], s89 offen sc1
v_pk_fma_f32 v[80:81], v[80:81], v[106:107], v[110:111] op_sel_hi:[1,0,0]
v_pk_fma_f32 v[82:83], v[82:83], v[106:107], v[110:111] op_sel_hi:[1,0,0]
v_pk_fma_f32 v[84:85], v[84:85], v[106:107], v[110:111] op_sel_hi:[1,0,0]
v_pk_fma_f32 v[86:87], v[86:87], v[106:107], v[110:111] op_sel_hi:[1,0,0]
v_cvt_pk_bf16_f32 v52, v80, v81
v_cvt_pk_bf16_f32 v53, v82, v83
v_cvt_pk_bf16_f32 v54, v84, v85
v_cvt_pk_bf16_f32 v55, v86, v87
s_nop 0
v_permlane32_swap_b32 v52, v54
v_permlane32_swap_b32 v53, v55
buffer_store_dwordx4 v[52:55], v41, s[4:7], s90 offen sc1
v_pk_fma_f32 v[88:89], v[88:89], v[106:107], v[110:111] op_sel_hi:[1,0,0]
v_pk_fma_f32 v[90:91], v[90:91], v[106:107], v[110:111] op_sel_hi:[1,0,0]
v_pk_fma_f32 v[92:93], v[92:93], v[106:107], v[110:111] op_sel_hi:[1,0,0]
v_pk_fma_f32 v[94:95], v[94:95], v[106:107], v[110:111] op_sel_hi:[1,0,0]
v_cvt_pk_bf16_f32 v56, v88, v89
v_cvt_pk_bf16_f32 v57, v90, v91
v_cvt_pk_bf16_f32 v58, v92, v93
v_cvt_pk_bf16_f32 v59, v94, v95
s_nop 0
v_permlane32_swap_b32 v56, v58
v_permlane32_swap_b32 v57, v59
buffer_store_dwordx4 v[56:59], v41, s[4:7], s91 offen sc1
v_pk_fma_f32 v[96:97], v[96:97], v[106:107], v[110:111] op_sel_hi:[1,0,0]
v_pk_fma_f32 v[98:99], v[98:99], v[106:107], v[110:111] op_sel_hi:[1,0,0]
v_pk_fma_f32 v[100:101], v[100:101], v[106:107], v[110:111] op_sel_hi:[1,0,0]
v_pk_fma_f32 v[102:103], v[102:103], v[106:107], v[110:111] op_sel_hi:[1,0,0]
v_cvt_pk_bf16_f32 v60, v96, v97
v_cvt_pk_bf16_f32 v61, v98, v99
v_cvt_pk_bf16_f32 v62, v100, v101
v_cvt_pk_bf16_f32 v63, v102, v103
s_nop 0
v_permlane32_swap_b32 v60, v62
v_permlane32_swap_b32 v61, v63
buffer_store_dwordx4 v[60:63], v41, s[4:7], s92 offen sc1
Lln_skip:
s_waitcnt vmcnt(10)
v_readfirstlane_b32 s68, v36
v_readfirstlane_b32 s69, v37
s_mov_b32 s53, 0x67800000
s_nop 1
s_add_u32 s68, s68, 1
s_addc_u32 s69, s69, 0
v_mov_b32 v36, s68
v_mov_b32 v37, s69
s_waitcnt vmcnt(0)
s_barrier
s_bitcmp1_b32 s60, 0
s_cselect_b32 s41, 67108864, s84
s_add_u32 s41, s41, 65536
buffer_store_dwordx2 v[36:37], v34, s[4:7], s41 offen sc1
ds_read_b64_tr_b16 a[128:129], v1 offset:32768
ds_read_b64_tr_b16 a[130:131], v1 offset:34816
ds_read_b64_tr_b16 a[132:133], v1 offset:36864
ds_read_b64_tr_b16 a[134:135], v1 offset:38912
ds_read_b64_tr_b16 a[136:137], v1 offset:40960
ds_read_b64_tr_b16 a[138:139], v1 offset:43008
ds_read_b64_tr_b16 a[140:141], v1 offset:45056
ds_read_b64_tr_b16 a[142:143], v1 offset:47104
ds_read_b64_tr_b16 a[144:145], v2 offset:32768
ds_read_b64_tr_b16 a[146:147], v2 offset:34816
ds_read_b64_tr_b16 a[148:149], v2 offset:36864
ds_read_b64_tr_b16 a[150:151], v2 offset:38912
ds_read_b64_tr_b16 a[152:153], v2 offset:40960
ds_read_b64_tr_b16 a[154:155], v2 offset:43008
ds_read_b64_tr_b16 a[156:157], v2 offset:45056
s_waitcnt lgkmcnt(14)
ds_read_b64_tr_b16 a[158:159], v2 offset:47104
s_waitcnt lgkmcnt(14)
ds_read_b64_tr_b16 a[160:161], v3 offset:32768
s_waitcnt lgkmcnt(14)
ds_read_b64_tr_b16 a[162:163], v3 offset:34816
s_waitcnt lgkmcnt(14)
ds_read_b64_tr_b16 a[164:165], v3 offset:36864
s_waitcnt lgkmcnt(14)
ds_read_b64_tr_b16 a[166:167], v3 offset:38912
s_waitcnt lgkmcnt(14)
ds_read_b64_tr_b16 a[168:169], v3 offset:40960
s_waitcnt lgkmcnt(14)
ds_read_b64_tr_b16 a[170:171], v3 offset:43008
s_waitcnt lgkmcnt(14)
ds_read_b64_tr_b16 a[172:173], v3 offset:45056
s_waitcnt lgkmcnt(14)
ds_read_b64_tr_b16 a[174:175], v3 offset:47104
s_waitcnt lgkmcnt(14)
ds_read_b64_tr_b16 a[176:177], v4 offset:32768
s_waitcnt lgkmcnt(14)
ds_read_b64_tr_b16 a[178:179], v4 offset:34816
s_waitcnt lgkmcnt(14)
ds_read_b64_tr_b16 a[180:181], v4 offset:36864
s_waitcnt lgkmcnt(14)
ds_read_b64_tr_b16 a[182:183], v4 offset:38912
s_waitcnt lgkmcnt(14)
ds_read_b64_tr_b16 a[184:185], v4 offset:40960
s_waitcnt lgkmcnt(14)
ds_read_b64_tr_b16 a[186:187], v4 offset:43008
s_waitcnt lgkmcnt(14)
ds_read_b64_tr_b16 a[188:189], v4 offset:45056
s_waitcnt lgkmcnt(14)
ds_read_b64_tr_b16 a[190:191], v4 offset:47104
s_add_u32 m0, s37, 0
s_mov_b32 s39, 1048576
buffer_load_dwordx4 v6, s[8:11], s39 offen offset:0  lds
s_mov_b32 s38, 1113088
buffer_load_dwordx4 v6, s[8:11], s38 offen offset:1024  lds
s_mov_b32 s39, 1177600
buffer_load_dwordx4 v6, s[8:11], s39 offen offset:2048  lds
s_mov_b32 s38, 1242112
buffer_load_dwordx4 v6, s[8:11], s38 offen offset:3072  lds
s_add_u32 m0, s37, 16384
s_mov_b32 s39, 1048704
buffer_load_dwordx4 v6, s[8:11], s39 offen offset:0  lds
s_mov_b32 s38, 1113216
buffer_load_dwordx4 v6, s[8:11], s38 offen offset:1024  lds
s_mov_b32 s39, 1177728
buffer_load_dwordx4 v6, s[8:11], s39 offen offset:2048  lds
s_mov_b32 s38, 1242240
buffer_load_dwordx4 v6, s[8:11], s38 offen offset:3072  lds
v_and_b32 v35, 15, v0
v_lshlrev_b32 v35, 8, v35
s_cmp_lg_u32 s36, 0
s_cbranch_scc1 Lh1_skip
buffer_load_dwordx2 v[38:39], v35, s[4:7], s59 offen sc1
s_waitcnt vmcnt(0)
v_cmp_ne_u64 vcc, s[68:69], v[38:39]
s_nop 3
s_cbranch_vccnz Lp_ln
Lr_ln:
Lh1_skip:
s_barrier
s_add_u32 s40, s42, 0
buffer_load_dwordx4 a[0:3], v5, s[4:7], s40 offen offset:0 sc1
buffer_load_dwordx4 a[4:7], v5, s[4:7], s40 offen offset:1024 sc1
buffer_load_dwordx4 a[8:11], v5, s[4:7], s40 offen offset:2048 sc1
buffer_load_dwordx4 a[12:15], v5, s[4:7], s40 offen offset:3072 sc1
s_add_u32 s40, s42, 4096
buffer_load_dwordx4 a[16:19], v5, s[4:7], s40 offen offset:0 sc1
buffer_load_dwordx4 a[20:23], v5, s[4:7], s40 offen offset:1024 sc1
buffer_load_dwordx4 a[24:27], v5, s[4:7], s40 offen offset:2048 sc1
buffer_load_dwordx4 a[28:31], v5, s[4:7], s40 offen offset:3072 sc1
s_add_u32 s40, s42, 8192
buffer_load_dwordx4 a[32:35], v5, s[4:7], s40 offen offset:0 sc1
buffer_load_dwordx4 a[36:39], v5, s[4:7], s40 offen offset:1024 sc1
buffer_load_dwordx4 a[40:43], v5, s[4:7], s40 offen offset:2048 sc1
buffer_load_dwordx4 a[44:47], v5, s[4:7], s40 offen offset:3072 sc1
s_add_u32 s40, s42, 12288
buffer_load_dwordx4 a[48:51], v5, s[4:7], s40 offen offset:0 sc1
buffer_load_dwordx4 a[52:55], v5, s[4:7], s40 offen offset:1024 sc1
buffer_load_dwordx4 a[56:59], v5, s[4:7], s40 offen offset:2048 sc1
buffer_load_dwordx4 a[60:63], v5, s[4:7], s40 offen offset:3072 sc1
s_waitcnt vmcnt(15)
v_mfma_f32_16x16x32_bf16 v[32:35], a[128:131], a[0:3], 0
s_add_u32 s40, s42, 16384
s_waitcnt vmcnt(14)
v_mfma_f32_16x16x32_bf16 v[32:35], a[132:135], a[4:7], v[32:35]
s_waitcnt vmcnt(13)
v_mfma_f32_16x16x32_bf16 v[32:35], a[136:139], a[8:11], v[32:35]
s_waitcnt vmcnt(12)
v_mfma_f32_16x16x32_bf16 v[32:35], a[140:143], a[12:15], v[32:35]
v_mfma_f32_16x16x32_bf16 v[48:51], a[144:147], a[0:3], 0
v_mfma_f32_16x16x32_bf16 v[48:51], a[148:151], a[4:7], v[48:51]
v_mfma_f32_16x16x32_bf16 v[48:51], a[152:155], a[8:11], v[48:51]
v_mfma_f32_16x16x32_bf16 v[48:51], a[156:159], a[12:15], v[48:51]
s_waitcnt lgkmcnt(14)
v_mfma_f32_16x16x32_bf16 v[64:67], a[160:163], a[0:3], 0
s_waitcnt lgkmcnt(12)
v_mfma_f32_16x16x32_bf16 v[64:67], a[164:167], a[4:7], v[64:67]
s_waitcnt lgkmcnt(10)
v_mfma_f32_16x16x32_bf16 v[64:67], a[168:171], a[8:11], v[64:67]
s_waitcnt lgkmcnt(8)
v_mfma_f32_16x16x32_bf16 v[64:67], a[172:175], a[12:15], v[64:67]
s_waitcnt lgkmcnt(6)
v_mfma_f32_16x16x32_bf16 v[80:83], a[176:179], a[0:3], 0
s_waitcnt lgkmcnt(4)
v_mfma_f32_16x16x32_bf16 v[80:83], a[180:183], a[4:7], v[80:83]
s_waitcnt lgkmcnt(2)
v_mfma_f32_16x16x32_bf16 v[80:83], a[184:187], a[8:11], v[80:83]
s_waitcnt lgkmcnt(0)
v_mfma_f32_16x16x32_bf16 v[80:83], a[188:191], a[12:15], v[80:83]
s_waitcnt vmcnt(11)
v_mfma_f32_16x16x32_bf16 v[36:39], a[128:131], a[16:19], 0
s_waitcnt vmcnt(10)
v_mfma_f32_16x16x32_bf16 v[36:39], a[132:135], a[20:23], v[36:39]
s_waitcnt vmcnt(9)
v_mfma_f32_16x16x32_bf16 v[36:39], a[136:139], a[24:27], v[36:39]
s_waitcnt vmcnt(8)
v_mfma_f32_16x16x32_bf16 v[36:39], a[140:143], a[28:31], v[36:39]
v_mfma_f32_16x16x32_bf16 v[52:55], a[144:147], a[16:19], 0
v_mfma_f32_16x16x32_bf16 v[52:55], a[148:151], a[20:23], v[52:55]
v_mfma_f32_16x16x32_bf16 v[52:55], a[152:155], a[24:27], v[52:55]
v_mfma_f32_16x16x32_bf16 v[52:55], a[156:159], a[28:31], v[52:55]
v_mfma_f32_16x16x32_bf16 v[68:71], a[160:163], a[16:19], 0
v_mfma_f32_16x16x32_bf16 v[68:71], a[164:167], a[20:23], v[68:71]
v_mfma_f32_16x16x32_bf16 v[68:71], a[168:171], a[24:27], v[68:71]
v_mfma_f32_16x16x32_bf16 v[68:71], a[172:175], a[28:31], v[68:71]
v_mfma_f32_16x16x32_bf16 v[84:87], a[176:179], a[16:19], 0
v_mfma_f32_16x16x32_bf16 v[84:87], a[180:183], a[20:23], v[84:87]
v_mfma_f32_16x16x32_bf16 v[84:87], a[184:187], a[24:27], v[84:87]
v_mfma_f32_16x16x32_bf16 v[84:87], a[188:191], a[28:31], v[84:87]
s_waitcnt vmcnt(7)
v_mfma_f32_16x16x32_bf16 v[40:43], a[128:131], a[32:35], 0
s_waitcnt vmcnt(6)
v_mfma_f32_16x16x32_bf16 v[40:43], a[132:135], a[36:39], v[40:43]
s_waitcnt vmcnt(5)
v_mfma_f32_16x16x32_bf16 v[40:43], a[136:139], a[40:43], v[40:43]
s_waitcnt vmcnt(4)
v_mfma_f32_16x16x32_bf16 v[40:43], a[140:143], a[44:47], v[40:43]
buffer_load_dwordx4 a[64:67], v5, s[4:7], s40 offen offset:0 sc1
v_mfma_f32_16x16x32_bf16 v[56:59], a[144:147], a[32:35], 0
v_mfma_f32_16x16x32_bf16 v[56:59], a[148:151], a[36:39], v[56:59]
v_mfma_f32_16x16x32_bf16 v[56:59], a[152:155], a[40:43], v[56:59]
v_mfma_f32_16x16x32_bf16 v[56:59], a[156:159], a[44:47], v[56:59]
buffer_load_dwordx4 a[68:71], v5, s[4:7], s40 offen offset:1024 sc1
v_mfma_f32_16x16x32_bf16 v[72:75], a[160:163], a[32:35], 0
v_mfma_f32_16x16x32_bf16 v[72:75], a[164:167], a[36:39], v[72:75]
v_mfma_f32_16x16x32_bf16 v[72:75], a[168:171], a[40:43], v[72:75]
v_mfma_f32_16x16x32_bf16 v[72:75], a[172:175], a[44:47], v[72:75]
buffer_load_dwordx4 a[72:75], v5, s[4:7], s40 offen offset:2048 sc1
v_mfma_f32_16x16x32_bf16 v[88:91], a[176:179], a[32:35], 0
v_mfma_f32_16x16x32_bf16 v[88:91], a[180:183], a[36:39], v[88:91]
v_mfma_f32_16x16x32_bf16 v[88:91], a[184:187], a[40:43], v[88:91]
v_mfma_f32_16x16x32_bf16 v[88:91], a[188:191], a[44:47], v[88:91]
s_waitcnt vmcnt(6)
v_mfma_f32_16x16x32_bf16 v[44:47], a[128:131], a[48:51], 0
s_waitcnt vmcnt(5)
v_mfma_f32_16x16x32_bf16 v[44:47], a[132:135], a[52:55], v[44:47]
s_waitcnt vmcnt(4)
v_mfma_f32_16x16x32_bf16 v[44:47], a[136:139], a[56:59], v[44:47]
s_barrier
s_waitcnt vmcnt(3)
v_mfma_f32_16x16x32_bf16 v[44:47], a[140:143], a[60:63], v[44:47]
buffer_load_dwordx4 a[76:79], v5, s[4:7], s40 offen offset:3072 sc1
v_mfma_f32_16x16x32_bf16 v[60:63], a[144:147], a[48:51], 0
s_add_u32 s40, s42, 20480
v_mfma_f32_16x16x32_bf16 v[60:63], a[148:151], a[52:55], v[60:63]
buffer_load_dwordx4 a[80:83], v5, s[4:7], s40 offen offset:0 sc1
v_mfma_f32_16x16x32_bf16 v[60:63], a[152:155], a[56:59], v[60:63]
ds_read_b64_tr_b16 a[128:129], v1 offset:49152
v_mfma_f32_16x16x32_bf16 v[60:63], a[156:159], a[60:63], v[60:63]
ds_read_b64_tr_b16 a[130:131], v1 offset:51200
v_mfma_f32_16x16x32_bf16 v[76:79], a[160:163], a[48:51], 0
ds_read_b64_tr_b16 a[132:133], v1 offset:53248
v_mfma_f32_16x16x32_bf16 v[76:79], a[164:167], a[52:55], v[76:79]
ds_read_b64_tr_b16 a[134:135], v1 offset:55296
v_mfma_f32_16x16x32_bf16 v[76:79], a[168:171], a[56:59], v[76:79]
ds_read_b64_tr_b16 a[136:137], v1 offset:57344
v_mfma_f32_16x16x32_bf16 v[76:79], a[172:175], a[60:63], v[76:79]
ds_read_b64_tr_b16 a[138:139], v1 offset:59392
v_mfma_f32_16x16x32_bf16 v[92:95], a[176:179], a[48:51], 0
ds_read_b64_tr_b16 a[140:141], v1 offset:61440
v_mfma_f32_16x16x32_bf16 v[92:95], a[180:183], a[52:55], v[92:95]
ds_read_b64_tr_b16 a[142:143], v1 offset:63488
v_mfma_f32_16x16x32_bf16 v[92:95], a[184:187], a[56:59], v[92:95]
buffer_load_dwordx4 a[84:87], v5, s[4:7], s40 offen offset:1024 sc1
v_mfma_f32_16x16x32_bf16 v[92:95], a[188:191], a[60:63], v[92:95]
s_waitcnt lgkmcnt(4)
v_mfma_f32_16x16x32_bf16 v[96:99], a[128:131], a[0:3], 0
buffer_load_dwordx4 a[88:91], v5, s[4:7], s40 offen offset:2048 sc1
v_mfma_f32_16x16x32_bf16 v[96:99], a[132:135], a[4:7], v[96:99]
ds_read_b64_tr_b16 a[144:145], v2 offset:49152
s_waitcnt lgkmcnt(1)
v_mfma_f32_16x16x32_bf16 v[96:99], a[136:139], a[8:11], v[96:99]
ds_read_b64_tr_b16 a[146:147], v2 offset:51200
v_mfma_f32_16x16x32_bf16 v[96:99], a[140:143], a[12:15], v[96:99]
ds_read_b64_tr_b16 a[148:149], v2 offset:53248
v_mfma_f32_16x16x32_bf16 v[100:103], a[128:131], a[16:19], 0
buffer_load_dwordx4 a[92:95], v5, s[4:7], s40 offen offset:3072 sc1
v_mfma_f32_16x16x32_bf16 v[100:103], a[132:135], a[20:23], v[100:103]
ds_read_b64_tr_b16 a[150:151], v2 offset:55296
s_add_u32 s40, s42, 24576
v_mfma_f32_16x16x32_bf16 v[100:103], a[136:139], a[24:27], v[100:103]
ds_read_b64_tr_b16 a[152:153], v2 offset:57344
v_mfma_f32_16x16x32_bf16 v[100:103], a[140:143], a[28:31], v[100:103]
v_mfma_f32_16x16x32_bf16 v[104:107], a[128:131], a[32:35], 0
buffer_load_dwordx4 a[96:99], v5, s[4:7], s40 offen offset:0 sc1
v_mfma_f32_16x16x32_bf16 v[104:107], a[132:135], a[36:39], v[104:107]
ds_read_b64_tr_b16 a[154:155], v2 offset:59392
v_mfma_f32_16x16x32_bf16 v[104:107], a[136:139], a[40:43], v[104:107]
ds_read_b64_tr_b16 a[156:157], v2 offset:61440
v_mfma_f32_16x16x32_bf16 v[104:107], a[140:143], a[44:47], v[104:107]
ds_read_b64_tr_b16 a[158:159], v2 offset:63488
v_mfma_f32_16x16x32_bf16 v[108:111], a[128:131], a[48:51], 0
buffer_load_dwordx4 a[100:103], v5, s[4:7], s40 offen offset:1024 sc1
v_mfma_f32_16x16x32_bf16 v[108:111], a[132:135], a[52:55], v[108:111]
v_mfma_f32_16x16x32_bf16 v[108:111], a[136:139], a[56:59], v[108:111]
v_mfma_f32_16x16x32_bf16 v[108:111], a[140:143], a[60:63], v[108:111]
s_waitcnt lgkmcnt(0)
v_mfma_f32_16x16x32_bf16 v[112:115], a[144:147], a[0:3], 0
buffer_load_dwordx4 a[104:107], v5, s[4:7], s40 offen offset:2048 sc1
v_mfma_f32_16x16x32_bf16 v[112:115], a[148:151], a[4:7], v[112:115]
ds_read_b64_tr_b16 a[128:129], v3 offset:49152
v_mfma_f32_16x16x32_bf16 v[112:115], a[152:155], a[8:11], v[112:115]
ds_read_b64_tr_b16 a[130:131], v3 offset:51200
v_mfma_f32_16x16x32_bf16 v[112:115], a[156:159], a[12:15], v[112:115]
ds_read_b64_tr_b16 a[132:133], v3 offset:53248
v_mfma_f32_16x16x32_bf16 v[116:119], a[144:147], a[16:19], 0
buffer_load_dwordx4 a[108:111], v5, s[4:7], s40 offen offset:3072 sc1
v_mfma_f32_16x16x32_bf16 v[116:119], a[148:151], a[20:23], v[116:119]
ds_read_b64_tr_b16 a[134:135], v3 offset:55296
s_add_u32 s40, s42, 28672
v_mfma_f32_16x16x32_bf16 v[116:119], a[152:155], a[24:27], v[116:119]
ds_read_b64_tr_b16 a[136:137], v3 offset:57344
v_mfma_f32_16x16x32_bf16 v[116:119], a[156:159], a[28:31], v[116:119]
v_mfma_f32_16x16x32_bf16 v[120:123], a[144:147], a[32:35], 0
buffer_load_dwordx4 a[112:115], v5, s[4:7], s40 offen offset:0 sc1
v_mfma_f32_16x16x32_bf16 v[120:123], a[148:151], a[36:39], v[120:123]
ds_read_b64_tr_b16 a[138:139], v3 offset:59392
v_mfma_f32_16x16x32_bf16 v[120:123], a[152:155], a[40:43], v[120:123]
ds_read_b64_tr_b16 a[140:141], v3 offset:61440
v_mfma_f32_16x16x32_bf16 v[120:123], a[156:159], a[44:47], v[120:123]
ds_read_b64_tr_b16 a[142:143], v3 offset:63488
v_mfma_f32_16x16x32_bf16 v[124:127], a[144:147], a[48:51], 0
buffer_load_dwordx4 a[116:119], v5, s[4:7], s40 offen offset:1024 sc1
v_mfma_f32_16x16x32_bf16 v[124:127], a[148:151], a[52:55], v[124:127]
v_mfma_f32_16x16x32_bf16 v[124:127], a[152:155], a[56:59], v[124:127]
v_mfma_f32_16x16x32_bf16 v[124:127], a[156:159], a[60:63], v[124:127]
s_waitcnt lgkmcnt(0)
v_mfma_f32_16x16x32_bf16 v[128:131], a[128:131], a[0:3], 0
buffer_load_dwordx4 a[120:123], v5, s[4:7], s40 offen offset:2048 sc1
v_mfma_f32_16x16x32_bf16 v[128:131], a[132:135], a[4:7], v[128:131]
ds_read_b64_tr_b16 a[144:145], v4 offset:49152
v_mfma_f32_16x16x32_bf16 v[128:131], a[136:139], a[8:11], v[128:131]
ds_read_b64_tr_b16 a[146:147], v4 offset:51200
v_mfma_f32_16x16x32_bf16 v[128:131], a[140:143], a[12:15], v[128:131]
ds_read_b64_tr_b16 a[148:149], v4 offset:53248
v_mfma_f32_16x16x32_bf16 v[132:135], a[128:131], a[16:19], 0
buffer_load_dwordx4 a[124:127], v5, s[4:7], s40 offen offset:3072 sc1
v_mfma_f32_16x16x32_bf16 v[132:135], a[132:135], a[20:23], v[132:135]
ds_read_b64_tr_b16 a[150:151], v4 offset:55296
s_add_u32 m0, s37, 32768
v_mfma_f32_16x16x32_bf16 v[132:135], a[136:139], a[24:27], v[132:135]
ds_read_b64_tr_b16 a[152:153], v4 offset:57344
s_mov_b32 s39, 2097152
v_mfma_f32_16x16x32_bf16 v[132:135], a[140:143], a[28:31], v[132:135]
v_mfma_f32_16x16x32_bf16 v[136:139], a[128:131], a[32:35], 0
buffer_load_dwordx4 v6, s[8:11], s39 offen offset:0  lds
v_mfma_f32_16x16x32_bf16 v[136:139], a[132:135], a[36:39], v[136:139]
ds_read_b64_tr_b16 a[154:155], v4 offset:59392
s_mov_b32 s38, 2161664
v_mfma_f32_16x16x32_bf16 v[136:139], a[136:139], a[40:43], v[136:139]
ds_read_b64_tr_b16 a[156:157], v4 offset:61440
v_mfma_f32_16x16x32_bf16 v[136:139], a[140:143], a[44:47], v[136:139]
ds_read_b64_tr_b16 a[158:159], v4 offset:63488
v_mfma_f32_16x16x32_bf16 v[140:143], a[128:131], a[48:51], 0
buffer_load_dwordx4 v6, s[8:11], s38 offen offset:1024  lds
v_mfma_f32_16x16x32_bf16 v[140:143], a[132:135], a[52:55], v[140:143]
s_mov_b32 s39, 2226176
v_mfma_f32_16x16x32_bf16 v[140:143], a[136:139], a[56:59], v[140:143]
v_mfma_f32_16x16x32_bf16 v[140:143], a[140:143], a[60:63], v[140:143]
s_waitcnt lgkmcnt(0)
v_mfma_f32_16x16x32_bf16 v[144:147], a[144:147], a[0:3], 0
buffer_load_dwordx4 v6, s[8:11], s39 offen offset:2048  lds
v_mfma_f32_16x16x32_bf16 v[144:147], a[148:151], a[4:7], v[144:147]
s_mov_b32 s38, 2290688
v_xor_b32 v1, 0x10000, v1
v_xor_b32 v2, 0x10000, v2
v_mfma_f32_16x16x32_bf16 v[144:147], a[152:155], a[8:11], v[144:147]
v_xor_b32 v3, 0x10000, v3
v_xor_b32 v4, 0x10000, v4
v_mfma_f32_16x16x32_bf16 v[144:147], a[156:159], a[12:15], v[144:147]
s_barrier
v_mfma_f32_16x16x32_bf16 v[148:151], a[144:147], a[16:19], 0
ds_read_b64_tr_b16 a[128:129], v1 offset:0
v_mfma_f32_16x16x32_bf16 v[148:151], a[148:151], a[20:23], v[148:151]
buffer_load_dwordx4 v6, s[8:11], s38 offen offset:3072  lds
v_mfma_f32_16x16x32_bf16 v[148:151], a[152:155], a[24:27], v[148:151]
ds_read_b64_tr_b16 a[130:131], v1 offset:2048
s_add_u32 m0, s37, 49152
v_mfma_f32_16x16x32_bf16 v[148:151], a[156:159], a[28:31], v[148:151]
ds_read_b64_tr_b16 a[132:133], v1 offset:4096
s_mov_b32 s39, 2097280
v_mfma_f32_16x16x32_bf16 v[152:155], a[144:147], a[32:35], 0
ds_read_b64_tr_b16 a[134:135], v1 offset:6144
v_mfma_f32_16x16x32_bf16 v[152:155], a[148:151], a[36:39], v[152:155]
ds_read_b64_tr_b16 a[136:137], v1 offset:8192
v_mfma_f32_16x16x32_bf16 v[152:155], a[152:155], a[40:43], v[152:155]
ds_read_b64_tr_b16 a[138:139], v1 offset:10240
v_mfma_f32_16x16x32_bf16 v[152:155], a[156:159], a[44:47], v[152:155]
ds_read_b64_tr_b16 a[140:141], v1 offset:12288
v_mfma_f32_16x16x32_bf16 v[156:159], a[144:147], a[48:51], 0
ds_read_b64_tr_b16 a[142:143], v1 offset:14336
v_mfma_f32_16x16x32_bf16 v[156:159], a[148:151], a[52:55], v[156:159]
buffer_load_dwordx4 v6, s[8:11], s39 offen offset:0  lds
v_mfma_f32_16x16x32_bf16 v[156:159], a[152:155], a[56:59], v[156:159]
s_mov_b32 s38, 2161792
v_mfma_f32_16x16x32_bf16 v[156:159], a[156:159], a[60:63], v[156:159]
s_waitcnt vmcnt(20) lgkmcnt(4)
v_mfma_f32_16x16x32_bf16 v[32:35], a[128:131], a[64:67], v[32:35]
ds_read_b64_tr_b16 a[144:145], v2 offset:0
s_waitcnt vmcnt(19)
v_mfma_f32_16x16x32_bf16 v[32:35], a[132:135], a[68:71], v[32:35]
s_add_u32 s40, s42, 32768
s_waitcnt vmcnt(18) lgkmcnt(1)
v_mfma_f32_16x16x32_bf16 v[32:35], a[136:139], a[72:75], v[32:35]
ds_read_b64_tr_b16 a[146:147], v2 offset:2048
s_waitcnt vmcnt(17)
v_mfma_f32_16x16x32_bf16 v[32:35], a[140:143], a[76:79], v[32:35]
ds_read_b64_tr_b16 a[148:149], v2 offset:4096
s_waitcnt vmcnt(16)
v_mfma_f32_16x16x32_bf16 v[36:39], a[128:131], a[80:83], v[36:39]
s_waitcnt vmcnt(15)
v_mfma_f32_16x16x32_bf16 v[36:39], a[132:135], a[84:87], v[36:39]
ds_read_b64_tr_b16 a[150:151], v2 offset:6144
s_waitcnt vmcnt(14)
v_mfma_f32_16x16x32_bf16 v[36:39], a[136:139], a[88:91], v[36:39]
ds_read_b64_tr_b16 a[152:153], v2 offset:8192
s_waitcnt vmcnt(13)
v_mfma_f32_16x16x32_bf16 v[36:39], a[140:143], a[92:95], v[36:39]
s_waitcnt vmcnt(12)
v_mfma_f32_16x16x32_bf16 v[40:43], a[128:131], a[96:99], v[40:43]
ds_read_b64_tr_b16 a[154:155], v2 offset:10240
s_waitcnt vmcnt(11)
v_mfma_f32_16x16x32_bf16 v[40:43], a[132:135], a[100:103], v[40:43]
ds_read_b64_tr_b16 a[156:157], v2 offset:12288
s_waitcnt vmcnt(10)
v_mfma_f32_16x16x32_bf16 v[40:43], a[136:139], a[104:107], v[40:43]
s_waitcnt vmcnt(9)
v_mfma_f32_16x16x32_bf16 v[40:43], a[140:143], a[108:111], v[40:43]
ds_read_b64_tr_b16 a[158:159], v2 offset:14336
s_waitcnt vmcnt(8)
v_mfma_f32_16x16x32_bf16 v[44:47], a[128:131], a[112:115], v[44:47]
s_waitcnt vmcnt(7)
v_mfma_f32_16x16x32_bf16 v[44:47], a[132:135], a[116:119], v[44:47]
s_waitcnt vmcnt(6)
v_mfma_f32_16x16x32_bf16 v[44:47], a[136:139], a[120:123], v[44:47]
s_waitcnt vmcnt(5)
v_mfma_f32_16x16x32_bf16 v[44:47], a[140:143], a[124:127], v[44:47]
s_waitcnt lgkmcnt(0)
v_mfma_f32_16x16x32_bf16 v[48:51], a[144:147], a[64:67], v[48:51]
buffer_load_dwordx4 a[0:3], v5, s[4:7], s40 offen offset:0 sc1
v_mfma_f32_16x16x32_bf16 v[48:51], a[148:151], a[68:71], v[48:51]
ds_read_b64_tr_b16 a[128:129], v3 offset:0
v_mfma_f32_16x16x32_bf16 v[48:51], a[152:155], a[72:75], v[48:51]
buffer_load_dwordx4 a[4:7], v5, s[4:7], s40 offen offset:1024 sc1
v_mfma_f32_16x16x32_bf16 v[48:51], a[156:159], a[76:79], v[48:51]
ds_read_b64_tr_b16 a[130:131], v3 offset:2048
v_mfma_f32_16x16x32_bf16 v[52:55], a[144:147], a[80:83], v[52:55]
ds_read_b64_tr_b16 a[132:133], v3 offset:4096
v_mfma_f32_16x16x32_bf16 v[52:55], a[148:151], a[84:87], v[52:55]
ds_read_b64_tr_b16 a[134:135], v3 offset:6144
v_mfma_f32_16x16x32_bf16 v[52:55], a[152:155], a[88:91], v[52:55]
buffer_load_dwordx4 a[8:11], v5, s[4:7], s40 offen offset:2048 sc1
v_mfma_f32_16x16x32_bf16 v[52:55], a[156:159], a[92:95], v[52:55]
ds_read_b64_tr_b16 a[136:137], v3 offset:8192
v_mfma_f32_16x16x32_bf16 v[56:59], a[144:147], a[96:99], v[56:59]
ds_read_b64_tr_b16 a[138:139], v3 offset:10240
v_mfma_f32_16x16x32_bf16 v[56:59], a[148:151], a[100:103], v[56:59]
ds_read_b64_tr_b16 a[140:141], v3 offset:12288
v_mfma_f32_16x16x32_bf16 v[56:59], a[152:155], a[104:107], v[56:59]
buffer_load_dwordx4 a[12:15], v5, s[4:7], s40 offen offset:3072 sc1
v_mfma_f32_16x16x32_bf16 v[56:59], a[156:159], a[108:111], v[56:59]
ds_read_b64_tr_b16 a[142:143], v3 offset:14336
s_add_u32 s40, s42, 36864
v_mfma_f32_16x16x32_bf16 v[60:63], a[144:147], a[112:115], v[60:63]
v_mfma_f32_16x16x32_bf16 v[60:63], a[148:151], a[116:119], v[60:63]
v_mfma_f32_16x16x32_bf16 v[60:63], a[152:155], a[120:123], v[60:63]
buffer_load_dwordx4 a[16:19], v5, s[4:7], s40 offen offset:0 sc1
v_mfma_f32_16x16x32_bf16 v[60:63], a[156:159], a[124:127], v[60:63]
s_waitcnt lgkmcnt(0)
v_mfma_f32_16x16x32_bf16 v[64:67], a[128:131], a[64:67], v[64:67]
ds_read_b64_tr_b16 a[144:145], v4 offset:0
v_mfma_f32_16x16x32_bf16 v[64:67], a[132:135], a[68:71], v[64:67]
v_mfma_f32_16x16x32_bf16 v[64:67], a[136:139], a[72:75], v[64:67]
buffer_load_dwordx4 a[20:23], v5, s[4:7], s40 offen offset:1024 sc1
v_mfma_f32_16x16x32_bf16 v[64:67], a[140:143], a[76:79], v[64:67]
ds_read_b64_tr_b16 a[146:147], v4 offset:2048
v_mfma_f32_16x16x32_bf16 v[68:71], a[128:131], a[80:83], v[68:71]
ds_read_b64_tr_b16 a[148:149], v4 offset:4096
v_mfma_f32_16x16x32_bf16 v[68:71], a[132:135], a[84:87], v[68:71]
ds_read_b64_tr_b16 a[150:151], v4 offset:6144
v_mfma_f32_16x16x32_bf16 v[68:71], a[136:139], a[88:91], v[68:71]
buffer_load_dwordx4 a[24:27], v5, s[4:7], s40 offen offset:2048 sc1
v_mfma_f32_16x16x32_bf16 v[68:71], a[140:143], a[92:95], v[68:71]
ds_read_b64_tr_b16 a[152:153], v4 offset:8192
v_mfma_f32_16x16x32_bf16 v[72:75], a[128:131], a[96:99], v[72:75]
ds_read_b64_tr_b16 a[154:155], v4 offset:10240
v_mfma_f32_16x16x32_bf16 v[72:75], a[132:135], a[100:103], v[72:75]
ds_read_b64_tr_b16 a[156:157], v4 offset:12288
v_mfma_f32_16x16x32_bf16 v[72:75], a[136:139], a[104:107], v[72:75]
buffer_load_dwordx4 a[28:31], v5, s[4:7], s40 offen offset:3072 sc1
v_mfma_f32_16x16x32_bf16 v[72:75], a[140:143], a[108:111], v[72:75]
ds_read_b64_tr_b16 a[158:159], v4 offset:14336
s_add_u32 s40, s42, 40960
v_mfma_f32_16x16x32_bf16 v[76:79], a[128:131], a[112:115], v[76:79]
v_mfma_f32_16x16x32_bf16 v[76:79], a[132:135], a[116:119], v[76:79]
v_mfma_f32_16x16x32_bf16 v[76:79], a[136:139], a[120:123], v[76:79]
buffer_load_dwordx4 a[32:35], v5, s[4:7], s40 offen offset:0 sc1
v_mfma_f32_16x16x32_bf16 v[76:79], a[140:143], a[124:127], v[76:79]
s_waitcnt lgkmcnt(0)
v_mfma_f32_16x16x32_bf16 v[80:83], a[144:147], a[64:67], v[80:83]
v_mfma_f32_16x16x32_bf16 v[80:83], a[148:151], a[68:71], v[80:83]
v_mfma_f32_16x16x32_bf16 v[80:83], a[152:155], a[72:75], v[80:83]
buffer_load_dwordx4 a[36:39], v5, s[4:7], s40 offen offset:1024 sc1
v_mfma_f32_16x16x32_bf16 v[80:83], a[156:159], a[76:79], v[80:83]
s_barrier
v_mfma_f32_16x16x32_bf16 v[84:87], a[144:147], a[80:83], v[84:87]
ds_read_b64_tr_b16 a[128:129], v1 offset:16384
v_mfma_f32_16x16x32_bf16 v[84:87], a[148:151], a[84:87], v[84:87]
ds_read_b64_tr_b16 a[130:131], v1 offset:18432
v_mfma_f32_16x16x32_bf16 v[84:87], a[152:155], a[88:91], v[84:87]
buffer_load_dwordx4 a[40:43], v5, s[4:7], s40 offen offset:2048 sc1
v_mfma_f32_16x16x32_bf16 v[84:87], a[156:159], a[92:95], v[84:87]
ds_read_b64_tr_b16 a[132:133], v1 offset:20480
v_mfma_f32_16x16x32_bf16 v[88:91], a[144:147], a[96:99], v[88:91]
ds_read_b64_tr_b16 a[134:135], v1 offset:22528
v_mfma_f32_16x16x32_bf16 v[88:91], a[148:151], a[100:103], v[88:91]
ds_read_b64_tr_b16 a[136:137], v1 offset:24576
v_mfma_f32_16x16x32_bf16 v[88:91], a[152:155], a[104:107], v[88:91]
ds_read_b64_tr_b16 a[138:139], v1 offset:26624
v_mfma_f32_16x16x32_bf16 v[88:91], a[156:159], a[108:111], v[88:91]
ds_read_b64_tr_b16 a[140:141], v1 offset:28672
v_mfma_f32_16x16x32_bf16 v[92:95], a[144:147], a[112:115], v[92:95]
ds_read_b64_tr_b16 a[142:143], v1 offset:30720
v_mfma_f32_16x16x32_bf16 v[92:95], a[148:151], a[116:119], v[92:95]
buffer_load_dwordx4 a[44:47], v5, s[4:7], s40 offen offset:3072 sc1
v_mfma_f32_16x16x32_bf16 v[92:95], a[152:155], a[120:123], v[92:95]
s_add_u32 s40, s42, 45056
v_mfma_f32_16x16x32_bf16 v[92:95], a[156:159], a[124:127], v[92:95]
s_waitcnt lgkmcnt(4)
v_mfma_f32_16x16x32_bf16 v[96:99], a[128:131], a[64:67], v[96:99]
buffer_load_dwordx4 a[48:51], v5, s[4:7], s40 offen offset:0 sc1
v_mfma_f32_16x16x32_bf16 v[96:99], a[132:135], a[68:71], v[96:99]
ds_read_b64_tr_b16 a[144:145], v2 offset:16384
s_waitcnt lgkmcnt(1)
v_mfma_f32_16x16x32_bf16 v[96:99], a[136:139], a[72:75], v[96:99]
ds_read_b64_tr_b16 a[146:147], v2 offset:18432
v_mfma_f32_16x16x32_bf16 v[96:99], a[140:143], a[76:79], v[96:99]
buffer_load_dwordx4 a[52:55], v5, s[4:7], s40 offen offset:1024 sc1
v_mfma_f32_16x16x32_bf16 v[100:103], a[128:131], a[80:83], v[100:103]
ds_read_b64_tr_b16 a[148:149], v2 offset:20480
v_mfma_f32_16x16x32_bf16 v[100:103], a[132:135], a[84:87], v[100:103]
ds_read_b64_tr_b16 a[150:151], v2 offset:22528
v_mfma_f32_16x16x32_bf16 v[100:103], a[136:139], a[88:91], v[100:103]
ds_read_b64_tr_b16 a[152:153], v2 offset:24576
v_mfma_f32_16x16x32_bf16 v[100:103], a[140:143], a[92:95], v[100:103]
buffer_load_dwordx4 a[56:59], v5, s[4:7], s40 offen offset:2048 sc1
v_mfma_f32_16x16x32_bf16 v[104:107], a[128:131], a[96:99], v[104:107]
ds_read_b64_tr_b16 a[154:155], v2 offset:26624
v_mfma_f32_16x16x32_bf16 v[104:107], a[132:135], a[100:103], v[104:107]
ds_read_b64_tr_b16 a[156:157], v2 offset:28672
v_mfma_f32_16x16x32_bf16 v[104:107], a[136:139], a[104:107], v[104:107]
v_mfma_f32_16x16x32_bf16 v[104:107], a[140:143], a[108:111], v[104:107]
buffer_load_dwordx4 a[60:63], v5, s[4:7], s40 offen offset:3072 sc1
v_mfma_f32_16x16x32_bf16 v[108:111], a[128:131], a[112:115], v[108:111]
ds_read_b64_tr_b16 a[158:159], v2 offset:30720
v_mfma_f32_16x16x32_bf16 v[108:111], a[132:135], a[116:119], v[108:111]
v_mfma_f32_16x16x32_bf16 v[108:111], a[136:139], a[120:123], v[108:111]
v_mfma_f32_16x16x32_bf16 v[108:111], a[140:143], a[124:127], v[108:111]
s_waitcnt lgkmcnt(0)
v_mfma_f32_16x16x32_bf16 v[112:115], a[144:147], a[64:67], v[112:115]
buffer_load_dwordx4 v6, s[8:11], s38 offen offset:1024  lds
v_mfma_f32_16x16x32_bf16 v[112:115], a[148:151], a[68:71], v[112:115]
ds_read_b64_tr_b16 a[128:129], v3 offset:16384
s_mov_b32 s39, 2226304
v_mfma_f32_16x16x32_bf16 v[112:115], a[152:155], a[72:75], v[112:115]
ds_read_b64_tr_b16 a[130:131], v3 offset:18432
v_mfma_f32_16x16x32_bf16 v[112:115], a[156:159], a[76:79], v[112:115]
buffer_load_dwordx4 v6, s[8:11], s39 offen offset:2048  lds
v_mfma_f32_16x16x32_bf16 v[116:119], a[144:147], a[80:83], v[116:119]
ds_read_b64_tr_b16 a[132:133], v3 offset:20480
s_mov_b32 s38, 2290816
v_mfma_f32_16x16x32_bf16 v[116:119], a[148:151], a[84:87], v[116:119]
ds_read_b64_tr_b16 a[134:135], v3 offset:22528
v_mfma_f32_16x16x32_bf16 v[116:119], a[152:155], a[88:91], v[116:119]
ds_read_b64_tr_b16 a[136:137], v3 offset:24576
v_mfma_f32_16x16x32_bf16 v[116:119], a[156:159], a[92:95], v[116:119]
buffer_load_dwordx4 v6, s[8:11], s38 offen offset:3072  lds
v_mfma_f32_16x16x32_bf16 v[120:123], a[144:147], a[96:99], v[120:123]
ds_read_b64_tr_b16 a[138:139], v3 offset:26624
s_add_u32 m0, s37, 65536
v_mfma_f32_16x16x32_bf16 v[120:123], a[148:151], a[100:103], v[120:123]
ds_read_b64_tr_b16 a[140:141], v3 offset:28672
s_mov_b32 s39, 3145728
v_mfma_f32_16x16x32_bf16 v[120:123], a[152:155], a[104:107], v[120:123]
v_mfma_f32_16x16x32_bf16 v[120:123], a[156:159], a[108:111], v[120:123]
buffer_load_dwordx4 v6, s[8:11], s39 offen offset:0  lds
v_mfma_f32_16x16x32_bf16 v[124:127], a[144:147], a[112:115], v[124:127]
ds_read_b64_tr_b16 a[142:143], v3 offset:30720
s_mov_b32 s38, 3210240
v_mfma_f32_16x16x32_bf16 v[124:127], a[148:151], a[116:119], v[124:127]
v_mfma_f32_16x16x32_bf16 v[124:127], a[152:155], a[120:123], v[124:127]
v_mfma_f32_16x16x32_bf16 v[124:127], a[156:159], a[124:127], v[124:127]
s_waitcnt lgkmcnt(0)
v_mfma_f32_16x16x32_bf16 v[128:131], a[128:131], a[64:67], v[128:131]
buffer_load_dwordx4 v6, s[8:11], s38 offen offset:1024  lds
v_mfma_f32_16x16x32_bf16 v[128:131], a[132:135], a[68:71], v[128:131]
ds_read_b64_tr_b16 a[144:145], v4 offset:16384
s_mov_b32 s39, 3274752
v_mfma_f32_16x16x32_bf16 v[128:131], a[136:139], a[72:75], v[128:131]
ds_read_b64_tr_b16 a[146:147], v4 offset:18432
v_mfma_f32_16x16x32_bf16 v[128:131], a[140:143], a[76:79], v[128:131]
buffer_load_dwordx4 v6, s[8:11], s39 offen offset:2048  lds
v_mfma_f32_16x16x32_bf16 v[132:135], a[128:131], a[80:83], v[132:135]
ds_read_b64_tr_b16 a[148:149], v4 offset:20480
s_mov_b32 s38, 3339264
v_mfma_f32_16x16x32_bf16 v[132:135], a[132:135], a[84:87], v[132:135]
ds_read_b64_tr_b16 a[150:151], v4 offset:22528
v_mfma_f32_16x16x32_bf16 v[132:135], a[136:139], a[88:91], v[132:135]
ds_read_b64_tr_b16 a[152:153], v4 offset:24576
v_mfma_f32_16x16x32_bf16 v[132:135], a[140:143], a[92:95], v[132:135]
buffer_load_dwordx4 v6, s[8:11], s38 offen offset:3072  lds
v_mfma_f32_16x16x32_bf16 v[136:139], a[128:131], a[96:99], v[136:139]
ds_read_b64_tr_b16 a[154:155], v4 offset:26624
s_add_u32 m0, s37, 81920
v_mfma_f32_16x16x32_bf16 v[136:139], a[132:135], a[100:103], v[136:139]
ds_read_b64_tr_b16 a[156:157], v4 offset:28672
s_mov_b32 s39, 3145856
v_mfma_f32_16x16x32_bf16 v[136:139], a[136:139], a[104:107], v[136:139]
v_mfma_f32_16x16x32_bf16 v[136:139], a[140:143], a[108:111], v[136:139]
buffer_load_dwordx4 v6, s[8:11], s39 offen offset:0  lds
v_mfma_f32_16x16x32_bf16 v[140:143], a[128:131], a[112:115], v[140:143]
ds_read_b64_tr_b16 a[158:159], v4 offset:30720
s_mov_b32 s38, 3210368
v_mfma_f32_16x16x32_bf16 v[140:143], a[132:135], a[116:119], v[140:143]
v_mfma_f32_16x16x32_bf16 v[140:143], a[136:139], a[120:123], v[140:143]
v_mfma_f32_16x16x32_bf16 v[140:143], a[140:143], a[124:127], v[140:143]
s_waitcnt lgkmcnt(0)
v_mfma_f32_16x16x32_bf16 v[144:147], a[144:147], a[64:67], v[144:147]
buffer_load_dwordx4 v6, s[8:11], s38 offen offset:1024  lds
v_mfma_f32_16x16x32_bf16 v[144:147], a[148:151], a[68:71], v[144:147]
s_mov_b32 s39, 3274880
v_mfma_f32_16x16x32_bf16 v[144:147], a[152:155], a[72:75], v[144:147]
s_waitcnt vmcnt(26)
s_barrier
v_mfma_f32_16x16x32_bf16 v[144:147], a[156:159], a[76:79], v[144:147]
buffer_load_dwordx4 v6, s[8:11], s39 offen offset:2048  lds
v_mfma_f32_16x16x32_bf16 v[148:151], a[144:147], a[80:83], v[148:151]
ds_read_b64_tr_b16 a[128:129], v1 offset:32768
s_mov_b32 s38, 3339392
v_mfma_f32_16x16x32_bf16 v[148:151], a[148:151], a[84:87], v[148:151]
ds_read_b64_tr_b16 a[130:131], v1 offset:34816
v_mfma_f32_16x16x32_bf16 v[148:151], a[152:155], a[88:91], v[148:151]
ds_read_b64_tr_b16 a[132:133], v1 offset:36864
v_mfma_f32_16x16x32_bf16 v[148:151], a[156:159], a[92:95], v[148:151]
buffer_load_dwordx4 v6, s[8:11], s38 offen offset:3072  lds
v_mfma_f32_16x16x32_bf16 v[152:155], a[144:147], a[96:99], v[152:155]
ds_read_b64_tr_b16 a[134:135], v1 offset:38912
s_add_u32 m0, s37, 98304
v_mfma_f32_16x16x32_bf16 v[152:155], a[148:151], a[100:103], v[152:155]
ds_read_b64_tr_b16 a[136:137], v1 offset:40960
s_mov_b32 s39, 4194304
v_mfma_f32_16x16x32_bf16 v[152:155], a[152:155], a[104:107], v[152:155]
ds_read_b64_tr_b16 a[138:139], v1 offset:43008
v_mfma_f32_16x16x32_bf16 v[152:155], a[156:159], a[108:111], v[152:155]
ds_read_b64_tr_b16 a[140:141], v1 offset:45056
v_mfma_f32_16x16x32_bf16 v[156:159], a[144:147], a[112:115], v[156:159]
ds_read_b64_tr_b16 a[142:143], v1 offset:47104
v_mfma_f32_16x16x32_bf16 v[156:159], a[148:151], a[116:119], v[156:159]
buffer_load_dwordx4 v6, s[8:11], s39 offen offset:0  lds
v_mfma_f32_16x16x32_bf16 v[156:159], a[152:155], a[120:123], v[156:159]
s_mov_b32 s38, 4258816
v_mfma_f32_16x16x32_bf16 v[156:159], a[156:159], a[124:127], v[156:159]
s_waitcnt vmcnt(27) lgkmcnt(4)
v_mfma_f32_16x16x32_bf16 v[32:35], a[128:131], a[0:3], v[32:35]
ds_read_b64_tr_b16 a[144:145], v2 offset:32768
s_waitcnt vmcnt(26)
v_mfma_f32_16x16x32_bf16 v[32:35], a[132:135], a[4:7], v[32:35]
s_add_u32 s40, s42, 49152
s_waitcnt vmcnt(25) lgkmcnt(1)
v_mfma_f32_16x16x32_bf16 v[32:35], a[136:139], a[8:11], v[32:35]
ds_read_b64_tr_b16 a[146:147], v2 offset:34816
s_waitcnt vmcnt(24)
v_mfma_f32_16x16x32_bf16 v[32:35], a[140:143], a[12:15], v[32:35]
ds_read_b64_tr_b16 a[148:149], v2 offset:36864
s_waitcnt vmcnt(23)
v_mfma_f32_16x16x32_bf16 v[36:39], a[128:131], a[16:19], v[36:39]
s_waitcnt vmcnt(22)
v_mfma_f32_16x16x32_bf16 v[36:39], a[132:135], a[20:23], v[36:39]
ds_read_b64_tr_b16 a[150:151], v2 offset:38912
s_waitcnt vmcnt(21)
v_mfma_f32_16x16x32_bf16 v[36:39], a[136:139], a[24:27], v[36:39]
ds_read_b64_tr_b16 a[152:153], v2 offset:40960
s_waitcnt vmcnt(20)
v_mfma_f32_16x16x32_bf16 v[36:39], a[140:143], a[28:31], v[36:39]
s_waitcnt vmcnt(19)
v_mfma_f32_16x16x32_bf16 v[40:43], a[128:131], a[32:35], v[40:43]
ds_read_b64_tr_b16 a[154:155], v2 offset:43008
s_waitcnt vmcnt(18)
v_mfma_f32_16x16x32_bf16 v[40:43], a[132:135], a[36:39], v[40:43]
ds_read_b64_tr_b16 a[156:157], v2 offset:45056
s_waitcnt vmcnt(17)
v_mfma_f32_16x16x32_bf16 v[40:43], a[136:139], a[40:43], v[40:43]
s_waitcnt vmcnt(16)
v_mfma_f32_16x16x32_bf16 v[40:43], a[140:143], a[44:47], v[40:43]
ds_read_b64_tr_b16 a[158:159], v2 offset:47104
s_waitcnt vmcnt(15)
v_mfma_f32_16x16x32_bf16 v[44:47], a[128:131], a[48:51], v[44:47]
s_waitcnt vmcnt(14)
v_mfma_f32_16x16x32_bf16 v[44:47], a[132:135], a[52:55], v[44:47]
s_waitcnt vmcnt(13)
v_mfma_f32_16x16x32_bf16 v[44:47], a[136:139], a[56:59], v[44:47]
s_waitcnt vmcnt(12)
v_mfma_f32_16x16x32_bf16 v[44:47], a[140:143], a[60:63], v[44:47]
s_waitcnt lgkmcnt(0)
v_mfma_f32_16x16x32_bf16 v[48:51], a[144:147], a[0:3], v[48:51]
buffer_load_dwordx4 a[64:67], v5, s[4:7], s40 offen offset:0 sc1
v_mfma_f32_16x16x32_bf16 v[48:51], a[148:151], a[4:7], v[48:51]
ds_read_b64_tr_b16 a[128:129], v3 offset:32768
v_mfma_f32_16x16x32_bf16 v[48:51], a[152:155], a[8:11], v[48:51]
buffer_load_dwordx4 a[68:71], v5, s[4:7], s40 offen offset:1024 sc1
v_mfma_f32_16x16x32_bf16 v[48:51], a[156:159], a[12:15], v[48:51]
ds_read_b64_tr_b16 a[130:131], v3 offset:34816
v_mfma_f32_16x16x32_bf16 v[52:55], a[144:147], a[16:19], v[52:55]
ds_read_b64_tr_b16 a[132:133], v3 offset:36864
v_mfma_f32_16x16x32_bf16 v[52:55], a[148:151], a[20:23], v[52:55]
ds_read_b64_tr_b16 a[134:135], v3 offset:38912
v_mfma_f32_16x16x32_bf16 v[52:55], a[152:155], a[24:27], v[52:55]
buffer_load_dwordx4 a[72:75], v5, s[4:7], s40 offen offset:2048 sc1
v_mfma_f32_16x16x32_bf16 v[52:55], a[156:159], a[28:31], v[52:55]
ds_read_b64_tr_b16 a[136:137], v3 offset:40960
v_mfma_f32_16x16x32_bf16 v[56:59], a[144:147], a[32:35], v[56:59]
ds_read_b64_tr_b16 a[138:139], v3 offset:43008
v_mfma_f32_16x16x32_bf16 v[56:59], a[148:151], a[36:39], v[56:59]
ds_read_b64_tr_b16 a[140:141], v3 offset:45056
v_mfma_f32_16x16x32_bf16 v[56:59], a[152:155], a[40:43], v[56:59]
buffer_load_dwordx4 a[76:79], v5, s[4:7], s40 offen offset:3072 sc1
v_mfma_f32_16x16x32_bf16 v[56:59], a[156:159], a[44:47], v[56:59]
ds_read_b64_tr_b16 a[142:143], v3 offset:47104
s_add_u32 s40, s42, 53248
v_mfma_f32_16x16x32_bf16 v[60:63], a[144:147], a[48:51], v[60:63]
v_mfma_f32_16x16x32_bf16 v[60:63], a[148:151], a[52:55], v[60:63]
v_mfma_f32_16x16x32_bf16 v[60:63], a[152:155], a[56:59], v[60:63]
buffer_load_dwordx4 a[80:83], v5, s[4:7], s40 offen offset:0 sc1
v_mfma_f32_16x16x32_bf16 v[60:63], a[156:159], a[60:63], v[60:63]
s_waitcnt lgkmcnt(0)
v_mfma_f32_16x16x32_bf16 v[64:67], a[128:131], a[0:3], v[64:67]
ds_read_b64_tr_b16 a[144:145], v4 offset:32768
v_mfma_f32_16x16x32_bf16 v[64:67], a[132:135], a[4:7], v[64:67]
v_mfma_f32_16x16x32_bf16 v[64:67], a[136:139], a[8:11], v[64:67]
buffer_load_dwordx4 a[84:87], v5, s[4:7], s40 offen offset:1024 sc1
v_mfma_f32_16x16x32_bf16 v[64:67], a[140:143], a[12:15], v[64:67]
ds_read_b64_tr_b16 a[146:147], v4 offset:34816
v_mfma_f32_16x16x32_bf16 v[68:71], a[128:131], a[16:19], v[68:71]
ds_read_b64_tr_b16 a[148:149], v4 offset:36864
v_mfma_f32_16x16x32_bf16 v[68:71], a[132:135], a[20:23], v[68:71]
ds_read_b64_tr_b16 a[150:151], v4 offset:38912
v_mfma_f32_16x16x32_bf16 v[68:71], a[136:139], a[24:27], v[68:71]
buffer_load_dwordx4 a[88:91], v5, s[4:7], s40 offen offset:2048 sc1
v_mfma_f32_16x16x32_bf16 v[68:71], a[140:143], a[28:31], v[68:71]
ds_read_b64_tr_b16 a[152:153], v4 offset:40960
v_mfma_f32_16x16x32_bf16 v[72:75], a[128:131], a[32:35], v[72:75]
ds_read_b64_tr_b16 a[154:155], v4 offset:43008
v_mfma_f32_16x16x32_bf16 v[72:75], a[132:135], a[36:39], v[72:75]
ds_read_b64_tr_b16 a[156:157], v4 offset:45056
v_mfma_f32_16x16x32_bf16 v[72:75], a[136:139], a[40:43], v[72:75]
buffer_load_dwordx4 a[92:95], v5, s[4:7], s40 offen offset:3072 sc1
v_mfma_f32_16x16x32_bf16 v[72:75], a[140:143], a[44:47], v[72:75]
ds_read_b64_tr_b16 a[158:159], v4 offset:47104
s_add_u32 s40, s42, 57344
v_mfma_f32_16x16x32_bf16 v[76:79], a[128:131], a[48:51], v[76:79]
v_mfma_f32_16x16x32_bf16 v[76:79], a[132:135], a[52:55], v[76:79]
v_mfma_f32_16x16x32_bf16 v[76:79], a[136:139], a[56:59], v[76:79]
buffer_load_dwordx4 a[96:99], v5, s[4:7], s40 offen offset:0 sc1
v_mfma_f32_16x16x32_bf16 v[76:79], a[140:143], a[60:63], v[76:79]
s_waitcnt lgkmcnt(0)
v_mfma_f32_16x16x32_bf16 v[80:83], a[144:147], a[0:3], v[80:83]
v_mfma_f32_16x16x32_bf16 v[80:83], a[148:151], a[4:7], v[80:83]
v_mfma_f32_16x16x32_bf16 v[80:83], a[152:155], a[8:11], v[80:83]
buffer_load_dwordx4 a[100:103], v5, s[4:7], s40 offen offset:1024 sc1
v_mfma_f32_16x16x32_bf16 v[80:83], a[156:159], a[12:15], v[80:83]
s_waitcnt vmcnt(19)
s_barrier
v_mfma_f32_16x16x32_bf16 v[84:87], a[144:147], a[16:19], v[84:87]
ds_read_b64_tr_b16 a[128:129], v1 offset:49152
v_mfma_f32_16x16x32_bf16 v[84:87], a[148:151], a[20:23], v[84:87]
ds_read_b64_tr_b16 a[130:131], v1 offset:51200
v_mfma_f32_16x16x32_bf16 v[84:87], a[152:155], a[24:27], v[84:87]
buffer_load_dwordx4 a[104:107], v5, s[4:7], s40 offen offset:2048 sc1
v_mfma_f32_16x16x32_bf16 v[84:87], a[156:159], a[28:31], v[84:87]
ds_read_b64_tr_b16 a[132:133], v1 offset:53248
v_mfma_f32_16x16x32_bf16 v[88:91], a[144:147], a[32:35], v[88:91]
ds_read_b64_tr_b16 a[134:135], v1 offset:55296
v_mfma_f32_16x16x32_bf16 v[88:91], a[148:151], a[36:39], v[88:91]
ds_read_b64_tr_b16 a[136:137], v1 offset:57344
v_mfma_f32_16x16x32_bf16 v[88:91], a[152:155], a[40:43], v[88:91]
ds_read_b64_tr_b16 a[138:139], v1 offset:59392
v_mfma_f32_16x16x32_bf16 v[88:91], a[156:159], a[44:47], v[88:91]
ds_read_b64_tr_b16 a[140:141], v1 offset:61440
v_mfma_f32_16x16x32_bf16 v[92:95], a[144:147], a[48:51], v[92:95]
ds_read_b64_tr_b16 a[142:143], v1 offset:63488
v_mfma_f32_16x16x32_bf16 v[92:95], a[148:151], a[52:55], v[92:95]
buffer_load_dwordx4 a[108:111], v5, s[4:7], s40 offen offset:3072 sc1
v_mfma_f32_16x16x32_bf16 v[92:95], a[152:155], a[56:59], v[92:95]
s_add_u32 s40, s42, 61440
v_mfma_f32_16x16x32_bf16 v[92:95], a[156:159], a[60:63], v[92:95]
s_waitcnt lgkmcnt(4)
v_mfma_f32_16x16x32_bf16 v[96:99], a[128:131], a[0:3], v[96:99]
buffer_load_dwordx4 a[112:115], v5, s[4:7], s40 offen offset:0 sc1
v_mfma_f32_16x16x32_bf16 v[96:99], a[132:135], a[4:7], v[96:99]
ds_read_b64_tr_b16 a[144:145], v2 offset:49152
s_waitcnt lgkmcnt(1)
v_mfma_f32_16x16x32_bf16 v[96:99], a[136:139], a[8:11], v[96:99]
ds_read_b64_tr_b16 a[146:147], v2 offset:51200
v_mfma_f32_16x16x32_bf16 v[96:99], a[140:143], a[12:15], v[96:99]
buffer_load_dwordx4 a[116:119], v5, s[4:7], s40 offen offset:1024 sc1
v_mfma_f32_16x16x32_bf16 v[100:103], a[128:131], a[16:19], v[100:103]
ds_read_b64_tr_b16 a[148:149], v2 offset:53248
v_mfma_f32_16x16x32_bf16 v[100:103], a[132:135], a[20:23], v[100:103]
ds_read_b64_tr_b16 a[150:151], v2 offset:55296
v_mfma_f32_16x16x32_bf16 v[100:103], a[136:139], a[24:27], v[100:103]
ds_read_b64_tr_b16 a[152:153], v2 offset:57344
v_mfma_f32_16x16x32_bf16 v[100:103], a[140:143], a[28:31], v[100:103]
buffer_load_dwordx4 a[120:123], v5, s[4:7], s40 offen offset:2048 sc1
v_mfma_f32_16x16x32_bf16 v[104:107], a[128:131], a[32:35], v[104:107]
ds_read_b64_tr_b16 a[154:155], v2 offset:59392
v_mfma_f32_16x16x32_bf16 v[104:107], a[132:135], a[36:39], v[104:107]
ds_read_b64_tr_b16 a[156:157], v2 offset:61440
v_mfma_f32_16x16x32_bf16 v[104:107], a[136:139], a[40:43], v[104:107]
v_mfma_f32_16x16x32_bf16 v[104:107], a[140:143], a[44:47], v[104:107]
buffer_load_dwordx4 a[124:127], v5, s[4:7], s40 offen offset:3072 sc1
v_mfma_f32_16x16x32_bf16 v[108:111], a[128:131], a[48:51], v[108:111]
ds_read_b64_tr_b16 a[158:159], v2 offset:63488
v_mfma_f32_16x16x32_bf16 v[108:111], a[132:135], a[52:55], v[108:111]
v_mfma_f32_16x16x32_bf16 v[108:111], a[136:139], a[56:59], v[108:111]
v_mfma_f32_16x16x32_bf16 v[108:111], a[140:143], a[60:63], v[108:111]
s_waitcnt lgkmcnt(0)
v_mfma_f32_16x16x32_bf16 v[112:115], a[144:147], a[0:3], v[112:115]
buffer_load_dwordx4 v6, s[8:11], s38 offen offset:1024  lds
v_mfma_f32_16x16x32_bf16 v[112:115], a[148:151], a[4:7], v[112:115]
ds_read_b64_tr_b16 a[128:129], v3 offset:49152
s_mov_b32 s39, 4323328
v_mfma_f32_16x16x32_bf16 v[112:115], a[152:155], a[8:11], v[112:115]
ds_read_b64_tr_b16 a[130:131], v3 offset:51200
v_mfma_f32_16x16x32_bf16 v[112:115], a[156:159], a[12:15], v[112:115]
buffer_load_dwordx4 v6, s[8:11], s39 offen offset:2048  lds
v_mfma_f32_16x16x32_bf16 v[116:119], a[144:147], a[16:19], v[116:119]
ds_read_b64_tr_b16 a[132:133], v3 offset:53248
s_mov_b32 s38, 4387840
v_mfma_f32_16x16x32_bf16 v[116:119], a[148:151], a[20:23], v[116:119]
ds_read_b64_tr_b16 a[134:135], v3 offset:55296
v_mfma_f32_16x16x32_bf16 v[116:119], a[152:155], a[24:27], v[116:119]
ds_read_b64_tr_b16 a[136:137], v3 offset:57344
v_mfma_f32_16x16x32_bf16 v[116:119], a[156:159], a[28:31], v[116:119]
buffer_load_dwordx4 v6, s[8:11], s38 offen offset:3072  lds
v_mfma_f32_16x16x32_bf16 v[120:123], a[144:147], a[32:35], v[120:123]
ds_read_b64_tr_b16 a[138:139], v3 offset:59392
s_add_u32 m0, s37, 114688
v_mfma_f32_16x16x32_bf16 v[120:123], a[148:151], a[36:39], v[120:123]
ds_read_b64_tr_b16 a[140:141], v3 offset:61440
s_mov_b32 s39, 4194432
v_mfma_f32_16x16x32_bf16 v[120:123], a[152:155], a[40:43], v[120:123]
v_mfma_f32_16x16x32_bf16 v[120:123], a[156:159], a[44:47], v[120:123]
buffer_load_dwordx4 v6, s[8:11], s39 offen offset:0  lds
v_mfma_f32_16x16x32_bf16 v[124:127], a[144:147], a[48:51], v[124:127]
ds_read_b64_tr_b16 a[142:143], v3 offset:63488
s_mov_b32 s38, 4258944
v_mfma_f32_16x16x32_bf16 v[124:127], a[148:151], a[52:55], v[124:127]
v_mfma_f32_16x16x32_bf16 v[124:127], a[152:155], a[56:59], v[124:127]
v_mfma_f32_16x16x32_bf16 v[124:127], a[156:159], a[60:63], v[124:127]
s_waitcnt lgkmcnt(0)
v_mfma_f32_16x16x32_bf16 v[128:131], a[128:131], a[0:3], v[128:131]
buffer_load_dwordx4 v6, s[8:11], s38 offen offset:1024  lds
v_mfma_f32_16x16x32_bf16 v[128:131], a[132:135], a[4:7], v[128:131]
ds_read_b64_tr_b16 a[144:145], v4 offset:49152
s_mov_b32 s39, 4323456
v_mfma_f32_16x16x32_bf16 v[128:131], a[136:139], a[8:11], v[128:131]
ds_read_b64_tr_b16 a[146:147], v4 offset:51200
v_mfma_f32_16x16x32_bf16 v[128:131], a[140:143], a[12:15], v[128:131]
buffer_load_dwordx4 v6, s[8:11], s39 offen offset:2048  lds
v_mfma_f32_16x16x32_bf16 v[132:135], a[128:131], a[16:19], v[132:135]
ds_read_b64_tr_b16 a[148:149], v4 offset:53248
s_mov_b32 s38, 4387968
v_mfma_f32_16x16x32_bf16 v[132:135], a[132:135], a[20:23], v[132:135]
ds_read_b64_tr_b16 a[150:151], v4 offset:55296
v_mfma_f32_16x16x32_bf16 v[132:135], a[136:139], a[24:27], v[132:135]
ds_read_b64_tr_b16 a[152:153], v4 offset:57344
v_mfma_f32_16x16x32_bf16 v[132:135], a[140:143], a[28:31], v[132:135]
buffer_load_dwordx4 v6, s[8:11], s38 offen offset:3072  lds
v_mfma_f32_16x16x32_bf16 v[136:139], a[128:131], a[32:35], v[136:139]
ds_read_b64_tr_b16 a[154:155], v4 offset:59392
s_add_u32 m0, s37, 0
v_mfma_f32_16x16x32_bf16 v[136:139], a[132:135], a[36:39], v[136:139]
ds_read_b64_tr_b16 a[156:157], v4 offset:61440
s_mov_b32 s39, 0
v_mfma_f32_16x16x32_bf16 v[136:139], a[136:139], a[40:43], v[136:139]
v_mfma_f32_16x16x32_bf16 v[136:139], a[140:143], a[44:47], v[136:139]
buffer_load_dwordx4 v9, s[20:23], s39 offen offset:0  lds
v_mfma_f32_16x16x32_bf16 v[140:143], a[128:131], a[48:51], v[140:143]
ds_read_b64_tr_b16 a[158:159], v4 offset:63488
v_mfma_f32_16x16x32_bf16 v[140:143], a[132:135], a[52:55], v[140:143]
v_mfma_f32_16x16x32_bf16 v[140:143], a[136:139], a[56:59], v[140:143]
v_mfma_f32_16x16x32_bf16 v[140:143], a[140:143], a[60:63], v[140:143]
s_waitcnt lgkmcnt(0)
v_mfma_f32_16x16x32_bf16 v[144:147], a[144:147], a[0:3], v[144:147]
buffer_load_dwordx4 v10, s[20:23], s39 offen offset:1024  lds
v_mfma_f32_16x16x32_bf16 v[144:147], a[148:151], a[4:7], v[144:147]
v_xor_b32 v1, 0x10000, v1
v_xor_b32 v2, 0x10000, v2
v_mfma_f32_16x16x32_bf16 v[144:147], a[152:155], a[8:11], v[144:147]
v_xor_b32 v3, 0x10000, v3
v_xor_b32 v4, 0x10000, v4
v_mfma_f32_16x16x32_bf16 v[144:147], a[156:159], a[12:15], v[144:147]
buffer_load_dwordx4 v11, s[20:23], s39 offen offset:2048  lds
v_mfma_f32_16x16x32_bf16 v[148:151], a[144:147], a[16:19], v[148:151]
s_waitcnt vmcnt(31)
s_barrier
v_mfma_f32_16x16x32_bf16 v[148:151], a[148:151], a[20:23], v[148:151]
ds_read_b64_tr_b16 a[128:129], v1 offset:0
v_mfma_f32_16x16x32_bf16 v[148:151], a[152:155], a[24:27], v[148:151]
ds_read_b64_tr_b16 a[130:131], v1 offset:2048
v_mfma_f32_16x16x32_bf16 v[148:151], a[156:159], a[28:31], v[148:151]
ds_read_b64_tr_b16 a[132:133], v1 offset:4096
v_mfma_f32_16x16x32_bf16 v[152:155], a[144:147], a[32:35], v[152:155]
ds_read_b64_tr_b16 a[134:135], v1 offset:6144
v_mfma_f32_16x16x32_bf16 v[152:155], a[148:151], a[36:39], v[152:155]
ds_read_b64_tr_b16 a[136:137], v1 offset:8192
v_mfma_f32_16x16x32_bf16 v[152:155], a[152:155], a[40:43], v[152:155]
ds_read_b64_tr_b16 a[138:139], v1 offset:10240
v_mfma_f32_16x16x32_bf16 v[152:155], a[156:159], a[44:47], v[152:155]
ds_read_b64_tr_b16 a[140:141], v1 offset:12288
v_mfma_f32_16x16x32_bf16 v[156:159], a[144:147], a[48:51], v[156:159]
ds_read_b64_tr_b16 a[142:143], v1 offset:14336
v_mfma_f32_16x16x32_bf16 v[156:159], a[148:151], a[52:55], v[156:159]
buffer_load_dwordx4 v12, s[20:23], s39 offen offset:3072  lds
v_mfma_f32_16x16x32_bf16 v[156:159], a[152:155], a[56:59], v[156:159]
s_add_u32 m0, s37, 16384
s_mov_b32 s38, 0
v_mfma_f32_16x16x32_bf16 v[156:159], a[156:159], a[60:63], v[156:159]
s_waitcnt vmcnt(26) lgkmcnt(4)
v_mfma_f32_16x16x32_bf16 v[32:35], a[128:131], a[64:67], v[32:35]
ds_read_b64_tr_b16 a[144:145], v2 offset:0
s_waitcnt vmcnt(25)
v_mfma_f32_16x16x32_bf16 v[32:35], a[132:135], a[68:71], v[32:35]
s_add_u32 s40, s42, 65536
s_waitcnt vmcnt(24) lgkmcnt(1)
v_mfma_f32_16x16x32_bf16 v[32:35], a[136:139], a[72:75], v[32:35]
ds_read_b64_tr_b16 a[146:147], v2 offset:2048
s_waitcnt vmcnt(23)
v_mfma_f32_16x16x32_bf16 v[32:35], a[140:143], a[76:79], v[32:35]
ds_read_b64_tr_b16 a[148:149], v2 offset:4096
s_waitcnt vmcnt(22)
v_mfma_f32_16x16x32_bf16 v[36:39], a[128:131], a[80:83], v[36:39]
s_waitcnt vmcnt(21)
v_mfma_f32_16x16x32_bf16 v[36:39], a[132:135], a[84:87], v[36:39]
ds_read_b64_tr_b16 a[150:151], v2 offset:6144
s_waitcnt vmcnt(20)
v_mfma_f32_16x16x32_bf16 v[36:39], a[136:139], a[88:91], v[36:39]
ds_read_b64_tr_b16 a[152:153], v2 offset:8192
s_waitcnt vmcnt(19)
v_mfma_f32_16x16x32_bf16 v[36:39], a[140:143], a[92:95], v[36:39]
s_waitcnt vmcnt(18)
v_mfma_f32_16x16x32_bf16 v[40:43], a[128:131], a[96:99], v[40:43]
ds_read_b64_tr_b16 a[154:155], v2 offset:10240
s_waitcnt vmcnt(17)
v_mfma_f32_16x16x32_bf16 v[40:43], a[132:135], a[100:103], v[40:43]
ds_read_b64_tr_b16 a[156:157], v2 offset:12288
s_waitcnt vmcnt(16)
v_mfma_f32_16x16x32_bf16 v[40:43], a[136:139], a[104:107], v[40:43]
s_waitcnt vmcnt(15)
v_mfma_f32_16x16x32_bf16 v[40:43], a[140:143], a[108:111], v[40:43]
ds_read_b64_tr_b16 a[158:159], v2 offset:14336
s_waitcnt vmcnt(14)
v_mfma_f32_16x16x32_bf16 v[44:47], a[128:131], a[112:115], v[44:47]
s_waitcnt vmcnt(13)
v_mfma_f32_16x16x32_bf16 v[44:47], a[132:135], a[116:119], v[44:47]
s_waitcnt vmcnt(12)
v_mfma_f32_16x16x32_bf16 v[44:47], a[136:139], a[120:123], v[44:47]
s_waitcnt vmcnt(11)
v_mfma_f32_16x16x32_bf16 v[44:47], a[140:143], a[124:127], v[44:47]
s_waitcnt lgkmcnt(0)
v_mfma_f32_16x16x32_bf16 v[48:51], a[144:147], a[64:67], v[48:51]
buffer_load_dwordx4 a[0:3], v5, s[4:7], s40 offen offset:0 sc1
v_mfma_f32_16x16x32_bf16 v[48:51], a[148:151], a[68:71], v[48:51]
ds_read_b64_tr_b16 a[128:129], v3 offset:0
v_mfma_f32_16x16x32_bf16 v[48:51], a[152:155], a[72:75], v[48:51]
buffer_load_dwordx4 a[4:7], v5, s[4:7], s40 offen offset:1024 sc1
v_mfma_f32_16x16x32_bf16 v[48:51], a[156:159], a[76:79], v[48:51]
ds_read_b64_tr_b16 a[130:131], v3 offset:2048
v_mfma_f32_16x16x32_bf16 v[52:55], a[144:147], a[80:83], v[52:55]
ds_read_b64_tr_b16 a[132:133], v3 offset:4096
v_mfma_f32_16x16x32_bf16 v[52:55], a[148:151], a[84:87], v[52:55]
ds_read_b64_tr_b16 a[134:135], v3 offset:6144
v_mfma_f32_16x16x32_bf16 v[52:55], a[152:155], a[88:91], v[52:55]
buffer_load_dwordx4 a[8:11], v5, s[4:7], s40 offen offset:2048 sc1
v_mfma_f32_16x16x32_bf16 v[52:55], a[156:159], a[92:95], v[52:55]
ds_read_b64_tr_b16 a[136:137], v3 offset:8192
v_mfma_f32_16x16x32_bf16 v[56:59], a[144:147], a[96:99], v[56:59]
ds_read_b64_tr_b16 a[138:139], v3 offset:10240
v_mfma_f32_16x16x32_bf16 v[56:59], a[148:151], a[100:103], v[56:59]
ds_read_b64_tr_b16 a[140:141], v3 offset:12288
v_mfma_f32_16x16x32_bf16 v[56:59], a[152:155], a[104:107], v[56:59]
buffer_load_dwordx4 a[12:15], v5, s[4:7], s40 offen offset:3072 sc1
v_mfma_f32_16x16x32_bf16 v[56:59], a[156:159], a[108:111], v[56:59]
ds_read_b64_tr_b16 a[142:143], v3 offset:14336
s_add_u32 s40, s42, 69632
v_mfma_f32_16x16x32_bf16 v[60:63], a[144:147], a[112:115], v[60:63]
v_mfma_f32_16x16x32_bf16 v[60:63], a[148:151], a[116:119], v[60:63]
v_mfma_f32_16x16x32_bf16 v[60:63], a[152:155], a[120:123], v[60:63]
buffer_load_dwordx4 a[16:19], v5, s[4:7], s40 offen offset:0 sc1
v_mfma_f32_16x16x32_bf16 v[60:63], a[156:159], a[124:127], v[60:63]
s_waitcnt lgkmcnt(0)
v_mfma_f32_16x16x32_bf16 v[64:67], a[128:131], a[64:67], v[64:67]
ds_read_b64_tr_b16 a[144:145], v4 offset:0
v_mfma_f32_16x16x32_bf16 v[64:67], a[132:135], a[68:71], v[64:67]
v_mfma_f32_16x16x32_bf16 v[64:67], a[136:139], a[72:75], v[64:67]
buffer_load_dwordx4 a[20:23], v5, s[4:7], s40 offen offset:1024 sc1
v_mfma_f32_16x16x32_bf16 v[64:67], a[140:143], a[76:79], v[64:67]
ds_read_b64_tr_b16 a[146:147], v4 offset:2048
v_mfma_f32_16x16x32_bf16 v[68:71], a[128:131], a[80:83], v[68:71]
ds_read_b64_tr_b16 a[148:149], v4 offset:4096
v_mfma_f32_16x16x32_bf16 v[68:71], a[132:135], a[84:87], v[68:71]
ds_read_b64_tr_b16 a[150:151], v4 offset:6144
v_mfma_f32_16x16x32_bf16 v[68:71], a[136:139], a[88:91], v[68:71]
buffer_load_dwordx4 a[24:27], v5, s[4:7], s40 offen offset:2048 sc1
v_mfma_f32_16x16x32_bf16 v[68:71], a[140:143], a[92:95], v[68:71]
ds_read_b64_tr_b16 a[152:153], v4 offset:8192
v_mfma_f32_16x16x32_bf16 v[72:75], a[128:131], a[96:99], v[72:75]
ds_read_b64_tr_b16 a[154:155], v4 offset:10240
v_mfma_f32_16x16x32_bf16 v[72:75], a[132:135], a[100:103], v[72:75]
ds_read_b64_tr_b16 a[156:157], v4 offset:12288
v_mfma_f32_16x16x32_bf16 v[72:75], a[136:139], a[104:107], v[72:75]
buffer_load_dwordx4 a[28:31], v5, s[4:7], s40 offen offset:3072 sc1
v_mfma_f32_16x16x32_bf16 v[72:75], a[140:143], a[108:111], v[72:75]
ds_read_b64_tr_b16 a[158:159], v4 offset:14336
s_add_u32 s40, s42, 73728
v_mfma_f32_16x16x32_bf16 v[76:79], a[128:131], a[112:115], v[76:79]
v_mfma_f32_16x16x32_bf16 v[76:79], a[132:135], a[116:119], v[76:79]
v_mfma_f32_16x16x32_bf16 v[76:79], a[136:139], a[120:123], v[76:79]
buffer_load_dwordx4 a[32:35], v5, s[4:7], s40 offen offset:0 sc1
v_mfma_f32_16x16x32_bf16 v[76:79], a[140:143], a[124:127], v[76:79]
s_waitcnt lgkmcnt(0)
v_mfma_f32_16x16x32_bf16 v[80:83], a[144:147], a[64:67], v[80:83]
v_mfma_f32_16x16x32_bf16 v[80:83], a[148:151], a[68:71], v[80:83]
v_mfma_f32_16x16x32_bf16 v[80:83], a[152:155], a[72:75], v[80:83]
buffer_load_dwordx4 a[36:39], v5, s[4:7], s40 offen offset:1024 sc1
v_mfma_f32_16x16x32_bf16 v[80:83], a[156:159], a[76:79], v[80:83]
s_barrier
v_mfma_f32_16x16x32_bf16 v[84:87], a[144:147], a[80:83], v[84:87]
ds_read_b64_tr_b16 a[128:129], v1 offset:16384
v_mfma_f32_16x16x32_bf16 v[84:87], a[148:151], a[84:87], v[84:87]
ds_read_b64_tr_b16 a[130:131], v1 offset:18432
v_mfma_f32_16x16x32_bf16 v[84:87], a[152:155], a[88:91], v[84:87]
buffer_load_dwordx4 a[40:43], v5, s[4:7], s40 offen offset:2048 sc1
v_mfma_f32_16x16x32_bf16 v[84:87], a[156:159], a[92:95], v[84:87]
ds_read_b64_tr_b16 a[132:133], v1 offset:20480
v_mfma_f32_16x16x32_bf16 v[88:91], a[144:147], a[96:99], v[88:91]
ds_read_b64_tr_b16 a[134:135], v1 offset:22528
v_mfma_f32_16x16x32_bf16 v[88:91], a[148:151], a[100:103], v[88:91]
ds_read_b64_tr_b16 a[136:137], v1 offset:24576
v_mfma_f32_16x16x32_bf16 v[88:91], a[152:155], a[104:107], v[88:91]
ds_read_b64_tr_b16 a[138:139], v1 offset:26624
v_mfma_f32_16x16x32_bf16 v[88:91], a[156:159], a[108:111], v[88:91]
ds_read_b64_tr_b16 a[140:141], v1 offset:28672
v_mfma_f32_16x16x32_bf16 v[92:95], a[144:147], a[112:115], v[92:95]
ds_read_b64_tr_b16 a[142:143], v1 offset:30720
v_mfma_f32_16x16x32_bf16 v[92:95], a[148:151], a[116:119], v[92:95]
buffer_load_dwordx4 a[44:47], v5, s[4:7], s40 offen offset:3072 sc1
v_mfma_f32_16x16x32_bf16 v[92:95], a[152:155], a[120:123], v[92:95]
s_add_u32 s40, s42, 77824
v_mfma_f32_16x16x32_bf16 v[92:95], a[156:159], a[124:127], v[92:95]
s_waitcnt lgkmcnt(4)
v_mfma_f32_16x16x32_bf16 v[96:99], a[128:131], a[64:67], v[96:99]
buffer_load_dwordx4 a[48:51], v5, s[4:7], s40 offen offset:0 sc1
v_mfma_f32_16x16x32_bf16 v[96:99], a[132:135], a[68:71], v[96:99]
ds_read_b64_tr_b16 a[144:145], v2 offset:16384
s_waitcnt lgkmcnt(1)
v_mfma_f32_16x16x32_bf16 v[96:99], a[136:139], a[72:75], v[96:99]
ds_read_b64_tr_b16 a[146:147], v2 offset:18432
v_mfma_f32_16x16x32_bf16 v[96:99], a[140:143], a[76:79], v[96:99]
buffer_load_dwordx4 a[52:55], v5, s[4:7], s40 offen offset:1024 sc1
v_mfma_f32_16x16x32_bf16 v[100:103], a[128:131], a[80:83], v[100:103]
ds_read_b64_tr_b16 a[148:149], v2 offset:20480
v_mfma_f32_16x16x32_bf16 v[100:103], a[132:135], a[84:87], v[100:103]
ds_read_b64_tr_b16 a[150:151], v2 offset:22528
v_mfma_f32_16x16x32_bf16 v[100:103], a[136:139], a[88:91], v[100:103]
ds_read_b64_tr_b16 a[152:153], v2 offset:24576
v_mfma_f32_16x16x32_bf16 v[100:103], a[140:143], a[92:95], v[100:103]
buffer_load_dwordx4 a[56:59], v5, s[4:7], s40 offen offset:2048 sc1
v_mfma_f32_16x16x32_bf16 v[104:107], a[128:131], a[96:99], v[104:107]
ds_read_b64_tr_b16 a[154:155], v2 offset:26624
v_mfma_f32_16x16x32_bf16 v[104:107], a[132:135], a[100:103], v[104:107]
ds_read_b64_tr_b16 a[156:157], v2 offset:28672
v_mfma_f32_16x16x32_bf16 v[104:107], a[136:139], a[104:107], v[104:107]
v_mfma_f32_16x16x32_bf16 v[104:107], a[140:143], a[108:111], v[104:107]
buffer_load_dwordx4 a[60:63], v5, s[4:7], s40 offen offset:3072 sc1
v_mfma_f32_16x16x32_bf16 v[108:111], a[128:131], a[112:115], v[108:111]
ds_read_b64_tr_b16 a[158:159], v2 offset:30720
v_mfma_f32_16x16x32_bf16 v[108:111], a[132:135], a[116:119], v[108:111]
v_mfma_f32_16x16x32_bf16 v[108:111], a[136:139], a[120:123], v[108:111]
v_mfma_f32_16x16x32_bf16 v[108:111], a[140:143], a[124:127], v[108:111]
s_waitcnt lgkmcnt(0)
v_mfma_f32_16x16x32_bf16 v[112:115], a[144:147], a[64:67], v[112:115]
buffer_load_dwordx4 v13, s[24:27], s38 offen offset:0  lds
v_mfma_f32_16x16x32_bf16 v[112:115], a[148:151], a[68:71], v[112:115]
ds_read_b64_tr_b16 a[128:129], v3 offset:16384
v_mfma_f32_16x16x32_bf16 v[112:115], a[152:155], a[72:75], v[112:115]
ds_read_b64_tr_b16 a[130:131], v3 offset:18432
v_mfma_f32_16x16x32_bf16 v[112:115], a[156:159], a[76:79], v[112:115]
buffer_load_dwordx4 v13, s[24:27], s38 offen offset:1024  lds
v_mfma_f32_16x16x32_bf16 v[116:119], a[144:147], a[80:83], v[116:119]
ds_read_b64_tr_b16 a[132:133], v3 offset:20480
v_mfma_f32_16x16x32_bf16 v[116:119], a[148:151], a[84:87], v[116:119]
ds_read_b64_tr_b16 a[134:135], v3 offset:22528
v_mfma_f32_16x16x32_bf16 v[116:119], a[152:155], a[88:91], v[116:119]
ds_read_b64_tr_b16 a[136:137], v3 offset:24576
v_mfma_f32_16x16x32_bf16 v[116:119], a[156:159], a[92:95], v[116:119]
buffer_load_dwordx4 v13, s[24:27], s38 offen offset:2048  lds
v_mfma_f32_16x16x32_bf16 v[120:123], a[144:147], a[96:99], v[120:123]
ds_read_b64_tr_b16 a[138:139], v3 offset:26624
v_mfma_f32_16x16x32_bf16 v[120:123], a[148:151], a[100:103], v[120:123]
ds_read_b64_tr_b16 a[140:141], v3 offset:28672
v_mfma_f32_16x16x32_bf16 v[120:123], a[152:155], a[104:107], v[120:123]
v_mfma_f32_16x16x32_bf16 v[120:123], a[156:159], a[108:111], v[120:123]
buffer_load_dwordx4 v13, s[24:27], s38 offen offset:3072  lds
v_mfma_f32_16x16x32_bf16 v[124:127], a[144:147], a[112:115], v[124:127]
ds_read_b64_tr_b16 a[142:143], v3 offset:30720
s_add_u32 m0, s37, 32768
v_mfma_f32_16x16x32_bf16 v[124:127], a[148:151], a[116:119], v[124:127]
s_mov_b32 s39, 16384
v_mfma_f32_16x16x32_bf16 v[124:127], a[152:155], a[120:123], v[124:127]
v_mfma_f32_16x16x32_bf16 v[124:127], a[156:159], a[124:127], v[124:127]
s_waitcnt lgkmcnt(0)
v_mfma_f32_16x16x32_bf16 v[128:131], a[128:131], a[64:67], v[128:131]
buffer_load_dwordx4 v9, s[20:23], s39 offen offset:0  lds
v_mfma_f32_16x16x32_bf16 v[128:131], a[132:135], a[68:71], v[128:131]
ds_read_b64_tr_b16 a[144:145], v4 offset:16384
v_mfma_f32_16x16x32_bf16 v[128:131], a[136:139], a[72:75], v[128:131]
ds_read_b64_tr_b16 a[146:147], v4 offset:18432
v_mfma_f32_16x16x32_bf16 v[128:131], a[140:143], a[76:79], v[128:131]
buffer_load_dwordx4 v10, s[20:23], s39 offen offset:1024  lds
v_mfma_f32_16x16x32_bf16 v[132:135], a[128:131], a[80:83], v[132:135]
ds_read_b64_tr_b16 a[148:149], v4 offset:20480
v_mfma_f32_16x16x32_bf16 v[132:135], a[132:135], a[84:87], v[132:135]
ds_read_b64_tr_b16 a[150:151], v4 offset:22528
v_mfma_f32_16x16x32_bf16 v[132:135], a[136:139], a[88:91], v[132:135]
ds_read_b64_tr_b16 a[152:153], v4 offset:24576
v_mfma_f32_16x16x32_bf16 v[132:135], a[140:143], a[92:95], v[132:135]
buffer_load_dwordx4 v11, s[20:23], s39 offen offset:2048  lds
v_mfma_f32_16x16x32_bf16 v[136:139], a[128:131], a[96:99], v[136:139]
ds_read_b64_tr_b16 a[154:155], v4 offset:26624
v_mfma_f32_16x16x32_bf16 v[136:139], a[132:135], a[100:103], v[136:139]
ds_read_b64_tr_b16 a[156:157], v4 offset:28672
v_mfma_f32_16x16x32_bf16 v[136:139], a[136:139], a[104:107], v[136:139]
v_mfma_f32_16x16x32_bf16 v[136:139], a[140:143], a[108:111], v[136:139]
buffer_load_dwordx4 v12, s[20:23], s39 offen offset:3072  lds
v_mfma_f32_16x16x32_bf16 v[140:143], a[128:131], a[112:115], v[140:143]
ds_read_b64_tr_b16 a[158:159], v4 offset:30720
s_add_u32 m0, s37, 49152
v_mfma_f32_16x16x32_bf16 v[140:143], a[132:135], a[116:119], v[140:143]
s_mov_b32 s38, 16384
v_mfma_f32_16x16x32_bf16 v[140:143], a[136:139], a[120:123], v[140:143]
v_mfma_f32_16x16x32_bf16 v[140:143], a[140:143], a[124:127], v[140:143]
s_waitcnt lgkmcnt(0)
v_mfma_f32_16x16x32_bf16 v[144:147], a[144:147], a[64:67], v[144:147]
buffer_load_dwordx4 v13, s[24:27], s38 offen offset:0  lds
v_mfma_f32_16x16x32_bf16 v[144:147], a[148:151], a[68:71], v[144:147]
v_mfma_f32_16x16x32_bf16 v[144:147], a[152:155], a[72:75], v[144:147]
s_waitcnt vmcnt(33)
s_barrier
v_mfma_f32_16x16x32_bf16 v[144:147], a[156:159], a[76:79], v[144:147]
buffer_load_dwordx4 v13, s[24:27], s38 offen offset:1024  lds
v_mfma_f32_16x16x32_bf16 v[148:151], a[144:147], a[80:83], v[148:151]
ds_read_b64_tr_b16 a[128:129], v1 offset:32768
v_mfma_f32_16x16x32_bf16 v[148:151], a[148:151], a[84:87], v[148:151]
ds_read_b64_tr_b16 a[130:131], v1 offset:34816
v_mfma_f32_16x16x32_bf16 v[148:151], a[152:155], a[88:91], v[148:151]
ds_read_b64_tr_b16 a[132:133], v1 offset:36864
v_mfma_f32_16x16x32_bf16 v[148:151], a[156:159], a[92:95], v[148:151]
buffer_load_dwordx4 v13, s[24:27], s38 offen offset:2048  lds
v_mfma_f32_16x16x32_bf16 v[152:155], a[144:147], a[96:99], v[152:155]
ds_read_b64_tr_b16 a[134:135], v1 offset:38912
v_mfma_f32_16x16x32_bf16 v[152:155], a[148:151], a[100:103], v[152:155]
ds_read_b64_tr_b16 a[136:137], v1 offset:40960
v_mfma_f32_16x16x32_bf16 v[152:155], a[152:155], a[104:107], v[152:155]
ds_read_b64_tr_b16 a[138:139], v1 offset:43008
v_mfma_f32_16x16x32_bf16 v[152:155], a[156:159], a[108:111], v[152:155]
ds_read_b64_tr_b16 a[140:141], v1 offset:45056
v_mfma_f32_16x16x32_bf16 v[156:159], a[144:147], a[112:115], v[156:159]
ds_read_b64_tr_b16 a[142:143], v1 offset:47104
v_mfma_f32_16x16x32_bf16 v[156:159], a[148:151], a[116:119], v[156:159]
buffer_load_dwordx4 v13, s[24:27], s38 offen offset:3072  lds
v_mfma_f32_16x16x32_bf16 v[156:159], a[152:155], a[120:123], v[156:159]
s_add_u32 m0, s37, 65536
s_mov_b32 s39, 32768
v_mfma_f32_16x16x32_bf16 v[156:159], a[156:159], a[124:127], v[156:159]
s_waitcnt vmcnt(27) lgkmcnt(4)
v_mfma_f32_16x16x32_bf16 v[32:35], a[128:131], a[0:3], v[32:35]
ds_read_b64_tr_b16 a[144:145], v2 offset:32768
s_waitcnt vmcnt(26)
v_mfma_f32_16x16x32_bf16 v[32:35], a[132:135], a[4:7], v[32:35]
s_waitcnt vmcnt(25) lgkmcnt(1)
v_mfma_f32_16x16x32_bf16 v[32:35], a[136:139], a[8:11], v[32:35]
ds_read_b64_tr_b16 a[146:147], v2 offset:34816
s_waitcnt vmcnt(24)
v_mfma_f32_16x16x32_bf16 v[32:35], a[140:143], a[12:15], v[32:35]
ds_read_b64_tr_b16 a[148:149], v2 offset:36864
s_waitcnt vmcnt(23)
v_mfma_f32_16x16x32_bf16 v[36:39], a[128:131], a[16:19], v[36:39]
s_waitcnt vmcnt(22)
v_mfma_f32_16x16x32_bf16 v[36:39], a[132:135], a[20:23], v[36:39]
ds_read_b64_tr_b16 a[150:151], v2 offset:38912
s_waitcnt vmcnt(21)
v_mfma_f32_16x16x32_bf16 v[36:39], a[136:139], a[24:27], v[36:39]
ds_read_b64_tr_b16 a[152:153], v2 offset:40960
s_waitcnt vmcnt(20)
v_mfma_f32_16x16x32_bf16 v[36:39], a[140:143], a[28:31], v[36:39]
s_waitcnt vmcnt(19)
v_mfma_f32_16x16x32_bf16 v[40:43], a[128:131], a[32:35], v[40:43]
ds_read_b64_tr_b16 a[154:155], v2 offset:43008
s_waitcnt vmcnt(18)
v_mfma_f32_16x16x32_bf16 v[40:43], a[132:135], a[36:39], v[40:43]
ds_read_b64_tr_b16 a[156:157], v2 offset:45056
s_waitcnt vmcnt(17)
v_mfma_f32_16x16x32_bf16 v[40:43], a[136:139], a[40:43], v[40:43]
s_waitcnt vmcnt(16)
v_mfma_f32_16x16x32_bf16 v[40:43], a[140:143], a[44:47], v[40:43]
ds_read_b64_tr_b16 a[158:159], v2 offset:47104
s_waitcnt vmcnt(15)
v_mfma_f32_16x16x32_bf16 v[44:47], a[128:131], a[48:51], v[44:47]
s_waitcnt vmcnt(14)
v_mfma_f32_16x16x32_bf16 v[44:47], a[132:135], a[52:55], v[44:47]
s_waitcnt vmcnt(13)
v_mfma_f32_16x16x32_bf16 v[44:47], a[136:139], a[56:59], v[44:47]
s_waitcnt vmcnt(12)
v_mfma_f32_16x16x32_bf16 v[44:47], a[140:143], a[60:63], v[44:47]
s_waitcnt lgkmcnt(0)
v_mfma_f32_16x16x32_bf16 v[48:51], a[144:147], a[0:3], v[48:51]
buffer_load_dwordx4 v9, s[20:23], s39 offen offset:0  lds
v_mfma_f32_16x16x32_bf16 v[48:51], a[148:151], a[4:7], v[48:51]
ds_read_b64_tr_b16 a[128:129], v3 offset:32768
v_mfma_f32_16x16x32_bf16 v[48:51], a[152:155], a[8:11], v[48:51]
buffer_load_dwordx4 v10, s[20:23], s39 offen offset:1024  lds
v_mfma_f32_16x16x32_bf16 v[48:51], a[156:159], a[12:15], v[48:51]
ds_read_b64_tr_b16 a[130:131], v3 offset:34816
v_mfma_f32_16x16x32_bf16 v[52:55], a[144:147], a[16:19], v[52:55]
ds_read_b64_tr_b16 a[132:133], v3 offset:36864
v_mfma_f32_16x16x32_bf16 v[52:55], a[148:151], a[20:23], v[52:55]
ds_read_b64_tr_b16 a[134:135], v3 offset:38912
v_mfma_f32_16x16x32_bf16 v[52:55], a[152:155], a[24:27], v[52:55]
buffer_load_dwordx4 v11, s[20:23], s39 offen offset:2048  lds
v_mfma_f32_16x16x32_bf16 v[52:55], a[156:159], a[28:31], v[52:55]
ds_read_b64_tr_b16 a[136:137], v3 offset:40960
v_mfma_f32_16x16x32_bf16 v[56:59], a[144:147], a[32:35], v[56:59]
ds_read_b64_tr_b16 a[138:139], v3 offset:43008
v_mfma_f32_16x16x32_bf16 v[56:59], a[148:151], a[36:39], v[56:59]
ds_read_b64_tr_b16 a[140:141], v3 offset:45056
v_mfma_f32_16x16x32_bf16 v[56:59], a[152:155], a[40:43], v[56:59]
buffer_load_dwordx4 v12, s[20:23], s39 offen offset:3072  lds
v_mfma_f32_16x16x32_bf16 v[56:59], a[156:159], a[44:47], v[56:59]
ds_read_b64_tr_b16 a[142:143], v3 offset:47104
s_add_u32 m0, s37, 81920
v_mfma_f32_16x16x32_bf16 v[60:63], a[144:147], a[48:51], v[60:63]
s_mov_b32 s38, 32768
v_mfma_f32_16x16x32_bf16 v[60:63], a[148:151], a[52:55], v[60:63]
v_mfma_f32_16x16x32_bf16 v[60:63], a[152:155], a[56:59], v[60:63]
buffer_load_dwordx4 v13, s[24:27], s38 offen offset:0  lds
v_mfma_f32_16x16x32_bf16 v[60:63], a[156:159], a[60:63], v[60:63]
s_waitcnt lgkmcnt(0)
v_mfma_f32_16x16x32_bf16 v[64:67], a[128:131], a[0:3], v[64:67]
ds_read_b64_tr_b16 a[144:145], v4 offset:32768
v_mfma_f32_16x16x32_bf16 v[64:67], a[132:135], a[4:7], v[64:67]
v_mfma_f32_16x16x32_bf16 v[64:67], a[136:139], a[8:11], v[64:67]
buffer_load_dwordx4 v13, s[24:27], s38 offen offset:1024  lds
v_mfma_f32_16x16x32_bf16 v[64:67], a[140:143], a[12:15], v[64:67]
ds_read_b64_tr_b16 a[146:147], v4 offset:34816
v_mfma_f32_16x16x32_bf16 v[68:71], a[128:131], a[16:19], v[68:71]
ds_read_b64_tr_b16 a[148:149], v4 offset:36864
v_mfma_f32_16x16x32_bf16 v[68:71], a[132:135], a[20:23], v[68:71]
ds_read_b64_tr_b16 a[150:151], v4 offset:38912
v_mfma_f32_16x16x32_bf16 v[68:71], a[136:139], a[24:27], v[68:71]
buffer_load_dwordx4 v13, s[24:27], s38 offen offset:2048  lds
v_mfma_f32_16x16x32_bf16 v[68:71], a[140:143], a[28:31], v[68:71]
ds_read_b64_tr_b16 a[152:153], v4 offset:40960
v_mfma_f32_16x16x32_bf16 v[72:75], a[128:131], a[32:35], v[72:75]
ds_read_b64_tr_b16 a[154:155], v4 offset:43008
v_mfma_f32_16x16x32_bf16 v[72:75], a[132:135], a[36:39], v[72:75]
ds_read_b64_tr_b16 a[156:157], v4 offset:45056
v_mfma_f32_16x16x32_bf16 v[72:75], a[136:139], a[40:43], v[72:75]
buffer_load_dwordx4 v13, s[24:27], s38 offen offset:3072  lds
v_mfma_f32_16x16x32_bf16 v[72:75], a[140:143], a[44:47], v[72:75]
ds_read_b64_tr_b16 a[158:159], v4 offset:47104
v_mfma_f32_16x16x32_bf16 v[76:79], a[128:131], a[48:51], v[76:79]
v_mfma_f32_16x16x32_bf16 v[76:79], a[132:135], a[52:55], v[76:79]
v_mfma_f32_16x16x32_bf16 v[76:79], a[136:139], a[56:59], v[76:79]
v_mfma_f32_16x16x32_bf16 v[76:79], a[140:143], a[60:63], v[76:79]
s_waitcnt lgkmcnt(0)
v_mfma_f32_16x16x32_bf16 v[80:83], a[144:147], a[0:3], v[80:83]
v_mfma_f32_16x16x32_bf16 v[80:83], a[148:151], a[4:7], v[80:83]
v_mfma_f32_16x16x32_bf16 v[80:83], a[152:155], a[8:11], v[80:83]
s_barrier
v_mfma_f32_16x16x32_bf16 v[80:83], a[156:159], a[12:15], v[80:83]
ds_read_b64_tr_b16 a[128:129], v1 offset:49152
v_mfma_f32_16x16x32_bf16 v[84:87], a[144:147], a[16:19], v[84:87]
v_mfma_f32_16x16x32_bf16 v[84:87], a[148:151], a[20:23], v[84:87]
ds_read_b64_tr_b16 a[130:131], v1 offset:51200
v_mfma_f32_16x16x32_bf16 v[84:87], a[152:155], a[24:27], v[84:87]
ds_read_b64_tr_b16 a[132:133], v1 offset:53248
v_mfma_f32_16x16x32_bf16 v[84:87], a[156:159], a[28:31], v[84:87]
ds_read_b64_tr_b16 a[134:135], v1 offset:55296
v_mfma_f32_16x16x32_bf16 v[88:91], a[144:147], a[32:35], v[88:91]
ds_read_b64_tr_b16 a[136:137], v1 offset:57344
v_mfma_f32_16x16x32_bf16 v[88:91], a[148:151], a[36:39], v[88:91]
ds_read_b64_tr_b16 a[138:139], v1 offset:59392
v_mfma_f32_16x16x32_bf16 v[88:91], a[152:155], a[40:43], v[88:91]
ds_read_b64_tr_b16 a[140:141], v1 offset:61440
v_mfma_f32_16x16x32_bf16 v[88:91], a[156:159], a[44:47], v[88:91]
ds_read_b64_tr_b16 a[142:143], v1 offset:63488
v_mfma_f32_16x16x32_bf16 v[92:95], a[144:147], a[48:51], v[92:95]
v_mfma_f32_16x16x32_bf16 v[92:95], a[148:151], a[52:55], v[92:95]
v_mfma_f32_16x16x32_bf16 v[92:95], a[152:155], a[56:59], v[92:95]
v_mfma_f32_16x16x32_bf16 v[92:95], a[156:159], a[60:63], v[92:95]
s_waitcnt lgkmcnt(4)
v_mfma_f32_16x16x32_bf16 v[96:99], a[128:131], a[0:3], v[96:99]
ds_read_b64_tr_b16 a[144:145], v2 offset:49152
s_add_u32 m0, s37, 98304
v_mfma_f32_16x16x32_bf16 v[96:99], a[132:135], a[4:7], v[96:99]
s_mov_b32 s39, 49152
s_waitcnt lgkmcnt(1)
v_mfma_f32_16x16x32_bf16 v[96:99], a[136:139], a[8:11], v[96:99]
buffer_load_dwordx4 v9, s[20:23], s39 offen offset:0  lds
v_mfma_f32_16x16x32_bf16 v[96:99], a[140:143], a[12:15], v[96:99]
ds_read_b64_tr_b16 a[146:147], v2 offset:51200
v_mfma_f32_16x16x32_bf16 v[100:103], a[128:131], a[16:19], v[100:103]
ds_read_b64_tr_b16 a[148:149], v2 offset:53248
v_mul_f32 v32, s50, v32
v_mfma_f32_16x16x32_bf16 v[100:103], a[132:135], a[20:23], v[100:103]
buffer_load_dwordx4 v10, s[20:23], s39 offen offset:1024  lds
v_mfma_f32_16x16x32_bf16 v[100:103], a[136:139], a[24:27], v[100:103]
ds_read_b64_tr_b16 a[150:151], v2 offset:55296
v_mul_f32 v33, s50, v33
v_mfma_f32_16x16x32_bf16 v[100:103], a[140:143], a[28:31], v[100:103]
ds_read_b64_tr_b16 a[152:153], v2 offset:57344
v_mul_f32 v34, s50, v34
v_mfma_f32_16x16x32_bf16 v[104:107], a[128:131], a[32:35], v[104:107]
buffer_load_dwordx4 v11, s[20:23], s39 offen offset:2048  lds
v_mfma_f32_16x16x32_bf16 v[104:107], a[132:135], a[36:39], v[104:107]
ds_read_b64_tr_b16 a[154:155], v2 offset:59392
v_mul_f32 v35, s50, v35
v_mfma_f32_16x16x32_bf16 v[104:107], a[136:139], a[40:43], v[104:107]
ds_read_b64_tr_b16 a[156:157], v2 offset:61440
v_mul_f32 v36, s50, v36
v_mfma_f32_16x16x32_bf16 v[104:107], a[140:143], a[44:47], v[104:107]
ds_read_b64_tr_b16 a[158:159], v2 offset:63488
v_mul_f32 v37, s50, v37
v_mfma_f32_16x16x32_bf16 v[108:111], a[128:131], a[48:51], v[108:111]
buffer_load_dwordx4 v12, s[20:23], s39 offen offset:3072  lds
v_mfma_f32_16x16x32_bf16 v[108:111], a[132:135], a[52:55], v[108:111]
v_mul_f32 v38, s50, v38
v_mul_f32 v39, s50, v39
v_mfma_f32_16x16x32_bf16 v[108:111], a[136:139], a[56:59], v[108:111]
v_cvt_pk_bf16_f32 v32, v32, v33
v_cvt_pk_bf16_f32 v33, v34, v35
v_mfma_f32_16x16x32_bf16 v[108:111], a[140:143], a[60:63], v[108:111]
s_waitcnt lgkmcnt(0)
v_cvt_pk_bf16_f32 v34, v36, v37
v_cvt_pk_bf16_f32 v35, v38, v39
v_mfma_f32_16x16x32_bf16 v[112:115], a[144:147], a[0:3], v[112:115]
ds_read_b64_tr_b16 a[128:129], v3 offset:49152
v_mul_f32 v40, s50, v40
v_mfma_f32_16x16x32_bf16 v[112:115], a[148:151], a[4:7], v[112:115]
v_mul_f32 v41, s50, v41
v_permlane16_swap_b32 v32, v34
v_mfma_f32_16x16x32_bf16 v[112:115], a[152:155], a[8:11], v[112:115]
ds_read_b64_tr_b16 a[130:131], v3 offset:51200
v_permlane16_swap_b32 v33, v35
v_mfma_f32_16x16x32_bf16 v[112:115], a[156:159], a[12:15], v[112:115]
ds_read_b64_tr_b16 a[132:133], v3 offset:53248
v_mul_f32 v42, s50, v42
v_mfma_f32_16x16x32_bf16 v[116:119], a[144:147], a[16:19], v[116:119]
v_mul_f32 v43, s50, v43
v_mul_f32 v44, s50, v44
v_mfma_f32_16x16x32_bf16 v[116:119], a[148:151], a[20:23], v[116:119]
ds_read_b64_tr_b16 a[134:135], v3 offset:55296
v_mul_f32 v45, s50, v45
v_mfma_f32_16x16x32_bf16 v[116:119], a[152:155], a[24:27], v[116:119]
ds_read_b64_tr_b16 a[136:137], v3 offset:57344
v_mul_f32 v46, s50, v46
v_mfma_f32_16x16x32_bf16 v[116:119], a[156:159], a[28:31], v[116:119]
v_mul_f32 v47, s50, v47
v_accvgpr_write_b32 a64, v32
v_mfma_f32_16x16x32_bf16 v[120:123], a[144:147], a[32:35], v[120:123]
ds_read_b64_tr_b16 a[138:139], v3 offset:59392
v_accvgpr_write_b32 a65, v33
v_mfma_f32_16x16x32_bf16 v[120:123], a[148:151], a[36:39], v[120:123]
ds_read_b64_tr_b16 a[140:141], v3 offset:61440
v_accvgpr_write_b32 a66, v34
v_mfma_f32_16x16x32_bf16 v[120:123], a[152:155], a[40:43], v[120:123]
v_accvgpr_write_b32 a67, v35
v_cvt_pk_bf16_f32 v36, v40, v41
v_mfma_f32_16x16x32_bf16 v[120:123], a[156:159], a[44:47], v[120:123]
ds_read_b64_tr_b16 a[142:143], v3 offset:63488
v_cvt_pk_bf16_f32 v37, v42, v43
v_mfma_f32_16x16x32_bf16 v[124:127], a[144:147], a[48:51], v[124:127]
v_cvt_pk_bf16_f32 v38, v44, v45
v_cvt_pk_bf16_f32 v39, v46, v47
v_mfma_f32_16x16x32_bf16 v[124:127], a[148:151], a[52:55], v[124:127]
v_mul_f32 v48, s50, v48
v_mul_f32 v49, s50, v49
v_mfma_f32_16x16x32_bf16 v[124:127], a[152:155], a[56:59], v[124:127]
v_permlane16_swap_b32 v36, v38
v_permlane16_swap_b32 v37, v39
v_mfma_f32_16x16x32_bf16 v[124:127], a[156:159], a[60:63], v[124:127]
s_waitcnt lgkmcnt(0)
v_mul_f32 v50, s50, v50
v_mul_f32 v51, s50, v51
v_mfma_f32_16x16x32_bf16 v[128:131], a[128:131], a[0:3], v[128:131]
ds_read_b64_tr_b16 a[144:145], v4 offset:49152
v_mul_f32 v52, s50, v52
v_mfma_f32_16x16x32_bf16 v[128:131], a[132:135], a[4:7], v[128:131]
v_mul_f32 v53, s50, v53
v_mul_f32 v54, s50, v54
v_mfma_f32_16x16x32_bf16 v[128:131], a[136:139], a[8:11], v[128:131]
ds_read_b64_tr_b16 a[146:147], v4 offset:51200
v_mul_f32 v55, s50, v55
v_mfma_f32_16x16x32_bf16 v[128:131], a[140:143], a[12:15], v[128:131]
ds_read_b64_tr_b16 a[148:149], v4 offset:53248
v_accvgpr_write_b32 a68, v36
v_mfma_f32_16x16x32_bf16 v[132:135], a[128:131], a[16:19], v[132:135]
v_accvgpr_write_b32 a69, v37
v_accvgpr_write_b32 a70, v38
v_mfma_f32_16x16x32_bf16 v[132:135], a[132:135], a[20:23], v[132:135]
ds_read_b64_tr_b16 a[150:151], v4 offset:55296
v_accvgpr_write_b32 a71, v39
v_mfma_f32_16x16x32_bf16 v[132:135], a[136:139], a[24:27], v[132:135]
ds_read_b64_tr_b16 a[152:153], v4 offset:57344
v_cvt_pk_bf16_f32 v40, v48, v49
v_mfma_f32_16x16x32_bf16 v[132:135], a[140:143], a[28:31], v[132:135]
v_cvt_pk_bf16_f32 v41, v50, v51
v_cvt_pk_bf16_f32 v42, v52, v53
v_mfma_f32_16x16x32_bf16 v[136:139], a[128:131], a[32:35], v[136:139]
ds_read_b64_tr_b16 a[154:155], v4 offset:59392
v_cvt_pk_bf16_f32 v43, v54, v55
v_mfma_f32_16x16x32_bf16 v[136:139], a[132:135], a[36:39], v[136:139]
ds_read_b64_tr_b16 a[156:157], v4 offset:61440
v_mul_f32 v56, s50, v56
v_mfma_f32_16x16x32_bf16 v[136:139], a[136:139], a[40:43], v[136:139]
v_mul_f32 v57, s50, v57
v_permlane16_swap_b32 v40, v42
v_mfma_f32_16x16x32_bf16 v[136:139], a[140:143], a[44:47], v[136:139]
ds_read_b64_tr_b16 a[158:159], v4 offset:63488
v_permlane16_swap_b32 v41, v43
v_mfma_f32_16x16x32_bf16 v[140:143], a[128:131], a[48:51], v[140:143]
v_mul_f32 v58, s50, v58
v_mul_f32 v59, s50, v59
v_mfma_f32_16x16x32_bf16 v[140:143], a[132:135], a[52:55], v[140:143]
v_mul_f32 v60, s50, v60
v_mul_f32 v61, s50, v61
v_mfma_f32_16x16x32_bf16 v[140:143], a[136:139], a[56:59], v[140:143]
v_mul_f32 v62, s50, v62
v_mul_f32 v63, s50, v63
v_mfma_f32_16x16x32_bf16 v[140:143], a[140:143], a[60:63], v[140:143]
s_waitcnt lgkmcnt(0)
v_accvgpr_write_b32 a72, v40
v_accvgpr_write_b32 a73, v41
v_mfma_f32_16x16x32_bf16 v[144:147], a[144:147], a[0:3], v[144:147]
v_accvgpr_write_b32 a74, v42
v_accvgpr_write_b32 a75, v43
v_mfma_f32_16x16x32_bf16 v[144:147], a[148:151], a[4:7], v[144:147]
v_cvt_pk_bf16_f32 v44, v56, v57
v_cvt_pk_bf16_f32 v45, v58, v59
v_mfma_f32_16x16x32_bf16 v[144:147], a[152:155], a[8:11], v[144:147]
s_barrier
v_cvt_pk_bf16_f32 v46, v60, v61
v_cvt_pk_bf16_f32 v47, v62, v63
v_mfma_f32_16x16x32_bf16 v[144:147], a[156:159], a[12:15], v[144:147]
ds_read_b128 a[192:195], v14 offset:0
v_mul_f32 v64, s50, v64
v_mfma_f32_16x16x32_bf16 v[148:151], a[144:147], a[16:19], v[148:151]
ds_read_b128 a[196:199], v15 offset:0
v_mul_f32 v65, s50, v65
v_mfma_f32_16x16x32_bf16 v[148:151], a[148:151], a[20:23], v[148:151]
ds_read_b128 a[200:203], v16 offset:0
v_permlane16_swap_b32 v44, v46
v_mfma_f32_16x16x32_bf16 v[148:151], a[152:155], a[24:27], v[148:151]
ds_read_b128 a[204:207], v17 offset:0
v_permlane16_swap_b32 v45, v47
v_mfma_f32_16x16x32_bf16 v[148:151], a[156:159], a[28:31], v[148:151]
ds_read_b128 a[208:211], v18 offset:0
v_mul_f32 v66, s50, v66
v_mfma_f32_16x16x32_bf16 v[152:155], a[144:147], a[32:35], v[152:155]
ds_read_b128 a[212:215], v19 offset:0
v_mul_f32 v67, s50, v67
v_mfma_f32_16x16x32_bf16 v[152:155], a[148:151], a[36:39], v[152:155]
ds_read_b128 a[216:219], v20 offset:0
v_mul_f32 v68, s50, v68
v_mfma_f32_16x16x32_bf16 v[152:155], a[152:155], a[40:43], v[152:155]
ds_read_b128 a[220:223], v21 offset:0
v_mul_f32 v69, s50, v69
v_mfma_f32_16x16x32_bf16 v[152:155], a[156:159], a[44:47], v[152:155]
v_mul_f32 v70, s50, v70
v_mul_f32 v71, s50, v71
v_mfma_f32_16x16x32_bf16 v[156:159], a[144:147], a[48:51], v[156:159]
v_accvgpr_write_b32 a76, v44
v_accvgpr_write_b32 a77, v45
v_mfma_f32_16x16x32_bf16 v[156:159], a[148:151], a[52:55], v[156:159]
v_accvgpr_write_b32 a78, v46
v_accvgpr_write_b32 a79, v47
v_mfma_f32_16x16x32_bf16 v[156:159], a[152:155], a[56:59], v[156:159]
v_cvt_pk_bf16_f32 v48, v64, v65
v_cvt_pk_bf16_f32 v49, v66, v67
v_mfma_f32_16x16x32_bf16 v[156:159], a[156:159], a[60:63], v[156:159]
v_cvt_pk_bf16_f32 v50, v68, v69
v_cvt_pk_bf16_f32 v51, v70, v71
v_mul_f32 v72, s50, v72
v_mul_f32 v73, s50, v73
v_permlane16_swap_b32 v48, v50
v_permlane16_swap_b32 v49, v51
v_mul_f32 v74, s50, v74
v_mul_f32 v75, s50, v75
v_mul_f32 v76, s50, v76
v_mul_f32 v77, s50, v77
v_mul_f32 v78, s50, v78
v_mul_f32 v79, s50, v79
v_accvgpr_write_b32 a80, v48
v_accvgpr_write_b32 a81, v49
v_accvgpr_write_b32 a82, v50
v_accvgpr_write_b32 a83, v51
v_cvt_pk_bf16_f32 v52, v72, v73
v_cvt_pk_bf16_f32 v53, v74, v75
v_cvt_pk_bf16_f32 v54, v76, v77
v_cvt_pk_bf16_f32 v55, v78, v79
v_mul_f32 v80, s50, v80
v_mul_f32 v81, s50, v81
v_permlane16_swap_b32 v52, v54
v_permlane16_swap_b32 v53, v55
v_mul_f32 v82, s50, v82
v_mul_f32 v83, s50, v83
v_mul_f32 v84, s50, v84
v_mul_f32 v85, s50, v85
v_mul_f32 v86, s50, v86
v_mul_f32 v87, s50, v87
v_accvgpr_write_b32 a84, v52
v_accvgpr_write_b32 a85, v53
v_accvgpr_write_b32 a86, v54
v_accvgpr_write_b32 a87, v55
v_cvt_pk_bf16_f32 v56, v80, v81
v_cvt_pk_bf16_f32 v57, v82, v83
v_cvt_pk_bf16_f32 v58, v84, v85
v_cvt_pk_bf16_f32 v59, v86, v87
v_mul_f32 v88, s50, v88
v_mul_f32 v89, s50, v89
v_permlane16_swap_b32 v56, v58
v_permlane16_swap_b32 v57, v59
v_mul_f32 v90, s50, v90
v_mul_f32 v91, s50, v91
v_mul_f32 v92, s50, v92
v_mul_f32 v93, s50, v93
v_mul_f32 v94, s50, v94
v_mul_f32 v95, s50, v95
v_accvgpr_write_b32 a88, v56
v_accvgpr_write_b32 a89, v57
v_accvgpr_write_b32 a90, v58
v_accvgpr_write_b32 a91, v59
v_cvt_pk_bf16_f32 v60, v88, v89
v_cvt_pk_bf16_f32 v61, v90, v91
v_cvt_pk_bf16_f32 v62, v92, v93
v_cvt_pk_bf16_f32 v63, v94, v95
s_nop 0
v_permlane16_swap_b32 v60, v62
v_permlane16_swap_b32 v61, v63
v_accvgpr_write_b32 a92, v60
v_accvgpr_write_b32 a93, v61
v_accvgpr_write_b32 a94, v62
v_accvgpr_write_b32 a95, v63
v_pk_mul_f32 v[96:97], v[96:97], s[50:51] op_sel_hi:[1,0]
v_pk_mul_f32 v[98:99], v[98:99], s[50:51] op_sel_hi:[1,0]
v_pk_mul_f32 v[100:101], v[100:101], s[50:51] op_sel_hi:[1,0]
v_pk_mul_f32 v[102:103], v[102:103], s[50:51] op_sel_hi:[1,0]
v_cvt_pk_bf16_f32 v64, v96, v97
v_cvt_pk_bf16_f32 v65, v98, v99
v_cvt_pk_bf16_f32 v66, v100, v101
v_cvt_pk_bf16_f32 v67, v102, v103
v_pk_mul_f32 v[104:105], v[104:105], s[50:51] op_sel_hi:[1,0]
v_pk_mul_f32 v[106:107], v[106:107], s[50:51] op_sel_hi:[1,0]
v_permlane16_swap_b32 v64, v66
v_permlane16_swap_b32 v65, v67
v_pk_mul_f32 v[108:109], v[108:109], s[50:51] op_sel_hi:[1,0]
v_pk_mul_f32 v[110:111], v[110:111], s[50:51] op_sel_hi:[1,0]
v_accvgpr_write_b32 a96, v64
v_accvgpr_write_b32 a97, v65
v_accvgpr_write_b32 a98, v66
v_accvgpr_write_b32 a99, v67
v_cvt_pk_bf16_f32 v68, v104, v105
v_cvt_pk_bf16_f32 v69, v106, v107
v_cvt_pk_bf16_f32 v70, v108, v109
v_cvt_pk_bf16_f32 v71, v110, v111
v_pk_mul_f32 v[112:113], v[112:113], s[50:51] op_sel_hi:[1,0]
v_pk_mul_f32 v[114:115], v[114:115], s[50:51] op_sel_hi:[1,0]
v_permlane16_swap_b32 v68, v70
v_permlane16_swap_b32 v69, v71
v_pk_mul_f32 v[116:117], v[116:117], s[50:51] op_sel_hi:[1,0]
v_pk_mul_f32 v[118:119], v[118:119], s[50:51] op_sel_hi:[1,0]
v_accvgpr_write_b32 a100, v68
v_accvgpr_write_b32 a101, v69
v_accvgpr_write_b32 a102, v70
v_accvgpr_write_b32 a103, v71
v_cvt_pk_bf16_f32 v72, v112, v113
v_cvt_pk_bf16_f32 v73, v114, v115
v_cvt_pk_bf16_f32 v74, v116, v117
v_cvt_pk_bf16_f32 v75, v118, v119
v_pk_mul_f32 v[120:121], v[120:121], s[50:51] op_sel_hi:[1,0]
v_pk_mul_f32 v[122:123], v[122:123], s[50:51] op_sel_hi:[1,0]
v_permlane16_swap_b32 v72, v74
v_permlane16_swap_b32 v73, v75
v_pk_mul_f32 v[124:125], v[124:125], s[50:51] op_sel_hi:[1,0]
v_pk_mul_f32 v[126:127], v[126:127], s[50:51] op_sel_hi:[1,0]
v_accvgpr_write_b32 a104, v72
v_accvgpr_write_b32 a105, v73
v_accvgpr_write_b32 a106, v74
v_accvgpr_write_b32 a107, v75
v_cvt_pk_bf16_f32 v76, v120, v121
v_cvt_pk_bf16_f32 v77, v122, v123
v_cvt_pk_bf16_f32 v78, v124, v125
v_cvt_pk_bf16_f32 v79, v126, v127
v_pk_mul_f32 v[128:129], v[128:129], s[50:51] op_sel_hi:[1,0]
v_pk_mul_f32 v[130:131], v[130:131], s[50:51] op_sel_hi:[1,0]
v_permlane16_swap_b32 v76, v78
v_permlane16_swap_b32 v77, v79
v_pk_mul_f32 v[132:133], v[132:133], s[50:51] op_sel_hi:[1,0]
v_pk_mul_f32 v[134:135], v[134:135], s[50:51] op_sel_hi:[1,0]
v_accvgpr_write_b32 a108, v76
v_accvgpr_write_b32 a109, v77
v_accvgpr_write_b32 a110, v78
v_accvgpr_write_b32 a111, v79
v_cvt_pk_bf16_f32 v80, v128, v129
v_cvt_pk_bf16_f32 v81, v130, v131
v_cvt_pk_bf16_f32 v82, v132, v133
v_cvt_pk_bf16_f32 v83, v134, v135
s_waitcnt lgkmcnt(7)
v_mfma_f32_32x32x16_bf16 v[32:47], a[192:195], a[64:67], 0
v_mul_f32 v136, s50, v136
v_mfma_f32_32x32x16_bf16 v[48:63], a[192:195], a[68:71], 0
ds_read_b128 a[192:195], v14 offset:8192
s_waitcnt lgkmcnt(7)
v_mul_f32 v137, s50, v137
v_permlane16_swap_b32 v80, v82
v_permlane16_swap_b32 v81, v83
v_mul_f32 v138, s50, v138
v_mfma_f32_32x32x16_bf16 v[32:47], a[196:199], a[72:75], v[32:47]
v_mul_f32 v139, s50, v139
v_mul_f32 v140, s50, v140
v_mul_f32 v141, s50, v141
v_mul_f32 v142, s50, v142
v_mul_f32 v143, s50, v143
v_accvgpr_write_b32 a112, v80
v_mfma_f32_32x32x16_bf16 v[48:63], a[196:199], a[76:79], v[48:63]
ds_read_b128 a[196:199], v15 offset:8192
s_waitcnt lgkmcnt(7)
v_accvgpr_write_b32 a113, v81
v_accvgpr_write_b32 a114, v82
v_accvgpr_write_b32 a115, v83
v_cvt_pk_bf16_f32 v84, v136, v137
v_mfma_f32_32x32x16_bf16 v[32:47], a[200:203], a[80:83], v[32:47]
v_cvt_pk_bf16_f32 v85, v138, v139
v_cvt_pk_bf16_f32 v86, v140, v141
v_cvt_pk_bf16_f32 v87, v142, v143
v_mul_f32 v144, s50, v144
v_mul_f32 v145, s50, v145
v_permlane16_swap_b32 v84, v86
v_mfma_f32_32x32x16_bf16 v[48:63], a[200:203], a[84:87], v[48:63]
ds_read_b128 a[200:203], v16 offset:8192
s_waitcnt lgkmcnt(7)
v_permlane16_swap_b32 v85, v87
v_mul_f32 v146, s50, v146
v_mul_f32 v147, s50, v147
v_mul_f32 v148, s50, v148
v_mfma_f32_32x32x16_bf16 v[32:47], a[204:207], a[88:91], v[32:47]
v_mul_f32 v149, s50, v149
v_mul_f32 v150, s50, v150
v_mul_f32 v151, s50, v151
v_accvgpr_write_b32 a116, v84
v_accvgpr_write_b32 a117, v85
v_accvgpr_write_b32 a118, v86
v_mfma_f32_32x32x16_bf16 v[48:63], a[204:207], a[92:95], v[48:63]
ds_read_b128 a[204:207], v17 offset:8192
v_accvgpr_write_b32 a119, v87
v_cvt_pk_bf16_f32 v88, v144, v145
v_cvt_pk_bf16_f32 v89, v146, v147
v_cvt_pk_bf16_f32 v90, v148, v149
v_cvt_pk_bf16_f32 v91, v150, v151
v_mul_f32 v152, s50, v152
v_mul_f32 v153, s50, v153
v_permlane16_swap_b32 v88, v90
v_permlane16_swap_b32 v89, v91
v_mul_f32 v154, s50, v154
v_mul_f32 v155, s50, v155
v_mul_f32 v156, s50, v156
v_mul_f32 v157, s50, v157
v_mul_f32 v158, s50, v158
v_mul_f32 v159, s50, v159
v_accvgpr_write_b32 a120, v88
v_accvgpr_write_b32 a121, v89
v_accvgpr_write_b32 a122, v90
v_accvgpr_write_b32 a123, v91
v_cvt_pk_bf16_f32 v92, v152, v153
v_cvt_pk_bf16_f32 v93, v154, v155
v_cvt_pk_bf16_f32 v94, v156, v157
v_cvt_pk_bf16_f32 v95, v158, v159
s_nop 0
v_permlane16_swap_b32 v92, v94
v_permlane16_swap_b32 v93, v95
v_accvgpr_write_b32 a124, v92
v_accvgpr_write_b32 a125, v93
v_accvgpr_write_b32 a126, v94
v_accvgpr_write_b32 a127, v95
s_waitcnt lgkmcnt(7)
v_mfma_f32_32x32x16_bf16 v[32:47], a[208:211], a[96:99], v[32:47]
v_mov_b32 v96, v160
v_mfma_f32_32x32x16_bf16 v[48:63], a[208:211], a[100:103], v[48:63]
ds_read_b128 a[208:211], v18 offset:8192
s_waitcnt lgkmcnt(7)
v_mov_b32 v97, v161
v_mov_b32 v98, v162
v_mov_b32 v99, v163
v_mov_b32 v100, v164
v_mfma_f32_32x32x16_bf16 v[32:47], a[212:215], a[104:107], v[32:47]
v_mov_b32 v101, v165
v_mov_b32 v102, v166
v_mov_b32 v103, v167
v_mov_b32 v104, v168
v_mov_b32 v105, v169
v_mfma_f32_32x32x16_bf16 v[48:63], a[212:215], a[108:111], v[48:63]
ds_read_b128 a[212:215], v19 offset:8192
s_waitcnt lgkmcnt(7)
v_mfma_f32_32x32x16_bf16 v[32:47], a[216:219], a[112:115], v[32:47]
v_mfma_f32_32x32x16_bf16 v[48:63], a[216:219], a[116:119], v[48:63]
ds_read_b128 a[216:219], v20 offset:8192
s_waitcnt lgkmcnt(7)
v_mfma_f32_32x32x16_bf16 v[32:47], a[220:223], a[120:123], v[32:47]
v_mfma_f32_32x32x16_bf16 v[48:63], a[220:223], a[124:127], v[48:63]
ds_read_b128 a[220:223], v21 offset:8192
s_waitcnt lgkmcnt(7)
v_mfma_f32_32x32x16_bf16 v[64:79], a[192:195], a[64:67], 0
v_mfma_f32_32x32x16_bf16 v[80:95], a[192:195], a[68:71], 0
s_waitcnt lgkmcnt(6)
v_mfma_f32_32x32x16_bf16 v[64:79], a[196:199], a[72:75], v[64:79]
s_waitcnt vmcnt(16) lgkmcnt(0)
s_barrier
s_nop 2
v_exp_f32 v32, v32
v_mfma_f32_32x32x16_bf16 v[80:95], a[196:199], a[76:79], v[80:95]
ds_read_b64_tr_b16 a[224:225], v22 offset:16384
v_exp_f32 v33, v33
v_add_f32 v26, v26, v32
v_exp_f32 v34, v34
v_mfma_f32_32x32x16_bf16 v[64:79], a[200:203], a[80:83], v[64:79]
ds_read_b64_tr_b16 a[226:227], v22 offset:18432
ds_read_b64_tr_b16 a[228:229], v23 offset:16384
v_add_f32 v26, v26, v33
v_cvt_pk_bf16_f32 v32, v32, v33
v_exp_f32 v35, v35
v_mfma_f32_32x32x16_bf16 v[80:95], a[200:203], a[84:87], v[80:95]
ds_read_b64_tr_b16 a[230:231], v23 offset:18432
ds_read_b64_tr_b16 a[232:233], v24 offset:16384
v_add_f32 v26, v26, v34
v_exp_f32 v36, v36
v_add_f32 v26, v26, v35
v_mfma_f32_32x32x16_bf16 v[64:79], a[204:207], a[88:91], v[64:79]
ds_read_b64_tr_b16 a[234:235], v24 offset:18432
ds_read_b64_tr_b16 a[236:237], v25 offset:16384
v_cvt_pk_bf16_f32 v33, v34, v35
v_exp_f32 v37, v37
v_add_f32 v26, v26, v36
v_mfma_f32_32x32x16_bf16 v[80:95], a[204:207], a[92:95], v[80:95]
ds_read_b64_tr_b16 a[238:239], v25 offset:18432
ds_read_b64_tr_b16 a[240:241], v22 offset:20480
v_exp_f32 v38, v38
v_add_f32 v26, v26, v37
v_cvt_pk_bf16_f32 v34, v36, v37
v_mfma_f32_32x32x16_bf16 v[64:79], a[208:211], a[96:99], v[64:79]
ds_read_b64_tr_b16 a[242:243], v22 offset:22528
ds_read_b64_tr_b16 a[244:245], v23 offset:20480
v_exp_f32 v39, v39
v_add_f32 v26, v26, v38
v_add_f32 v26, v26, v39
v_mfma_f32_32x32x16_bf16 v[80:95], a[208:211], a[100:103], v[80:95]
ds_read_b64_tr_b16 a[246:247], v23 offset:22528
ds_read_b64_tr_b16 a[248:249], v24 offset:20480
v_cvt_pk_bf16_f32 v35, v38, v39
v_exp_f32 v48, v48
v_mfma_f32_32x32x16_bf16 v[64:79], a[212:215], a[104:107], v[64:79]
ds_read_b64_tr_b16 a[250:251], v24 offset:22528
ds_read_b64_tr_b16 a[252:253], v25 offset:20480
v_exp_f32 v49, v49
v_add_f32 v28, v28, v48
v_mfma_f32_32x32x16_bf16 v[80:95], a[212:215], a[108:111], v[80:95]
s_waitcnt lgkmcnt(14)
ds_read_b64_tr_b16 a[254:255], v25 offset:22528
v_exp_f32 v50, v50
v_add_f32 v28, v28, v49
v_cvt_pk_bf16_f32 v48, v48, v49
v_mfma_f32_32x32x16_bf16 v[64:79], a[216:219], a[112:115], v[64:79]
v_exp_f32 v51, v51
v_add_f32 v28, v28, v50
v_exp_f32 v52, v52
v_add_f32 v28, v28, v51
v_mfma_f32_32x32x16_bf16 v[80:95], a[216:219], a[116:119], v[80:95]
v_cvt_pk_bf16_f32 v49, v50, v51
v_exp_f32 v53, v53
v_add_f32 v28, v28, v52
v_exp_f32 v54, v54
v_mfma_f32_32x32x16_bf16 v[64:79], a[220:223], a[120:123], v[64:79]
v_add_f32 v28, v28, v53
v_cvt_pk_bf16_f32 v50, v52, v53
v_exp_f32 v55, v55
v_add_f32 v28, v28, v54
v_add_f32 v28, v28, v55
v_mfma_f32_32x32x16_bf16 v[80:95], a[220:223], a[124:127], v[80:95]
s_waitcnt lgkmcnt(8)
v_cvt_pk_bf16_f32 v51, v54, v55
v_mfma_f32_32x32x16_bf16 v[128:143], a[224:227], v[32:35], 0
ds_read_b128 a[192:195], v14 offset:32768
s_add_u32 m0, s37, 114688
s_mov_b32 s38, 49152
v_exp_f32 v40, v40
v_mfma_f32_32x32x16_bf16 v[192:207], a[224:227], v[48:51], 0
buffer_load_dwordx4 v13, s[24:27], s38 offen offset:0  lds
ds_read_b128 a[196:199], v15 offset:32768
v_exp_f32 v41, v41
v_add_f32 v26, v26, v40
v_mfma_f32_32x32x16_bf16 v[144:159], a[228:231], v[32:35], 0
ds_read_b128 a[200:203], v16 offset:32768
ds_read_b128 a[204:207], v17 offset:32768
v_exp_f32 v42, v42
v_add_f32 v26, v26, v41
v_cvt_pk_bf16_f32 v40, v40, v41
v_mfma_f32_32x32x16_bf16 v[208:223], a[228:231], v[48:51], 0
buffer_load_dwordx4 v13, s[24:27], s38 offen offset:1024  lds
ds_read_b128 a[208:211], v18 offset:32768
v_exp_f32 v43, v43
v_add_f32 v26, v26, v42
v_mfma_f32_32x32x16_bf16 v[160:175], a[232:235], v[32:35], 0
ds_read_b128 a[212:215], v19 offset:32768
ds_read_b128 a[216:219], v20 offset:32768
v_exp_f32 v44, v44
v_add_f32 v26, v26, v43
v_cvt_pk_bf16_f32 v41, v42, v43
v_mfma_f32_32x32x16_bf16 v[224:239], a[232:235], v[48:51], 0
s_waitcnt lgkmcnt(14)
ds_read_b128 a[220:223], v21 offset:32768
v_exp_f32 v45, v45
v_add_f32 v26, v26, v44
v_exp_f32 v46, v46
v_mfma_f32_32x32x16_bf16 v[176:191], a[236:239], v[32:35], 0
buffer_load_dwordx4 v13, s[24:27], s38 offen offset:2048  lds
v_add_f32 v26, v26, v45
v_cvt_pk_bf16_f32 v42, v44, v45
v_exp_f32 v47, v47
v_mfma_f32_32x32x16_bf16 v[240:255], a[236:239], v[48:51], 0
v_add_f32 v26, v26, v46
v_add_f32 v26, v26, v47
v_cvt_pk_bf16_f32 v43, v46, v47
v_exp_f32 v56, v56
v_exp_f32 v57, v57
v_add_f32 v28, v28, v56
v_exp_f32 v58, v58
v_add_f32 v28, v28, v57
v_cvt_pk_bf16_f32 v56, v56, v57
v_exp_f32 v59, v59
v_add_f32 v28, v28, v58
v_exp_f32 v60, v60
v_add_f32 v28, v28, v59
v_cvt_pk_bf16_f32 v57, v58, v59
v_exp_f32 v61, v61
v_add_f32 v28, v28, v60
v_exp_f32 v62, v62
v_add_f32 v28, v28, v61
v_cvt_pk_bf16_f32 v58, v60, v61
v_exp_f32 v63, v63
v_add_f32 v28, v28, v62
v_add_f32 v28, v28, v63
v_cvt_pk_bf16_f32 v59, v62, v63
s_waitcnt lgkmcnt(8)
v_mfma_f32_32x32x16_bf16 v[128:143], a[240:243], v[40:43], v[128:143]
buffer_load_dwordx4 v13, s[24:27], s38 offen offset:3072  lds
s_add_u32 m0, s37, 0
s_mov_b32 s39, 65536
v_exp_f32 v64, v64
v_mfma_f32_32x32x16_bf16 v[192:207], a[240:243], v[56:59], v[192:207]
v_exp_f32 v65, v65
v_add_f32 v26, v26, v64
v_exp_f32 v66, v66
v_add_f32 v26, v26, v65
v_mfma_f32_32x32x16_bf16 v[144:159], a[244:247], v[40:43], v[144:159]
buffer_load_dwordx4 v9, s[20:23], s39 offen offset:0  lds
v_cvt_pk_bf16_f32 v64, v64, v65
v_exp_f32 v67, v67
v_add_f32 v26, v26, v66
v_mfma_f32_32x32x16_bf16 v[208:223], a[244:247], v[56:59], v[208:223]
v_exp_f32 v68, v68
v_add_f32 v26, v26, v67
v_cvt_pk_bf16_f32 v65, v66, v67
v_exp_f32 v69, v69
v_mfma_f32_32x32x16_bf16 v[160:175], a[248:251], v[40:43], v[160:175]
v_add_f32 v26, v26, v68
v_exp_f32 v70, v70
v_add_f32 v26, v26, v69
v_cvt_pk_bf16_f32 v66, v68, v69
v_mfma_f32_32x32x16_bf16 v[224:239], a[248:251], v[56:59], v[224:239]
buffer_load_dwordx4 v10, s[20:23], s39 offen offset:1024  lds
v_exp_f32 v71, v71
v_add_f32 v26, v26, v70
v_add_f32 v26, v26, v71
v_mfma_f32_32x32x16_bf16 v[176:191], a[252:255], v[40:43], v[176:191]
v_cvt_pk_bf16_f32 v67, v70, v71
v_exp_f32 v80, v80
v_exp_f32 v81, v81
v_add_f32 v28, v28, v80
v_mfma_f32_32x32x16_bf16 v[240:255], a[252:255], v[56:59], v[240:255]
v_exp_f32 v82, v82
v_add_f32 v28, v28, v81
v_cvt_pk_bf16_f32 v80, v80, v81
v_exp_f32 v83, v83
v_add_f32 v28, v28, v82
v_exp_f32 v84, v84
v_add_f32 v28, v28, v83
v_cvt_pk_bf16_f32 v81, v82, v83
v_exp_f32 v85, v85
v_add_f32 v28, v28, v84
v_exp_f32 v86, v86
v_add_f32 v28, v28, v85
v_cvt_pk_bf16_f32 v82, v84, v85
v_exp_f32 v87, v87
v_add_f32 v28, v28, v86
v_add_f32 v28, v28, v87
v_cvt_pk_bf16_f32 v83, v86, v87
s_waitcnt lgkmcnt(0)
v_mfma_f32_32x32x16_bf16 v[32:47], a[192:195], a[64:67], 0
buffer_load_dwordx4 v11, s[20:23], s39 offen offset:2048  lds
ds_read_b64_tr_b16 a[224:225], v22 offset:24576
v_exp_f32 v72, v72
v_mfma_f32_32x32x16_bf16 v[48:63], a[192:195], a[68:71], 0
ds_read_b64_tr_b16 a[226:227], v22 offset:26624
ds_read_b64_tr_b16 a[228:229], v23 offset:24576
v_exp_f32 v73, v73
v_add_f32 v26, v26, v72
v_mfma_f32_32x32x16_bf16 v[32:47], a[196:199], a[72:75], v[32:47]
buffer_load_dwordx4 v12, s[20:23], s39 offen offset:3072  lds
ds_read_b64_tr_b16 a[230:231], v23 offset:26624
v_exp_f32 v74, v74
v_add_f32 v26, v26, v73
v_mfma_f32_32x32x16_bf16 v[48:63], a[196:199], a[76:79], v[48:63]
ds_read_b64_tr_b16 a[232:233], v24 offset:24576
ds_read_b64_tr_b16 a[234:235], v24 offset:26624
v_cvt_pk_bf16_f32 v72, v72, v73
v_exp_f32 v75, v75
v_add_f32 v26, v26, v74
v_mfma_f32_32x32x16_bf16 v[32:47], a[200:203], a[80:83], v[32:47]
ds_read_b64_tr_b16 a[236:237], v25 offset:24576
ds_read_b64_tr_b16 a[238:239], v25 offset:26624
v_exp_f32 v76, v76
v_add_f32 v26, v26, v75
v_cvt_pk_bf16_f32 v73, v74, v75
v_mfma_f32_32x32x16_bf16 v[48:63], a[200:203], a[84:87], v[48:63]
ds_read_b64_tr_b16 a[240:241], v22 offset:28672
ds_read_b64_tr_b16 a[242:243], v22 offset:30720
v_exp_f32 v77, v77
v_add_f32 v26, v26, v76
v_mfma_f32_32x32x16_bf16 v[32:47], a[204:207], a[88:91], v[32:47]
ds_read_b64_tr_b16 a[244:245], v23 offset:28672
ds_read_b64_tr_b16 a[246:247], v23 offset:30720
v_exp_f32 v78, v78
v_add_f32 v26, v26, v77
v_cvt_pk_bf16_f32 v74, v76, v77
v_mfma_f32_32x32x16_bf16 v[48:63], a[204:207], a[92:95], v[48:63]
ds_read_b64_tr_b16 a[248:249], v24 offset:28672
ds_read_b64_tr_b16 a[250:251], v24 offset:30720
v_exp_f32 v79, v79
v_add_f32 v26, v26, v78
v_add_f32 v26, v26, v79
v_mfma_f32_32x32x16_bf16 v[32:47], a[208:211], a[96:99], v[32:47]
ds_read_b64_tr_b16 a[252:253], v25 offset:28672
s_waitcnt lgkmcnt(14)
ds_read_b64_tr_b16 a[254:255], v25 offset:30720
v_cvt_pk_bf16_f32 v75, v78, v79
v_exp_f32 v88, v88
v_and_b32 v108, 63, v0
v_mfma_f32_32x32x16_bf16 v[48:63], a[208:211], a[100:103], v[48:63]
v_exp_f32 v89, v89
v_add_f32 v28, v28, v88
v_exp_f32 v90, v90
v_add_f32 v28, v28, v89
v_mfma_f32_32x32x16_bf16 v[32:47], a[212:215], a[104:107], v[32:47]
v_cvt_pk_bf16_f32 v88, v88, v89
v_exp_f32 v91, v91
v_add_f32 v28, v28, v90
v_exp_f32 v92, v92
v_mfma_f32_32x32x16_bf16 v[48:63], a[212:215], a[108:111], v[48:63]
v_min_u32 v108, 19, v108
v_add_f32 v28, v28, v91
v_cvt_pk_bf16_f32 v89, v90, v91
v_exp_f32 v93, v93
v_mul_u32_u24 v108, 3456, v108
v_mfma_f32_32x32x16_bf16 v[32:47], a[216:219], a[112:115], v[32:47]
v_add_f32 v28, v28, v92
v_exp_f32 v94, v94
v_add_f32 v28, v28, v93
v_cvt_pk_bf16_f32 v90, v92, v93
v_mfma_f32_32x32x16_bf16 v[48:63], a[216:219], a[116:119], v[48:63]
v_exp_f32 v95, v95
v_add_f32 v28, v28, v94
v_add_f32 v28, v28, v95
v_cvt_pk_bf16_f32 v91, v94, v95
v_mfma_f32_32x32x16_bf16 v[32:47], a[220:223], a[120:123], v[32:47]
v_mfma_f32_32x32x16_bf16 v[48:63], a[220:223], a[124:127], v[48:63]
s_waitcnt lgkmcnt(8)
v_mfma_f32_32x32x16_bf16 v[128:143], a[224:227], v[64:67], v[128:143]
ds_read_b128 a[192:195], v14 offset:40960
s_add_u32 m0, s52, 0
s_add_u32 s38, s45, 0
v_mfma_f32_32x32x16_bf16 v[192:207], a[224:227], v[80:83], v[192:207]
buffer_load_dwordx4 v8, s[28:31], s38 offen offset:0 nt lds
ds_read_b128 a[196:199], v15 offset:40960
s_add_u32 s39, s45, 9216
v_mfma_f32_32x32x16_bf16 v[144:159], a[228:231], v[64:67], v[144:159]
ds_read_b128 a[200:203], v16 offset:40960
ds_read_b128 a[204:207], v17 offset:40960
v_mfma_f32_32x32x16_bf16 v[208:223], a[228:231], v[80:83], v[208:223]
buffer_load_dwordx4 v8, s[28:31], s39 offen offset:1024 nt lds
ds_read_b128 a[208:211], v18 offset:40960
s_add_u32 s38, s45, 18432
v_exp_f32 v32, v32
v_mfma_f32_32x32x16_bf16 v[160:175], a[232:235], v[64:67], v[160:175]
ds_read_b128 a[212:215], v19 offset:40960
ds_read_b128 a[216:219], v20 offset:40960
v_exp_f32 v33, v33
v_add_f32 v26, v26, v32
v_mfma_f32_32x32x16_bf16 v[224:239], a[232:235], v[80:83], v[224:239]
s_waitcnt lgkmcnt(14)
ds_read_b128 a[220:223], v21 offset:40960
v_exp_f32 v34, v34
v_add_f32 v26, v26, v33
v_cvt_pk_bf16_f32 v32, v32, v33
v_mfma_f32_32x32x16_bf16 v[176:191], a[236:239], v[64:67], v[176:191]
buffer_load_dwordx4 v8, s[28:31], s38 offen offset:2048 nt lds
s_add_u32 s39, s45, 27648
v_exp_f32 v35, v35
v_add_f32 v26, v26, v34
v_mfma_f32_32x32x16_bf16 v[240:255], a[236:239], v[80:83], v[240:255]
s_waitcnt lgkmcnt(8)
v_exp_f32 v36, v36
v_add_f32 v26, v26, v35
v_cvt_pk_bf16_f32 v33, v34, v35
v_exp_f32 v37, v37
v_mfma_f32_32x32x16_bf16 v[128:143], a[240:243], v[72:75], v[128:143]
v_add_f32 v26, v26, v36
v_exp_f32 v38, v38
v_add_f32 v26, v26, v37
v_cvt_pk_bf16_f32 v34, v36, v37
v_mfma_f32_32x32x16_bf16 v[192:207], a[240:243], v[88:91], v[192:207]
v_exp_f32 v39, v39
v_add_f32 v26, v26, v38
v_add_f32 v26, v26, v39
v_cvt_pk_bf16_f32 v35, v38, v39
v_mfma_f32_32x32x16_bf16 v[144:159], a[244:247], v[72:75], v[144:159]
buffer_load_dwordx4 v8, s[28:31], s39 offen offset:3072 nt lds
v_exp_f32 v48, v48
v_exp_f32 v49, v49
v_mfma_f32_32x32x16_bf16 v[208:223], a[244:247], v[88:91], v[208:223]
v_add_f32 v28, v28, v48
v_exp_f32 v50, v50
v_add_f32 v28, v28, v49
v_cvt_pk_bf16_f32 v48, v48, v49
v_mfma_f32_32x32x16_bf16 v[160:175], a[248:251], v[72:75], v[160:175]
v_exp_f32 v51, v51
v_add_f32 v28, v28, v50
v_exp_f32 v52, v52
v_add_f32 v28, v28, v51
v_mfma_f32_32x32x16_bf16 v[224:239], a[248:251], v[88:91], v[224:239]
v_cvt_pk_bf16_f32 v49, v50, v51
v_exp_f32 v53, v53
v_add_f32 v28, v28, v52
v_exp_f32 v54, v54
v_mfma_f32_32x32x16_bf16 v[176:191], a[252:255], v[72:75], v[176:191]
v_add_f32 v28, v28, v53
v_cvt_pk_bf16_f32 v50, v52, v53
v_exp_f32 v55, v55
v_add_f32 v28, v28, v54
v_add_f32 v28, v28, v55
v_mfma_f32_32x32x16_bf16 v[240:255], a[252:255], v[88:91], v[240:255]
s_waitcnt lgkmcnt(0)
v_cvt_pk_bf16_f32 v51, v54, v55
v_mfma_f32_32x32x16_bf16 v[64:79], a[192:195], a[64:67], 0
s_waitcnt vmcnt(20)
s_barrier
s_lshl_b32 s56, s61, 2
s_add_u32 s56, s56, s36
s_mul_i32 s56, s56, 69120
v_exp_f32 v40, v40
v_mfma_f32_32x32x16_bf16 v[80:95], a[192:195], a[68:71], 0
buffer_load_dword v109, v108, s[12:15], s56 offen
ds_read_b64_tr_b16 a[224:225], v22 offset:49152
v_exp_f32 v41, v41
v_add_f32 v26, v26, v40
v_mfma_f32_32x32x16_bf16 v[64:79], a[196:199], a[72:75], v[64:79]
ds_read_b64_tr_b16 a[226:227], v22 offset:51200
ds_read_b64_tr_b16 a[228:229], v23 offset:49152
v_exp_f32 v42, v42
v_xor_b32 v14, 0x10000, v14
v_add_f32 v26, v26, v41
v_mfma_f32_32x32x16_bf16 v[80:95], a[196:199], a[76:79], v[80:95]
ds_read_b64_tr_b16 a[230:231], v23 offset:51200
ds_read_b64_tr_b16 a[232:233], v24 offset:49152
v_cvt_pk_bf16_f32 v40, v40, v41
v_exp_f32 v43, v43
v_xor_b32 v15, 0x10000, v15
v_mfma_f32_32x32x16_bf16 v[64:79], a[200:203], a[80:83], v[64:79]
ds_read_b64_tr_b16 a[234:235], v24 offset:51200
ds_read_b64_tr_b16 a[236:237], v25 offset:49152
v_add_f32 v26, v26, v42
v_exp_f32 v44, v44
v_add_f32 v26, v26, v43
v_mfma_f32_32x32x16_bf16 v[80:95], a[200:203], a[84:87], v[80:95]
ds_read_b64_tr_b16 a[238:239], v25 offset:51200
ds_read_b64_tr_b16 a[240:241], v22 offset:53248
v_xor_b32 v16, 0x10000, v16
v_cvt_pk_bf16_f32 v41, v42, v43
v_exp_f32 v45, v45
v_mfma_f32_32x32x16_bf16 v[64:79], a[204:207], a[88:91], v[64:79]
buffer_load_dword v107, v108, s[16:19], s56 offen
ds_read_b64_tr_b16 a[242:243], v22 offset:55296
v_add_f32 v26, v26, v44
v_xor_b32 v17, 0x10000, v17
v_xor_b32 v18, 0x10000, v18
v_mfma_f32_32x32x16_bf16 v[80:95], a[204:207], a[92:95], v[80:95]
ds_read_b64_tr_b16 a[244:245], v23 offset:53248
ds_read_b64_tr_b16 a[246:247], v23 offset:55296
v_exp_f32 v46, v46
v_add_f32 v26, v26, v45
v_cvt_pk_bf16_f32 v42, v44, v45
v_mfma_f32_32x32x16_bf16 v[64:79], a[208:211], a[96:99], v[64:79]
ds_read_b64_tr_b16 a[248:249], v24 offset:53248
ds_read_b64_tr_b16 a[250:251], v24 offset:55296
v_exp_f32 v47, v47
v_add_f32 v26, v26, v46
v_add_f32 v26, v26, v47
v_mfma_f32_32x32x16_bf16 v[80:95], a[208:211], a[100:103], v[80:95]
ds_read_b64_tr_b16 a[252:253], v25 offset:53248
s_waitcnt lgkmcnt(14)
ds_read_b64_tr_b16 a[254:255], v25 offset:55296
v_cvt_pk_bf16_f32 v43, v46, v47
v_xor_b32 v19, 0x10000, v19
v_exp_f32 v56, v56
v_mfma_f32_32x32x16_bf16 v[64:79], a[212:215], a[104:107], v[64:79]
v_exp_f32 v57, v57
v_add_f32 v28, v28, v56
v_xor_b32 v20, 0x10000, v20
v_exp_f32 v58, v58
v_mfma_f32_32x32x16_bf16 v[80:95], a[212:215], a[108:111], v[80:95]
v_add_f32 v28, v28, v57
v_cvt_pk_bf16_f32 v56, v56, v57
v_xor_b32 v21, 0x10000, v21
v_exp_f32 v59, v59
v_add_f32 v28, v28, v58
v_mfma_f32_32x32x16_bf16 v[64:79], a[216:219], a[112:115], v[64:79]
v_exp_f32 v60, v60
v_add_f32 v28, v28, v59
v_cvt_pk_bf16_f32 v57, v58, v59
v_exp_f32 v61, v61
v_mfma_f32_32x32x16_bf16 v[80:95], a[216:219], a[116:119], v[80:95]
v_add_f32 v28, v28, v60
v_exp_f32 v62, v62
v_add_f32 v28, v28, v61
v_cvt_pk_bf16_f32 v58, v60, v61
v_mfma_f32_32x32x16_bf16 v[64:79], a[220:223], a[120:123], v[64:79]
v_exp_f32 v63, v63
v_add_f32 v28, v28, v62
v_add_f32 v28, v28, v63
v_cvt_pk_bf16_f32 v59, v62, v63
v_mfma_f32_32x32x16_bf16 v[80:95], a[220:223], a[124:127], v[80:95]
s_waitcnt lgkmcnt(8)
v_mfma_f32_32x32x16_bf16 v[128:143], a[224:227], v[32:35], v[128:143]
ds_read_b128 a[192:195], v14 offset:0
s_add_u32 m0, s37, 16384
s_mov_b32 s38, 65536
v_mfma_f32_32x32x16_bf16 v[192:207], a[224:227], v[48:51], v[192:207]
buffer_load_dwordx4 v13, s[24:27], s38 offen offset:0  lds
ds_read_b128 a[196:199], v15 offset:0
v_mfma_f32_32x32x16_bf16 v[144:159], a[228:231], v[32:35], v[144:159]
ds_read_b128 a[200:203], v16 offset:0
ds_read_b128 a[204:207], v17 offset:0
v_mfma_f32_32x32x16_bf16 v[208:223], a[228:231], v[48:51], v[208:223]
buffer_load_dwordx4 v13, s[24:27], s38 offen offset:1024  lds
ds_read_b128 a[208:211], v18 offset:0
v_exp_f32 v64, v64
v_mfma_f32_32x32x16_bf16 v[160:175], a[232:235], v[32:35], v[160:175]
ds_read_b128 a[212:215], v19 offset:0
ds_read_b128 a[216:219], v20 offset:0
v_exp_f32 v65, v65
v_add_f32 v26, v26, v64
v_mfma_f32_32x32x16_bf16 v[224:239], a[232:235], v[48:51], v[224:239]
s_waitcnt lgkmcnt(14)
ds_read_b128 a[220:223], v21 offset:0
v_exp_f32 v66, v66
v_add_f32 v26, v26, v65
v_cvt_pk_bf16_f32 v64, v64, v65
v_mfma_f32_32x32x16_bf16 v[176:191], a[236:239], v[32:35], v[176:191]
buffer_load_dwordx4 v13, s[24:27], s38 offen offset:2048  lds
v_exp_f32 v67, v67
v_add_f32 v26, v26, v66
v_mfma_f32_32x32x16_bf16 v[240:255], a[236:239], v[48:51], v[240:255]
s_waitcnt lgkmcnt(8)
v_exp_f32 v68, v68
v_add_f32 v26, v26, v67
v_cvt_pk_bf16_f32 v65, v66, v67
v_exp_f32 v69, v69
v_mfma_f32_32x32x16_bf16 v[128:143], a[240:243], v[40:43], v[128:143]
v_add_f32 v26, v26, v68
v_exp_f32 v70, v70
v_add_f32 v26, v26, v69
v_cvt_pk_bf16_f32 v66, v68, v69
v_mfma_f32_32x32x16_bf16 v[192:207], a[240:243], v[56:59], v[192:207]
v_exp_f32 v71, v71
v_add_f32 v26, v26, v70
v_add_f32 v26, v26, v71
v_cvt_pk_bf16_f32 v67, v70, v71
v_mfma_f32_32x32x16_bf16 v[144:159], a[244:247], v[40:43], v[144:159]
buffer_load_dwordx4 v13, s[24:27], s38 offen offset:3072  lds
v_exp_f32 v80, v80
v_exp_f32 v81, v81
v_mfma_f32_32x32x16_bf16 v[208:223], a[244:247], v[56:59], v[208:223]
s_add_u32 m0, s37, 32768
s_mov_b32 s39, 81920
v_add_f32 v28, v28, v80
v_exp_f32 v82, v82
v_add_f32 v28, v28, v81
v_cvt_pk_bf16_f32 v80, v80, v81
v_mfma_f32_32x32x16_bf16 v[160:175], a[248:251], v[40:43], v[160:175]
v_exp_f32 v83, v83
v_add_f32 v28, v28, v82
v_exp_f32 v84, v84
v_add_f32 v28, v28, v83
v_mfma_f32_32x32x16_bf16 v[224:239], a[248:251], v[56:59], v[224:239]
buffer_load_dwordx4 v9, s[20:23], s39 offen offset:0  lds
v_cvt_pk_bf16_f32 v81, v82, v83
v_exp_f32 v85, v85
v_add_f32 v28, v28, v84
v_mfma_f32_32x32x16_bf16 v[176:191], a[252:255], v[40:43], v[176:191]
v_exp_f32 v86, v86
v_add_f32 v28, v28, v85
v_cvt_pk_bf16_f32 v82, v84, v85
v_exp_f32 v87, v87
v_mfma_f32_32x32x16_bf16 v[240:255], a[252:255], v[56:59], v[240:255]
s_waitcnt lgkmcnt(0)
v_add_f32 v28, v28, v86
v_add_f32 v28, v28, v87
v_cvt_pk_bf16_f32 v83, v86, v87
v_mfma_f32_32x32x16_bf16 v[32:47], a[192:195], a[64:67], 0
buffer_load_dwordx4 v10, s[20:23], s39 offen offset:1024  lds
ds_read_b64_tr_b16 a[224:225], v22 offset:57344
v_exp_f32 v72, v72
v_mfma_f32_32x32x16_bf16 v[48:63], a[192:195], a[68:71], 0
ds_read_b64_tr_b16 a[226:227], v22 offset:59392
ds_read_b64_tr_b16 a[228:229], v23 offset:57344
v_exp_f32 v73, v73
v_add_f32 v26, v26, v72
v_mfma_f32_32x32x16_bf16 v[32:47], a[196:199], a[72:75], v[32:47]
ds_read_b64_tr_b16 a[230:231], v23 offset:59392
ds_read_b64_tr_b16 a[232:233], v24 offset:57344
v_exp_f32 v74, v74
v_add_f32 v26, v26, v73
v_cvt_pk_bf16_f32 v72, v72, v73
v_mfma_f32_32x32x16_bf16 v[48:63], a[196:199], a[76:79], v[48:63]
buffer_load_dwordx4 v11, s[20:23], s39 offen offset:2048  lds
ds_read_b64_tr_b16 a[234:235], v24 offset:59392
v_exp_f32 v75, v75
v_add_f32 v26, v26, v74
v_mfma_f32_32x32x16_bf16 v[32:47], a[200:203], a[80:83], v[32:47]
ds_read_b64_tr_b16 a[236:237], v25 offset:57344
ds_read_b64_tr_b16 a[238:239], v25 offset:59392
v_exp_f32 v76, v76
v_add_f32 v26, v26, v75
v_cvt_pk_bf16_f32 v73, v74, v75
v_mfma_f32_32x32x16_bf16 v[48:63], a[200:203], a[84:87], v[48:63]
ds_read_b64_tr_b16 a[240:241], v22 offset:61440
ds_read_b64_tr_b16 a[242:243], v22 offset:63488
v_exp_f32 v77, v77
v_add_f32 v26, v26, v76
v_mfma_f32_32x32x16_bf16 v[32:47], a[204:207], a[88:91], v[32:47]
buffer_load_dwordx4 v12, s[20:23], s39 offen offset:3072  lds
ds_read_b64_tr_b16 a[244:245], v23 offset:61440
v_exp_f32 v78, v78
v_add_f32 v26, v26, v77
v_mfma_f32_32x32x16_bf16 v[48:63], a[204:207], a[92:95], v[48:63]
ds_read_b64_tr_b16 a[246:247], v23 offset:63488
ds_read_b64_tr_b16 a[248:249], v24 offset:61440
v_cvt_pk_bf16_f32 v74, v76, v77
v_exp_f32 v79, v79
v_add_f32 v26, v26, v78
v_mfma_f32_32x32x16_bf16 v[32:47], a[208:211], a[96:99], v[32:47]
ds_read_b64_tr_b16 a[250:251], v24 offset:63488
ds_read_b64_tr_b16 a[252:253], v25 offset:61440
v_add_f32 v26, v26, v79
v_cvt_pk_bf16_f32 v75, v78, v79
v_exp_f32 v88, v88
v_mfma_f32_32x32x16_bf16 v[48:63], a[208:211], a[100:103], v[48:63]
s_waitcnt lgkmcnt(14)
ds_read_b64_tr_b16 a[254:255], v25 offset:63488
v_exp_f32 v89, v89
v_add_f32 v28, v28, v88
v_exp_f32 v90, v90
v_mfma_f32_32x32x16_bf16 v[32:47], a[212:215], a[104:107], v[32:47]
v_add_f32 v28, v28, v89
v_cvt_pk_bf16_f32 v88, v88, v89
v_exp_f32 v91, v91
v_add_f32 v28, v28, v90
v_mfma_f32_32x32x16_bf16 v[48:63], a[212:215], a[108:111], v[48:63]
v_exp_f32 v92, v92
v_add_f32 v28, v28, v91
v_cvt_pk_bf16_f32 v89, v90, v91
v_exp_f32 v93, v93
v_mfma_f32_32x32x16_bf16 v[32:47], a[216:219], a[112:115], v[32:47]
v_add_f32 v28, v28, v92
v_exp_f32 v94, v94
v_add_f32 v28, v28, v93
v_cvt_pk_bf16_f32 v90, v92, v93
v_mfma_f32_32x32x16_bf16 v[48:63], a[216:219], a[116:119], v[48:63]
v_exp_f32 v95, v95
v_add_f32 v28, v28, v94
v_add_f32 v28, v28, v95
v_cvt_pk_bf16_f32 v91, v94, v95
v_mfma_f32_32x32x16_bf16 v[32:47], a[220:223], a[120:123], v[32:47]
v_mfma_f32_32x32x16_bf16 v[48:63], a[220:223], a[124:127], v[48:63]
s_waitcnt lgkmcnt(8)
v_mfma_f32_32x32x16_bf16 v[128:143], a[224:227], v[64:67], v[128:143]
ds_read_b128 a[192:195], v14 offset:8192
s_add_u32 m0, s52, 4096
s_add_u32 s38, s46, 0
v_mfma_f32_32x32x16_bf16 v[192:207], a[224:227], v[80:83], v[192:207]
buffer_load_dwordx4 v8, s[32:35], s38 offen offset:0 nt lds
ds_read_b128 a[196:199], v15 offset:8192
s_add_u32 s39, s46, 9216
v_xor_b32 v22, 0x10000, v22
v_mfma_f32_32x32x16_bf16 v[144:159], a[228:231], v[64:67], v[144:159]
ds_read_b128 a[200:203], v16 offset:8192
ds_read_b128 a[204:207], v17 offset:8192
v_xor_b32 v23, 0x10000, v23
v_mfma_f32_32x32x16_bf16 v[208:223], a[228:231], v[80:83], v[208:223]
buffer_load_dwordx4 v8, s[32:35], s39 offen offset:1024 nt lds
ds_read_b128 a[208:211], v18 offset:8192
v_xor_b32 v24, 0x10000, v24
v_exp_f32 v32, v32
v_mfma_f32_32x32x16_bf16 v[160:175], a[232:235], v[64:67], v[160:175]
ds_read_b128 a[212:215], v19 offset:8192
ds_read_b128 a[216:219], v20 offset:8192
v_exp_f32 v33, v33
v_add_f32 v26, v26, v32
v_xor_b32 v25, 0x10000, v25
v_mfma_f32_32x32x16_bf16 v[224:239], a[232:235], v[80:83], v[224:239]
s_waitcnt lgkmcnt(14)
ds_read_b128 a[220:223], v21 offset:8192
s_add_u32 s38, s46, 18432
v_exp_f32 v34, v34
v_add_f32 v26, v26, v33
v_cvt_pk_bf16_f32 v32, v32, v33
v_mfma_f32_32x32x16_bf16 v[176:191], a[236:239], v[64:67], v[176:191]
buffer_load_dwordx4 v8, s[32:35], s38 offen offset:2048 nt lds
s_add_u32 s39, s46, 27648
v_exp_f32 v35, v35
v_add_f32 v26, v26, v34
v_mfma_f32_32x32x16_bf16 v[240:255], a[236:239], v[80:83], v[240:255]
s_waitcnt lgkmcnt(8)
v_exp_f32 v36, v36
v_add_f32 v26, v26, v35
v_cvt_pk_bf16_f32 v33, v34, v35
v_exp_f32 v37, v37
v_mfma_f32_32x32x16_bf16 v[128:143], a[240:243], v[72:75], v[128:143]
v_add_f32 v26, v26, v36
v_exp_f32 v38, v38
v_add_f32 v26, v26, v37
v_cvt_pk_bf16_f32 v34, v36, v37
v_mfma_f32_32x32x16_bf16 v[192:207], a[240:243], v[88:91], v[192:207]
v_exp_f32 v39, v39
v_add_f32 v26, v26, v38
v_add_f32 v26, v26, v39
v_cvt_pk_bf16_f32 v35, v38, v39
v_mfma_f32_32x32x16_bf16 v[144:159], a[244:247], v[72:75], v[144:159]
buffer_load_dwordx4 v8, s[32:35], s39 offen offset:3072 nt lds
v_exp_f32 v48, v48
v_exp_f32 v49, v49
v_mfma_f32_32x32x16_bf16 v[208:223], a[244:247], v[88:91], v[208:223]
v_add_f32 v28, v28, v48
v_exp_f32 v50, v50
v_add_f32 v28, v28, v49
v_cvt_pk_bf16_f32 v48, v48, v49
v_mfma_f32_32x32x16_bf16 v[160:175], a[248:251], v[72:75], v[160:175]
v_exp_f32 v51, v51
v_add_f32 v28, v28, v50
v_exp_f32 v52, v52
v_add_f32 v28, v28, v51
v_mfma_f32_32x32x16_bf16 v[224:239], a[248:251], v[88:91], v[224:239]
v_cvt_pk_bf16_f32 v49, v50, v51
v_exp_f32 v53, v53
v_add_f32 v28, v28, v52
v_exp_f32 v54, v54
v_mfma_f32_32x32x16_bf16 v[176:191], a[252:255], v[72:75], v[176:191]
v_add_f32 v28, v28, v53
v_cvt_pk_bf16_f32 v50, v52, v53
v_exp_f32 v55, v55
v_add_f32 v28, v28, v54
v_add_f32 v28, v28, v55
v_mfma_f32_32x32x16_bf16 v[240:255], a[252:255], v[88:91], v[240:255]
s_waitcnt lgkmcnt(0)
v_cvt_pk_bf16_f32 v51, v54, v55
v_mfma_f32_32x32x16_bf16 v[64:79], a[192:195], a[64:67], 0
s_waitcnt vmcnt(26)
s_barrier
v_exp_f32 v40, v40
v_mfma_f32_32x32x16_bf16 v[80:95], a[192:195], a[68:71], 0
ds_read_b64_tr_b16 a[224:225], v22 offset:16384
v_exp_f32 v41, v41
v_add_f32 v26, v26, v40
v_exp_f32 v42, v42
v_mfma_f32_32x32x16_bf16 v[64:79], a[196:199], a[72:75], v[64:79]
ds_read_b64_tr_b16 a[226:227], v22 offset:18432
ds_read_b64_tr_b16 a[228:229], v23 offset:16384
v_add_f32 v26, v26, v41
v_cvt_pk_bf16_f32 v40, v40, v41
v_exp_f32 v43, v43
v_mfma_f32_32x32x16_bf16 v[80:95], a[196:199], a[76:79], v[80:95]
ds_read_b64_tr_b16 a[230:231], v23 offset:18432
ds_read_b64_tr_b16 a[232:233], v24 offset:16384
v_add_f32 v26, v26, v42
v_exp_f32 v44, v44
v_add_f32 v26, v26, v43
v_mfma_f32_32x32x16_bf16 v[64:79], a[200:203], a[80:83], v[64:79]
ds_read_b64_tr_b16 a[234:235], v24 offset:18432
ds_read_b64_tr_b16 a[236:237], v25 offset:16384
v_cvt_pk_bf16_f32 v41, v42, v43
v_exp_f32 v45, v45
v_add_f32 v26, v26, v44
v_mfma_f32_32x32x16_bf16 v[80:95], a[200:203], a[84:87], v[80:95]
ds_read_b64_tr_b16 a[238:239], v25 offset:18432
ds_read_b64_tr_b16 a[240:241], v22 offset:20480
v_exp_f32 v46, v46
v_add_f32 v26, v26, v45
v_cvt_pk_bf16_f32 v42, v44, v45
v_mfma_f32_32x32x16_bf16 v[64:79], a[204:207], a[88:91], v[64:79]
ds_read_b64_tr_b16 a[242:243], v22 offset:22528
ds_read_b64_tr_b16 a[244:245], v23 offset:20480
v_exp_f32 v47, v47
v_add_f32 v26, v26, v46
v_add_f32 v26, v26, v47
v_mfma_f32_32x32x16_bf16 v[80:95], a[204:207], a[92:95], v[80:95]
ds_read_b64_tr_b16 a[246:247], v23 offset:22528
ds_read_b64_tr_b16 a[248:249], v24 offset:20480
v_cvt_pk_bf16_f32 v43, v46, v47
v_exp_f32 v56, v56
v_mfma_f32_32x32x16_bf16 v[64:79], a[208:211], a[96:99], v[64:79]
ds_read_b64_tr_b16 a[250:251], v24 offset:22528
ds_read_b64_tr_b16 a[252:253], v25 offset:20480
v_exp_f32 v57, v57
v_add_f32 v28, v28, v56
v_mfma_f32_32x32x16_bf16 v[80:95], a[208:211], a[100:103], v[80:95]
s_waitcnt lgkmcnt(14)
ds_read_b64_tr_b16 a[254:255], v25 offset:22528
v_exp_f32 v58, v58
v_add_f32 v28, v28, v57
v_cvt_pk_bf16_f32 v56, v56, v57
v_mfma_f32_32x32x16_bf16 v[64:79], a[212:215], a[104:107], v[64:79]
v_exp_f32 v59, v59
v_add_f32 v28, v28, v58
v_exp_f32 v60, v60
v_add_f32 v28, v28, v59
v_mfma_f32_32x32x16_bf16 v[80:95], a[212:215], a[108:111], v[80:95]
v_cvt_pk_bf16_f32 v57, v58, v59
v_exp_f32 v61, v61
v_add_f32 v28, v28, v60
v_exp_f32 v62, v62
v_mfma_f32_32x32x16_bf16 v[64:79], a[216:219], a[112:115], v[64:79]
v_add_f32 v28, v28, v61
v_cvt_pk_bf16_f32 v58, v60, v61
v_exp_f32 v63, v63
v_add_f32 v28, v28, v62
v_add_f32 v28, v28, v63
v_mfma_f32_32x32x16_bf16 v[80:95], a[216:219], a[116:119], v[80:95]
v_cvt_pk_bf16_f32 v59, v62, v63
v_mfma_f32_32x32x16_bf16 v[64:79], a[220:223], a[120:123], v[64:79]
v_mfma_f32_32x32x16_bf16 v[80:95], a[220:223], a[124:127], v[80:95]
s_waitcnt lgkmcnt(8)
v_mfma_f32_32x32x16_bf16 v[128:143], a[224:227], v[32:35], v[128:143]
ds_read_b128 a[192:195], v14 offset:32768
s_add_u32 m0, s37, 49152
s_mov_b32 s38, 81920
v_mfma_f32_32x32x16_bf16 v[192:207], a[224:227], v[48:51], v[192:207]
buffer_load_dwordx4 v13, s[24:27], s38 offen offset:0  lds
ds_read_b128 a[196:199], v15 offset:32768
v_mfma_f32_32x32x16_bf16 v[144:159], a[228:231], v[32:35], v[144:159]
ds_read_b128 a[200:203], v16 offset:32768
ds_read_b128 a[204:207], v17 offset:32768
v_mfma_f32_32x32x16_bf16 v[208:223], a[228:231], v[48:51], v[208:223]
buffer_load_dwordx4 v13, s[24:27], s38 offen offset:1024  lds
ds_read_b128 a[208:211], v18 offset:32768
v_exp_f32 v64, v64
v_mfma_f32_32x32x16_bf16 v[160:175], a[232:235], v[32:35], v[160:175]
ds_read_b128 a[212:215], v19 offset:32768
ds_read_b128 a[216:219], v20 offset:32768
v_exp_f32 v65, v65
v_add_f32 v26, v26, v64
v_mfma_f32_32x32x16_bf16 v[224:239], a[232:235], v[48:51], v[224:239]
s_waitcnt lgkmcnt(14)
ds_read_b128 a[220:223], v21 offset:32768
v_exp_f32 v66, v66
v_add_f32 v26, v26, v65
v_cvt_pk_bf16_f32 v64, v64, v65
v_mfma_f32_32x32x16_bf16 v[176:191], a[236:239], v[32:35], v[176:191]
buffer_load_dwordx4 v13, s[24:27], s38 offen offset:2048  lds
v_exp_f32 v67, v67
v_add_f32 v26, v26, v66
v_mfma_f32_32x32x16_bf16 v[240:255], a[236:239], v[48:51], v[240:255]
s_waitcnt lgkmcnt(8)
v_exp_f32 v68, v68
v_add_f32 v26, v26, v67
v_cvt_pk_bf16_f32 v65, v66, v67
v_exp_f32 v69, v69
v_mfma_f32_32x32x16_bf16 v[128:143], a[240:243], v[40:43], v[128:143]
v_add_f32 v26, v26, v68
v_exp_f32 v70, v70
v_add_f32 v26, v26, v69
v_cvt_pk_bf16_f32 v66, v68, v69
v_mfma_f32_32x32x16_bf16 v[192:207], a[240:243], v[56:59], v[192:207]
v_exp_f32 v71, v71
v_add_f32 v26, v26, v70
v_add_f32 v26, v26, v71
v_cvt_pk_bf16_f32 v67, v70, v71
v_mfma_f32_32x32x16_bf16 v[144:159], a[244:247], v[40:43], v[144:159]
buffer_load_dwordx4 v13, s[24:27], s38 offen offset:3072  lds
v_exp_f32 v80, v80
v_exp_f32 v81, v81
v_mfma_f32_32x32x16_bf16 v[208:223], a[244:247], v[56:59], v[208:223]
s_add_u32 m0, s37, 65536
s_mov_b32 s39, 98304
v_add_f32 v28, v28, v80
v_exp_f32 v82, v82
v_add_f32 v28, v28, v81
v_cvt_pk_bf16_f32 v80, v80, v81
v_mfma_f32_32x32x16_bf16 v[160:175], a[248:251], v[40:43], v[160:175]
v_exp_f32 v83, v83
v_add_f32 v28, v28, v82
v_exp_f32 v84, v84
v_add_f32 v28, v28, v83
v_mfma_f32_32x32x16_bf16 v[224:239], a[248:251], v[56:59], v[224:239]
buffer_load_dwordx4 v9, s[20:23], s39 offen offset:0  lds
v_cvt_pk_bf16_f32 v81, v82, v83
v_exp_f32 v85, v85
v_add_f32 v28, v28, v84
v_mfma_f32_32x32x16_bf16 v[176:191], a[252:255], v[40:43], v[176:191]
v_exp_f32 v86, v86
v_add_f32 v28, v28, v85
v_cvt_pk_bf16_f32 v82, v84, v85
v_exp_f32 v87, v87
v_mfma_f32_32x32x16_bf16 v[240:255], a[252:255], v[56:59], v[240:255]
s_waitcnt lgkmcnt(0)
v_add_f32 v28, v28, v86
v_add_f32 v28, v28, v87
v_cvt_pk_bf16_f32 v83, v86, v87
v_mfma_f32_32x32x16_bf16 v[32:47], a[192:195], a[64:67], 0
buffer_load_dwordx4 v10, s[20:23], s39 offen offset:1024  lds
ds_read_b64_tr_b16 a[224:225], v22 offset:24576
v_exp_f32 v72, v72
v_mfma_f32_32x32x16_bf16 v[48:63], a[192:195], a[68:71], 0
ds_read_b64_tr_b16 a[226:227], v22 offset:26624
ds_read_b64_tr_b16 a[228:229], v23 offset:24576
v_exp_f32 v73, v73
v_add_f32 v26, v26, v72
v_mfma_f32_32x32x16_bf16 v[32:47], a[196:199], a[72:75], v[32:47]
ds_read_b64_tr_b16 a[230:231], v23 offset:26624
ds_read_b64_tr_b16 a[232:233], v24 offset:24576
v_exp_f32 v74, v74
v_add_f32 v26, v26, v73
v_cvt_pk_bf16_f32 v72, v72, v73
v_mfma_f32_32x32x16_bf16 v[48:63], a[196:199], a[76:79], v[48:63]
buffer_load_dwordx4 v11, s[20:23], s39 offen offset:2048  lds
ds_read_b64_tr_b16 a[234:235], v24 offset:26624
v_exp_f32 v75, v75
v_add_f32 v26, v26, v74
v_mfma_f32_32x32x16_bf16 v[32:47], a[200:203], a[80:83], v[32:47]
ds_read_b64_tr_b16 a[236:237], v25 offset:24576
ds_read_b64_tr_b16 a[238:239], v25 offset:26624
v_exp_f32 v76, v76
v_add_f32 v26, v26, v75
v_cvt_pk_bf16_f32 v73, v74, v75
v_mfma_f32_32x32x16_bf16 v[48:63], a[200:203], a[84:87], v[48:63]
ds_read_b64_tr_b16 a[240:241], v22 offset:28672
ds_read_b64_tr_b16 a[242:243], v22 offset:30720
v_exp_f32 v77, v77
v_add_f32 v26, v26, v76
v_mfma_f32_32x32x16_bf16 v[32:47], a[204:207], a[88:91], v[32:47]
buffer_load_dwordx4 v12, s[20:23], s39 offen offset:3072  lds
ds_read_b64_tr_b16 a[244:245], v23 offset:28672
v_exp_f32 v78, v78
v_add_f32 v26, v26, v77
v_mfma_f32_32x32x16_bf16 v[48:63], a[204:207], a[92:95], v[48:63]
ds_read_b64_tr_b16 a[246:247], v23 offset:30720
ds_read_b64_tr_b16 a[248:249], v24 offset:28672
v_cvt_pk_bf16_f32 v74, v76, v77
v_exp_f32 v79, v79
v_add_f32 v26, v26, v78
v_mfma_f32_32x32x16_bf16 v[32:47], a[208:211], a[96:99], v[32:47]
ds_read_b64_tr_b16 a[250:251], v24 offset:30720
ds_read_b64_tr_b16 a[252:253], v25 offset:28672
v_add_f32 v26, v26, v79
v_cvt_pk_bf16_f32 v75, v78, v79
v_exp_f32 v88, v88
v_mfma_f32_32x32x16_bf16 v[48:63], a[208:211], a[100:103], v[48:63]
s_waitcnt lgkmcnt(14)
ds_read_b64_tr_b16 a[254:255], v25 offset:30720
v_exp_f32 v89, v89
v_add_f32 v28, v28, v88
v_exp_f32 v90, v90
v_mfma_f32_32x32x16_bf16 v[32:47], a[212:215], a[104:107], v[32:47]
v_add_f32 v28, v28, v89
v_cvt_pk_bf16_f32 v88, v88, v89
v_exp_f32 v91, v91
v_add_f32 v28, v28, v90
v_mfma_f32_32x32x16_bf16 v[48:63], a[212:215], a[108:111], v[48:63]
v_exp_f32 v92, v92
v_add_f32 v28, v28, v91
v_cvt_pk_bf16_f32 v89, v90, v91
v_exp_f32 v93, v93
v_mfma_f32_32x32x16_bf16 v[32:47], a[216:219], a[112:115], v[32:47]
v_add_f32 v28, v28, v92
v_exp_f32 v94, v94
v_add_f32 v28, v28, v93
v_cvt_pk_bf16_f32 v90, v92, v93
v_mfma_f32_32x32x16_bf16 v[48:63], a[216:219], a[116:119], v[48:63]
v_exp_f32 v95, v95
v_add_f32 v28, v28, v94
v_add_f32 v28, v28, v95
v_cvt_pk_bf16_f32 v91, v94, v95
v_mfma_f32_32x32x16_bf16 v[32:47], a[220:223], a[120:123], v[32:47]
v_mfma_f32_32x32x16_bf16 v[48:63], a[220:223], a[124:127], v[48:63]
s_waitcnt lgkmcnt(8)
v_mfma_f32_32x32x16_bf16 v[128:143], a[224:227], v[64:67], v[128:143]
ds_read_b128 a[192:195], v14 offset:40960
v_mfma_f32_32x32x16_bf16 v[192:207], a[224:227], v[80:83], v[192:207]
ds_read_b128 a[196:199], v15 offset:40960
ds_read_b128 a[200:203], v16 offset:40960
v_mfma_f32_32x32x16_bf16 v[144:159], a[228:231], v[64:67], v[144:159]
ds_read_b128 a[204:207], v17 offset:40960
ds_read_b128 a[208:211], v18 offset:40960
v_mfma_f32_32x32x16_bf16 v[208:223], a[228:231], v[80:83], v[208:223]
ds_read_b128 a[212:215], v19 offset:40960
ds_read_b128 a[216:219], v20 offset:40960
v_exp_f32 v32, v32
v_mfma_f32_32x32x16_bf16 v[160:175], a[232:235], v[64:67], v[160:175]
s_waitcnt lgkmcnt(14)
ds_read_b128 a[220:223], v21 offset:40960
v_exp_f32 v33, v33
v_add_f32 v26, v26, v32
v_exp_f32 v34, v34
v_mfma_f32_32x32x16_bf16 v[224:239], a[232:235], v[80:83], v[224:239]
s_waitcnt vmcnt(22) lgkmcnt(14)
ds_read_b64_tr_b16 a[128:129], v96 offset:0
v_add_f32 v26, v26, v33
v_cvt_pk_bf16_f32 v32, v32, v33
v_exp_f32 v35, v35
v_add_f32 v26, v26, v34
v_mfma_f32_32x32x16_bf16 v[176:191], a[236:239], v[64:67], v[176:191]
s_waitcnt lgkmcnt(14)
ds_read_b64_tr_b16 a[130:131], v96 offset:1024
s_waitcnt lgkmcnt(14)
ds_read_b64_tr_b16 a[132:133], v97 offset:0
v_exp_f32 v36, v36
v_add_f32 v26, v26, v35
v_cvt_pk_bf16_f32 v33, v34, v35
v_mfma_f32_32x32x16_bf16 v[240:255], a[236:239], v[80:83], v[240:255]
s_waitcnt lgkmcnt(14)
ds_read_b64_tr_b16 a[134:135], v97 offset:1024
s_waitcnt lgkmcnt(14)
ds_read_b64_tr_b16 a[136:137], v96 offset:2048
s_waitcnt lgkmcnt(13)
v_exp_f32 v37, v37
v_add_f32 v26, v26, v36
v_mfma_f32_32x32x16_bf16 v[128:143], a[240:243], v[72:75], v[128:143]
ds_read_b64_tr_b16 a[138:139], v96 offset:3072
ds_read_b64_tr_b16 a[140:141], v97 offset:2048
v_exp_f32 v38, v38
v_add_f32 v26, v26, v37
v_cvt_pk_bf16_f32 v34, v36, v37
v_mfma_f32_32x32x16_bf16 v[192:207], a[240:243], v[88:91], v[192:207]
s_waitcnt lgkmcnt(14)
ds_read_b64_tr_b16 a[142:143], v97 offset:3072
v_exp_f32 v39, v39
v_add_f32 v26, v26, v38
v_add_f32 v26, v26, v39
v_cvt_pk_bf16_f32 v35, v38, v39
v_mfma_f32_32x32x16_bf16 v[144:159], a[244:247], v[72:75], v[144:159]
v_exp_f32 v48, v48
v_exp_f32 v49, v49
v_add_f32 v28, v28, v48
v_mfma_f32_32x32x16_bf16 v[208:223], a[244:247], v[88:91], v[208:223]
v_exp_f32 v50, v50
v_add_f32 v28, v28, v49
v_cvt_pk_bf16_f32 v48, v48, v49
v_exp_f32 v51, v51
v_mfma_f32_32x32x16_bf16 v[160:175], a[248:251], v[72:75], v[160:175]
v_add_f32 v28, v28, v50
v_exp_f32 v52, v52
v_add_f32 v28, v28, v51
v_cvt_pk_bf16_f32 v49, v50, v51
v_mfma_f32_32x32x16_bf16 v[224:239], a[248:251], v[88:91], v[224:239]
v_exp_f32 v53, v53
v_add_f32 v28, v28, v52
v_exp_f32 v54, v54
v_add_f32 v28, v28, v53
v_mfma_f32_32x32x16_bf16 v[176:191], a[252:255], v[72:75], v[176:191]
v_cvt_pk_bf16_f32 v50, v52, v53
v_exp_f32 v55, v55
v_add_f32 v28, v28, v54
v_add_f32 v28, v28, v55
v_cvt_pk_bf16_f32 v51, v54, v55
v_mfma_f32_32x32x16_bf16 v[240:255], a[252:255], v[88:91], v[240:255]
s_waitcnt lgkmcnt(8)
v_mfma_f32_32x32x16_bf16 v[64:79], a[192:195], a[64:67], 0
s_waitcnt lgkmcnt(0)
s_barrier
v_exp_f32 v40, v40
v_mfma_f32_32x32x16_bf16 v[80:95], a[192:195], a[68:71], 0
ds_read_b64_tr_b16 a[224:225], v22 offset:49152
v_exp_f32 v41, v41
v_add_f32 v26, v26, v40
v_exp_f32 v42, v42
v_mfma_f32_32x32x16_bf16 v[64:79], a[196:199], a[72:75], v[64:79]
ds_read_b64_tr_b16 a[226:227], v22 offset:51200
ds_read_b64_tr_b16 a[228:229], v23 offset:49152
v_xor_b32 v14, 0x10000, v14
v_add_f32 v26, v26, v41
v_cvt_pk_bf16_f32 v40, v40, v41
v_xor_b32 v15, 0x10000, v15
v_mfma_f32_32x32x16_bf16 v[80:95], a[196:199], a[76:79], v[80:95]
ds_read_b64_tr_b16 a[230:231], v23 offset:51200
ds_read_b64_tr_b16 a[232:233], v24 offset:49152
v_exp_f32 v43, v43
v_add_f32 v26, v26, v42
v_xor_b32 v16, 0x10000, v16
v_mfma_f32_32x32x16_bf16 v[64:79], a[200:203], a[80:83], v[64:79]
ds_read_b64_tr_b16 a[234:235], v24 offset:51200
ds_read_b64_tr_b16 a[236:237], v25 offset:49152
v_exp_f32 v44, v44
v_add_f32 v26, v26, v43
v_cvt_pk_bf16_f32 v41, v42, v43
v_mfma_f32_32x32x16_bf16 v[80:95], a[200:203], a[84:87], v[80:95]
ds_read_b64_tr_b16 a[238:239], v25 offset:51200
ds_read_b64_tr_b16 a[240:241], v22 offset:53248
v_exp_f32 v45, v45
v_add_f32 v26, v26, v44
v_xor_b32 v17, 0x10000, v17
v_mfma_f32_32x32x16_bf16 v[64:79], a[204:207], a[88:91], v[64:79]
ds_read_b64_tr_b16 a[242:243], v22 offset:55296
ds_read_b64_tr_b16 a[244:245], v23 offset:53248
v_exp_f32 v46, v46
v_add_f32 v26, v26, v45
v_cvt_pk_bf16_f32 v42, v44, v45
v_mfma_f32_32x32x16_bf16 v[80:95], a[204:207], a[92:95], v[80:95]
ds_read_b64_tr_b16 a[246:247], v23 offset:55296
ds_read_b64_tr_b16 a[248:249], v24 offset:53248
v_xor_b32 v18, 0x10000, v18
v_exp_f32 v47, v47
v_add_f32 v26, v26, v46
v_mfma_f32_32x32x16_bf16 v[64:79], a[208:211], a[96:99], v[64:79]
ds_read_b64_tr_b16 a[250:251], v24 offset:55296
ds_read_b64_tr_b16 a[252:253], v25 offset:53248
v_add_f32 v26, v26, v47
v_cvt_pk_bf16_f32 v43, v46, v47
v_xor_b32 v19, 0x10000, v19
v_xor_b32 v20, 0x10000, v20
v_mfma_f32_32x32x16_bf16 v[80:95], a[208:211], a[100:103], v[80:95]
s_waitcnt lgkmcnt(14)
ds_read_b64_tr_b16 a[254:255], v25 offset:55296
v_exp_f32 v56, v56
v_exp_f32 v57, v57
v_add_f32 v28, v28, v56
v_mfma_f32_32x32x16_bf16 v[64:79], a[212:215], a[104:107], v[64:79]
v_exp_f32 v58, v58
v_add_f32 v28, v28, v57
v_cvt_pk_bf16_f32 v56, v56, v57
v_xor_b32 v21, 0x10000, v21
v_mfma_f32_32x32x16_bf16 v[80:95], a[212:215], a[108:111], v[80:95]
v_exp_f32 v59, v59
v_add_f32 v28, v28, v58
v_exp_f32 v60, v60
v_add_f32 v28, v28, v59
v_mfma_f32_32x32x16_bf16 v[64:79], a[216:219], a[112:115], v[64:79]
v_cvt_pk_bf16_f32 v57, v58, v59
v_exp_f32 v61, v61
v_add_f32 v28, v28, v60
v_exp_f32 v62, v62
v_mfma_f32_32x32x16_bf16 v[80:95], a[216:219], a[116:119], v[80:95]
v_add_f32 v28, v28, v61
v_cvt_pk_bf16_f32 v58, v60, v61
v_exp_f32 v63, v63
v_add_f32 v28, v28, v62
v_add_f32 v28, v28, v63
v_mfma_f32_32x32x16_bf16 v[64:79], a[220:223], a[120:123], v[64:79]
v_cvt_pk_bf16_f32 v59, v62, v63
v_mfma_f32_32x32x16_bf16 v[80:95], a[220:223], a[124:127], v[80:95]
s_waitcnt lgkmcnt(8)
v_mfma_f32_32x32x16_bf16 v[128:143], a[224:227], v[32:35], v[128:143]
buffer_store_dwordx4 a[128:131], v5, s[4:7], s47 offen offset:0 sc1
ds_read_b128 a[192:195], v14 offset:0
s_add_u32 m0, s37, 81920
s_mov_b32 s38, 98304
v_mfma_f32_32x32x16_bf16 v[192:207], a[224:227], v[48:51], v[192:207]
ds_read_b128 a[196:199], v15 offset:0
ds_read_b128 a[200:203], v16 offset:0
v_mfma_f32_32x32x16_bf16 v[144:159], a[228:231], v[32:35], v[144:159]
buffer_load_dwordx4 v13, s[24:27], s38 offen offset:0  lds
ds_read_b128 a[204:207], v17 offset:0
v_mfma_f32_32x32x16_bf16 v[208:223], a[228:231], v[48:51], v[208:223]
ds_read_b128 a[208:211], v18 offset:0
ds_read_b128 a[212:215], v19 offset:0
v_exp_f32 v64, v64
v_mfma_f32_32x32x16_bf16 v[160:175], a[232:235], v[32:35], v[160:175]
ds_read_b128 a[216:219], v20 offset:0
s_waitcnt lgkmcnt(14)
ds_read_b128 a[220:223], v21 offset:0
v_exp_f32 v65, v65
v_add_f32 v26, v26, v64
v_mfma_f32_32x32x16_bf16 v[224:239], a[232:235], v[48:51], v[224:239]
buffer_load_dwordx4 v13, s[24:27], s38 offen offset:1024  lds
v_exp_f32 v66, v66
v_add_f32 v26, v26, v65
v_cvt_pk_bf16_f32 v64, v64, v65
v_mfma_f32_32x32x16_bf16 v[176:191], a[236:239], v[32:35], v[176:191]
v_exp_f32 v67, v67
v_add_f32 v26, v26, v66
v_exp_f32 v68, v68
v_add_f32 v26, v26, v67
v_mfma_f32_32x32x16_bf16 v[240:255], a[236:239], v[48:51], v[240:255]
s_waitcnt lgkmcnt(8)
v_cvt_pk_bf16_f32 v65, v66, v67
v_exp_f32 v69, v69
v_add_f32 v26, v26, v68
v_exp_f32 v70, v70
v_mfma_f32_32x32x16_bf16 v[128:143], a[240:243], v[40:43], v[128:143]
v_add_f32 v26, v26, v69
v_cvt_pk_bf16_f32 v66, v68, v69
v_exp_f32 v71, v71
v_add_f32 v26, v26, v70
v_add_f32 v26, v26, v71
v_mfma_f32_32x32x16_bf16 v[192:207], a[240:243], v[56:59], v[192:207]
buffer_load_dwordx4 v13, s[24:27], s38 offen offset:2048  lds
v_cvt_pk_bf16_f32 v67, v70, v71
v_exp_f32 v80, v80
v_mfma_f32_32x32x16_bf16 v[144:159], a[244:247], v[40:43], v[144:159]
v_exp_f32 v81, v81
v_add_f32 v28, v28, v80
v_exp_f32 v82, v82
v_add_f32 v28, v28, v81
v_mfma_f32_32x32x16_bf16 v[208:223], a[244:247], v[56:59], v[208:223]
v_cvt_pk_bf16_f32 v80, v80, v81
v_exp_f32 v83, v83
v_add_f32 v28, v28, v82
v_exp_f32 v84, v84
v_mfma_f32_32x32x16_bf16 v[160:175], a[248:251], v[40:43], v[160:175]
buffer_load_dwordx4 v13, s[24:27], s38 offen offset:3072  lds
v_add_f32 v28, v28, v83
v_cvt_pk_bf16_f32 v81, v82, v83
v_exp_f32 v85, v85
v_mfma_f32_32x32x16_bf16 v[224:239], a[248:251], v[56:59], v[224:239]
s_add_u32 m0, s37, 98304
s_mov_b32 s39, 114688
v_add_f32 v28, v28, v84
v_exp_f32 v86, v86
v_add_f32 v28, v28, v85
v_cvt_pk_bf16_f32 v82, v84, v85
v_mfma_f32_32x32x16_bf16 v[176:191], a[252:255], v[40:43], v[176:191]
v_exp_f32 v87, v87
v_add_f32 v28, v28, v86
v_add_f32 v28, v28, v87
v_cvt_pk_bf16_f32 v83, v86, v87
v_mfma_f32_32x32x16_bf16 v[240:255], a[252:255], v[56:59], v[240:255]
buffer_load_dwordx4 v9, s[20:23], s39 offen offset:0  lds
s_waitcnt lgkmcnt(0)
v_mfma_f32_32x32x16_bf16 v[32:47], a[192:195], a[64:67], 0
ds_read_b64_tr_b16 a[224:225], v22 offset:57344
v_exp_f32 v72, v72
v_mfma_f32_32x32x16_bf16 v[48:63], a[192:195], a[68:71], 0
ds_read_b64_tr_b16 a[226:227], v22 offset:59392
ds_read_b64_tr_b16 a[228:229], v23 offset:57344
v_exp_f32 v73, v73
v_add_f32 v26, v26, v72
v_mfma_f32_32x32x16_bf16 v[32:47], a[196:199], a[72:75], v[32:47]
buffer_load_dwordx4 v10, s[20:23], s39 offen offset:1024  lds
ds_read_b64_tr_b16 a[230:231], v23 offset:59392
v_exp_f32 v74, v74
v_add_f32 v26, v26, v73
v_mfma_f32_32x32x16_bf16 v[48:63], a[196:199], a[76:79], v[48:63]
ds_read_b64_tr_b16 a[232:233], v24 offset:57344
ds_read_b64_tr_b16 a[234:235], v24 offset:59392
v_cvt_pk_bf16_f32 v72, v72, v73
v_exp_f32 v75, v75
v_add_f32 v26, v26, v74
v_mfma_f32_32x32x16_bf16 v[32:47], a[200:203], a[80:83], v[32:47]
ds_read_b64_tr_b16 a[236:237], v25 offset:57344
ds_read_b64_tr_b16 a[238:239], v25 offset:59392
v_exp_f32 v76, v76
v_add_f32 v26, v26, v75
v_cvt_pk_bf16_f32 v73, v74, v75
v_mfma_f32_32x32x16_bf16 v[48:63], a[200:203], a[84:87], v[48:63]
buffer_load_dwordx4 v11, s[20:23], s39 offen offset:2048  lds
ds_read_b64_tr_b16 a[240:241], v22 offset:61440
v_exp_f32 v77, v77
v_add_f32 v26, v26, v76
v_mfma_f32_32x32x16_bf16 v[32:47], a[204:207], a[88:91], v[32:47]
ds_read_b64_tr_b16 a[242:243], v22 offset:63488
ds_read_b64_tr_b16 a[244:245], v23 offset:61440
v_exp_f32 v78, v78
v_add_f32 v26, v26, v77
v_cvt_pk_bf16_f32 v74, v76, v77
v_mfma_f32_32x32x16_bf16 v[48:63], a[204:207], a[92:95], v[48:63]
ds_read_b64_tr_b16 a[246:247], v23 offset:63488
ds_read_b64_tr_b16 a[248:249], v24 offset:61440
v_exp_f32 v79, v79
v_add_f32 v26, v26, v78
v_add_f32 v26, v26, v79
v_mfma_f32_32x32x16_bf16 v[32:47], a[208:211], a[96:99], v[32:47]
buffer_store_dwordx4 a[132:135], v5, s[4:7], s47 offen offset:1024 sc1
ds_read_b64_tr_b16 a[250:251], v24 offset:63488
v_cvt_pk_bf16_f32 v75, v78, v79
v_exp_f32 v88, v88
v_mfma_f32_32x32x16_bf16 v[48:63], a[208:211], a[100:103], v[48:63]
ds_read_b64_tr_b16 a[252:253], v25 offset:61440
s_waitcnt lgkmcnt(14)
ds_read_b64_tr_b16 a[254:255], v25 offset:63488
s_add_u32 s41, s47, 20480
v_exp_f32 v89, v89
v_add_f32 v28, v28, v88
v_mfma_f32_32x32x16_bf16 v[32:47], a[212:215], a[104:107], v[32:47]
v_exp_f32 v90, v90
v_add_f32 v28, v28, v89
v_cvt_pk_bf16_f32 v88, v88, v89
v_exp_f32 v91, v91
v_mfma_f32_32x32x16_bf16 v[48:63], a[212:215], a[108:111], v[48:63]
buffer_load_dwordx4 v12, s[20:23], s39 offen offset:3072  lds
v_add_f32 v28, v28, v90
v_exp_f32 v92, v92
v_add_f32 v28, v28, v91
v_mfma_f32_32x32x16_bf16 v[32:47], a[216:219], a[112:115], v[32:47]
v_cvt_pk_bf16_f32 v89, v90, v91
v_exp_f32 v93, v93
v_add_f32 v28, v28, v92
v_exp_f32 v94, v94
v_mfma_f32_32x32x16_bf16 v[48:63], a[216:219], a[116:119], v[48:63]
v_add_f32 v28, v28, v93
v_cvt_pk_bf16_f32 v90, v92, v93
v_exp_f32 v95, v95
v_add_f32 v28, v28, v94
v_add_f32 v28, v28, v95
v_mfma_f32_32x32x16_bf16 v[32:47], a[220:223], a[120:123], v[32:47]
v_cvt_pk_bf16_f32 v91, v94, v95
v_mfma_f32_32x32x16_bf16 v[48:63], a[220:223], a[124:127], v[48:63]
s_waitcnt lgkmcnt(8)
v_mfma_f32_32x32x16_bf16 v[128:143], a[224:227], v[64:67], v[128:143]
ds_read_b128 a[192:195], v14 offset:8192
v_mfma_f32_32x32x16_bf16 v[192:207], a[224:227], v[80:83], v[192:207]
ds_read_b128 a[196:199], v15 offset:8192
ds_read_b128 a[200:203], v16 offset:8192
v_xor_b32 v22, 0x10000, v22
v_mfma_f32_32x32x16_bf16 v[144:159], a[228:231], v[64:67], v[144:159]
ds_read_b128 a[204:207], v17 offset:8192
ds_read_b128 a[208:211], v18 offset:8192
v_xor_b32 v23, 0x10000, v23
v_mfma_f32_32x32x16_bf16 v[208:223], a[228:231], v[80:83], v[208:223]
ds_read_b128 a[212:215], v19 offset:8192
ds_read_b128 a[216:219], v20 offset:8192
v_xor_b32 v24, 0x10000, v24
v_exp_f32 v32, v32
v_mfma_f32_32x32x16_bf16 v[160:175], a[232:235], v[64:67], v[160:175]
s_waitcnt lgkmcnt(14)
ds_read_b128 a[220:223], v21 offset:8192
v_exp_f32 v33, v33
v_add_f32 v26, v26, v32
v_exp_f32 v34, v34
v_mfma_f32_32x32x16_bf16 v[224:239], a[232:235], v[80:83], v[224:239]
s_waitcnt vmcnt(18) lgkmcnt(14)
ds_read_b64_tr_b16 a[144:145], v98 offset:4096
v_xor_b32 v25, 0x10000, v25
v_add_f32 v26, v26, v33
v_cvt_pk_bf16_f32 v32, v32, v33
v_exp_f32 v35, v35
v_mfma_f32_32x32x16_bf16 v[176:191], a[236:239], v[64:67], v[176:191]
s_waitcnt lgkmcnt(14)
ds_read_b64_tr_b16 a[146:147], v99 offset:4096
s_waitcnt lgkmcnt(14)
ds_read_b64_tr_b16 a[148:149], v100 offset:4096
v_add_f32 v26, v26, v34
v_exp_f32 v36, v36
v_add_f32 v26, v26, v35
v_mfma_f32_32x32x16_bf16 v[240:255], a[236:239], v[80:83], v[240:255]
s_waitcnt lgkmcnt(14)
ds_read_b64_tr_b16 a[150:151], v101 offset:4096
s_waitcnt lgkmcnt(14)
ds_read_b64_tr_b16 a[152:153], v102 offset:4096
s_waitcnt lgkmcnt(13)
v_cvt_pk_bf16_f32 v33, v34, v35
v_exp_f32 v37, v37
v_mfma_f32_32x32x16_bf16 v[128:143], a[240:243], v[72:75], v[128:143]
ds_read_b64_tr_b16 a[154:155], v103 offset:4096
ds_read_b64_tr_b16 a[156:157], v104 offset:4096
v_add_f32 v26, v26, v36
v_exp_f32 v38, v38
v_add_f32 v26, v26, v37
v_mfma_f32_32x32x16_bf16 v[192:207], a[240:243], v[88:91], v[192:207]
s_waitcnt lgkmcnt(14)
ds_read_b64_tr_b16 a[158:159], v105 offset:4096
v_cvt_pk_bf16_f32 v34, v36, v37
v_exp_f32 v39, v39
v_add_f32 v26, v26, v38
v_add_f32 v26, v26, v39
v_mfma_f32_32x32x16_bf16 v[144:159], a[244:247], v[72:75], v[144:159]
v_cvt_pk_bf16_f32 v35, v38, v39
v_exp_f32 v48, v48
v_exp_f32 v49, v49
v_add_f32 v28, v28, v48
v_mfma_f32_32x32x16_bf16 v[208:223], a[244:247], v[88:91], v[208:223]
v_exp_f32 v50, v50
v_add_f32 v28, v28, v49
v_cvt_pk_bf16_f32 v48, v48, v49
v_exp_f32 v51, v51
v_mfma_f32_32x32x16_bf16 v[160:175], a[248:251], v[72:75], v[160:175]
v_add_f32 v28, v28, v50
v_exp_f32 v52, v52
v_add_f32 v28, v28, v51
v_cvt_pk_bf16_f32 v49, v50, v51
v_mfma_f32_32x32x16_bf16 v[224:239], a[248:251], v[88:91], v[224:239]
v_exp_f32 v53, v53
v_add_f32 v28, v28, v52
v_exp_f32 v54, v54
v_add_f32 v28, v28, v53
v_mfma_f32_32x32x16_bf16 v[176:191], a[252:255], v[72:75], v[176:191]
buffer_store_dwordx4 a[136:139], v5, s[4:7], s41 offen offset:0 sc1
v_cvt_pk_bf16_f32 v50, v52, v53
v_exp_f32 v55, v55
v_add_f32 v28, v28, v54
v_mfma_f32_32x32x16_bf16 v[240:255], a[252:255], v[88:91], v[240:255]
s_waitcnt lgkmcnt(8)
v_add_f32 v28, v28, v55
v_cvt_pk_bf16_f32 v51, v54, v55
v_mfma_f32_32x32x16_bf16 v[64:79], a[192:195], a[64:67], 0
s_waitcnt lgkmcnt(0)
s_barrier
s_add_u32 s40, s42, 32768
v_exp_f32 v40, v40
v_mfma_f32_32x32x16_bf16 v[80:95], a[192:195], a[68:71], 0
buffer_load_dwordx4 v[112:115], v5, s[4:7], s40 offen offset:0 sc1
ds_read_b64_tr_b16 a[224:225], v22 offset:16384
v_exp_f32 v41, v41
v_add_f32 v26, v26, v40
v_mfma_f32_32x32x16_bf16 v[64:79], a[196:199], a[72:75], v[64:79]
ds_read_b64_tr_b16 a[226:227], v22 offset:18432
ds_read_b64_tr_b16 a[228:229], v23 offset:16384
v_exp_f32 v42, v42
v_add_f32 v26, v26, v41
v_cvt_pk_bf16_f32 v40, v40, v41
v_mfma_f32_32x32x16_bf16 v[80:95], a[196:199], a[76:79], v[80:95]
buffer_load_dwordx4 v[116:119], v5, s[4:7], s40 offen offset:1024 sc1
ds_read_b64_tr_b16 a[230:231], v23 offset:18432
v_exp_f32 v43, v43
v_add_f32 v26, v26, v42
v_mfma_f32_32x32x16_bf16 v[64:79], a[200:203], a[80:83], v[64:79]
ds_read_b64_tr_b16 a[232:233], v24 offset:16384
ds_read_b64_tr_b16 a[234:235], v24 offset:18432
v_exp_f32 v44, v44
v_add_f32 v26, v26, v43
v_cvt_pk_bf16_f32 v41, v42, v43
v_mfma_f32_32x32x16_bf16 v[80:95], a[200:203], a[84:87], v[80:95]
ds_read_b64_tr_b16 a[236:237], v25 offset:16384
ds_read_b64_tr_b16 a[238:239], v25 offset:18432
v_exp_f32 v45, v45
v_add_f32 v26, v26, v44
v_mfma_f32_32x32x16_bf16 v[64:79], a[204:207], a[88:91], v[64:79]
ds_read_b64_tr_b16 a[240:241], v22 offset:20480
ds_read_b64_tr_b16 a[242:243], v22 offset:22528
v_exp_f32 v46, v46
v_add_f32 v26, v26, v45
v_cvt_pk_bf16_f32 v42, v44, v45
v_mfma_f32_32x32x16_bf16 v[80:95], a[204:207], a[92:95], v[80:95]
buffer_load_dwordx4 v[120:123], v5, s[4:7], s40 offen offset:2048 sc1
ds_read_b64_tr_b16 a[244:245], v23 offset:20480
v_exp_f32 v47, v47
v_add_f32 v26, v26, v46
v_mfma_f32_32x32x16_bf16 v[64:79], a[208:211], a[96:99], v[64:79]
ds_read_b64_tr_b16 a[246:247], v23 offset:22528
ds_read_b64_tr_b16 a[248:249], v24 offset:20480
v_add_f32 v26, v26, v47
v_cvt_pk_bf16_f32 v43, v46, v47
v_exp_f32 v56, v56
v_mfma_f32_32x32x16_bf16 v[80:95], a[208:211], a[100:103], v[80:95]
ds_read_b64_tr_b16 a[250:251], v24 offset:22528
ds_read_b64_tr_b16 a[252:253], v25 offset:20480
v_exp_f32 v57, v57
v_add_f32 v28, v28, v56
v_mfma_f32_32x32x16_bf16 v[64:79], a[212:215], a[104:107], v[64:79]
buffer_load_dwordx4 v[124:127], v5, s[4:7], s40 offen offset:3072 sc1
s_waitcnt lgkmcnt(14)
ds_read_b64_tr_b16 a[254:255], v25 offset:22528
v_exp_f32 v58, v58
v_add_f32 v28, v28, v57
v_mfma_f32_32x32x16_bf16 v[80:95], a[212:215], a[108:111], v[80:95]
v_cvt_pk_bf16_f32 v56, v56, v57
v_exp_f32 v59, v59
v_add_f32 v28, v28, v58
v_exp_f32 v60, v60
v_mfma_f32_32x32x16_bf16 v[64:79], a[216:219], a[112:115], v[64:79]
v_add_f32 v28, v28, v59
v_cvt_pk_bf16_f32 v57, v58, v59
v_exp_f32 v61, v61
v_add_f32 v28, v28, v60
v_mfma_f32_32x32x16_bf16 v[80:95], a[216:219], a[116:119], v[80:95]
v_exp_f32 v62, v62
v_add_f32 v28, v28, v61
v_cvt_pk_bf16_f32 v58, v60, v61
v_exp_f32 v63, v63
v_mfma_f32_32x32x16_bf16 v[64:79], a[220:223], a[120:123], v[64:79]
v_add_f32 v28, v28, v62
v_add_f32 v28, v28, v63
v_cvt_pk_bf16_f32 v59, v62, v63
v_mfma_f32_32x32x16_bf16 v[80:95], a[220:223], a[124:127], v[80:95]
s_waitcnt lgkmcnt(8)
v_mfma_f32_32x32x16_bf16 v[128:143], a[224:227], v[32:35], v[128:143]
ds_read_b128 a[192:195], v14 offset:32768
s_add_u32 m0, s37, 114688
s_mov_b32 s38, 114688
v_mfma_f32_32x32x16_bf16 v[192:207], a[224:227], v[48:51], v[192:207]
buffer_load_dwordx4 v13, s[24:27], s38 offen offset:0  lds
ds_read_b128 a[196:199], v15 offset:32768
v_mfma_f32_32x32x16_bf16 v[144:159], a[228:231], v[32:35], v[144:159]
ds_read_b128 a[200:203], v16 offset:32768
ds_read_b128 a[204:207], v17 offset:32768
v_mfma_f32_32x32x16_bf16 v[208:223], a[228:231], v[48:51], v[208:223]
buffer_load_dwordx4 v13, s[24:27], s38 offen offset:1024  lds
ds_read_b128 a[208:211], v18 offset:32768
v_exp_f32 v64, v64
v_mfma_f32_32x32x16_bf16 v[160:175], a[232:235], v[32:35], v[160:175]
ds_read_b128 a[212:215], v19 offset:32768
ds_read_b128 a[216:219], v20 offset:32768
v_exp_f32 v65, v65
v_add_f32 v26, v26, v64
v_mfma_f32_32x32x16_bf16 v[224:239], a[232:235], v[48:51], v[224:239]
s_waitcnt lgkmcnt(14)
ds_read_b128 a[220:223], v21 offset:32768
v_exp_f32 v66, v66
v_add_f32 v26, v26, v65
v_cvt_pk_bf16_f32 v64, v64, v65
v_mfma_f32_32x32x16_bf16 v[176:191], a[236:239], v[32:35], v[176:191]
buffer_store_dwordx4 a[140:143], v5, s[4:7], s41 offen offset:1024 sc1
v_exp_f32 v67, v67
v_add_f32 v26, v26, v66
v_mfma_f32_32x32x16_bf16 v[240:255], a[236:239], v[48:51], v[240:255]
s_waitcnt lgkmcnt(8)
v_exp_f32 v68, v68
v_add_f32 v26, v26, v67
v_cvt_pk_bf16_f32 v65, v66, v67
v_exp_f32 v69, v69
v_mfma_f32_32x32x16_bf16 v[128:143], a[240:243], v[40:43], v[128:143]
v_add_f32 v26, v26, v68
v_exp_f32 v70, v70
v_add_f32 v26, v26, v69
v_cvt_pk_bf16_f32 v66, v68, v69
v_mfma_f32_32x32x16_bf16 v[192:207], a[240:243], v[56:59], v[192:207]
v_exp_f32 v71, v71
v_add_f32 v26, v26, v70
v_add_f32 v26, v26, v71
v_cvt_pk_bf16_f32 v67, v70, v71
v_mfma_f32_32x32x16_bf16 v[144:159], a[244:247], v[40:43], v[144:159]
buffer_load_dwordx4 v13, s[24:27], s38 offen offset:2048  lds
v_exp_f32 v80, v80
v_exp_f32 v81, v81
v_mfma_f32_32x32x16_bf16 v[208:223], a[244:247], v[56:59], v[208:223]
v_add_f32 v28, v28, v80
v_exp_f32 v82, v82
v_add_f32 v28, v28, v81
v_cvt_pk_bf16_f32 v80, v80, v81
v_mfma_f32_32x32x16_bf16 v[160:175], a[248:251], v[40:43], v[160:175]
v_exp_f32 v83, v83
v_add_f32 v28, v28, v82
v_exp_f32 v84, v84
v_add_f32 v28, v28, v83
v_mfma_f32_32x32x16_bf16 v[224:239], a[248:251], v[56:59], v[224:239]
buffer_load_dwordx4 v13, s[24:27], s38 offen offset:3072  lds
v_cvt_pk_bf16_f32 v81, v82, v83
v_exp_f32 v85, v85
v_add_f32 v28, v28, v84
v_mfma_f32_32x32x16_bf16 v[176:191], a[252:255], v[40:43], v[176:191]
s_add_u32 m0, s37, 0
v_exp_f32 v86, v86
v_add_f32 v28, v28, v85
v_cvt_pk_bf16_f32 v82, v84, v85
v_exp_f32 v87, v87
v_mfma_f32_32x32x16_bf16 v[240:255], a[252:255], v[56:59], v[240:255]
s_mov_b32 s39, 0
v_add_f32 v28, v28, v86
v_add_f32 v28, v28, v87
v_cvt_pk_bf16_f32 v83, v86, v87
s_waitcnt lgkmcnt(0)
v_mfma_f32_32x32x16_bf16 v[32:47], a[192:195], a[64:67], 0
buffer_load_dwordx4 v7, s[12:15], s39 offen offset:0  lds
ds_read_b64_tr_b16 a[224:225], v22 offset:24576
s_mov_b32 s38, 26624
v_exp_f32 v72, v72
v_mfma_f32_32x32x16_bf16 v[48:63], a[192:195], a[68:71], 0
ds_read_b64_tr_b16 a[226:227], v22 offset:26624
ds_read_b64_tr_b16 a[228:229], v23 offset:24576
v_exp_f32 v73, v73
v_add_f32 v26, v26, v72
v_mfma_f32_32x32x16_bf16 v[32:47], a[196:199], a[72:75], v[32:47]
ds_read_b64_tr_b16 a[230:231], v23 offset:26624
ds_read_b64_tr_b16 a[232:233], v24 offset:24576
v_exp_f32 v74, v74
v_add_f32 v26, v26, v73
v_cvt_pk_bf16_f32 v72, v72, v73
v_mfma_f32_32x32x16_bf16 v[48:63], a[196:199], a[76:79], v[48:63]
buffer_load_dwordx4 v7, s[12:15], s38 offen offset:1024  lds
ds_read_b64_tr_b16 a[234:235], v24 offset:26624
v_exp_f32 v75, v75
v_add_f32 v26, v26, v74
v_mfma_f32_32x32x16_bf16 v[32:47], a[200:203], a[80:83], v[32:47]
ds_read_b64_tr_b16 a[236:237], v25 offset:24576
ds_read_b64_tr_b16 a[238:239], v25 offset:26624
v_exp_f32 v76, v76
v_add_f32 v26, v26, v75
v_cvt_pk_bf16_f32 v73, v74, v75
v_mfma_f32_32x32x16_bf16 v[48:63], a[200:203], a[84:87], v[48:63]
ds_read_b64_tr_b16 a[240:241], v22 offset:28672
ds_read_b64_tr_b16 a[242:243], v22 offset:30720
s_mov_b32 s39, 53248
v_exp_f32 v77, v77
v_add_f32 v26, v26, v76
v_mfma_f32_32x32x16_bf16 v[32:47], a[204:207], a[88:91], v[32:47]
buffer_load_dwordx4 v7, s[12:15], s39 offen offset:2048  lds
ds_read_b64_tr_b16 a[244:245], v23 offset:28672
v_exp_f32 v78, v78
v_add_f32 v26, v26, v77
v_mfma_f32_32x32x16_bf16 v[48:63], a[204:207], a[92:95], v[48:63]
ds_read_b64_tr_b16 a[246:247], v23 offset:30720
ds_read_b64_tr_b16 a[248:249], v24 offset:28672
v_cvt_pk_bf16_f32 v74, v76, v77
v_exp_f32 v79, v79
v_add_f32 v26, v26, v78
v_mfma_f32_32x32x16_bf16 v[32:47], a[208:211], a[96:99], v[32:47]
ds_read_b64_tr_b16 a[250:251], v24 offset:30720
ds_read_b64_tr_b16 a[252:253], v25 offset:28672
v_add_f32 v26, v26, v79
v_cvt_pk_bf16_f32 v75, v78, v79
v_exp_f32 v88, v88
v_mfma_f32_32x32x16_bf16 v[48:63], a[208:211], a[100:103], v[48:63]
s_waitcnt lgkmcnt(14)
ds_read_b64_tr_b16 a[254:255], v25 offset:30720
v_exp_f32 v89, v89
v_add_f32 v28, v28, v88
v_exp_f32 v90, v90
v_mfma_f32_32x32x16_bf16 v[32:47], a[212:215], a[104:107], v[32:47]
s_mov_b32 s38, 79872
v_add_f32 v28, v28, v89
v_cvt_pk_bf16_f32 v88, v88, v89
v_exp_f32 v91, v91
v_add_f32 v28, v28, v90
v_mfma_f32_32x32x16_bf16 v[48:63], a[212:215], a[108:111], v[48:63]
buffer_load_dwordx4 v7, s[12:15], s38 offen offset:3072  lds
v_exp_f32 v92, v92
v_add_f32 v28, v28, v91
v_cvt_pk_bf16_f32 v89, v90, v91
v_mfma_f32_32x32x16_bf16 v[32:47], a[216:219], a[112:115], v[32:47]
s_add_u32 s40, s42, 16384
v_exp_f32 v93, v93
v_add_f32 v28, v28, v92
v_exp_f32 v94, v94
v_add_f32 v28, v28, v93
v_mfma_f32_32x32x16_bf16 v[48:63], a[216:219], a[116:119], v[48:63]
buffer_store_dwordx4 a[144:147], v5, s[4:7], s48 offen offset:0 sc1
v_cvt_pk_bf16_f32 v90, v92, v93
v_exp_f32 v95, v95
v_add_f32 v28, v28, v94
v_mfma_f32_32x32x16_bf16 v[32:47], a[220:223], a[120:123], v[32:47]
v_add_f32 v28, v28, v95
v_cvt_pk_bf16_f32 v91, v94, v95
v_mfma_f32_32x32x16_bf16 v[48:63], a[220:223], a[124:127], v[48:63]
s_waitcnt lgkmcnt(8)
v_mfma_f32_32x32x16_bf16 v[128:143], a[224:227], v[64:67], v[128:143]
buffer_load_dwordx4 a[0:3], v5, s[4:7], s40 offen offset:0 sc1
ds_read_b128 a[192:195], v14 offset:40960
v_mfma_f32_32x32x16_bf16 v[192:207], a[224:227], v[80:83], v[192:207]
ds_read_b128 a[196:199], v15 offset:40960
ds_read_b128 a[200:203], v16 offset:40960
v_mfma_f32_32x32x16_bf16 v[144:159], a[228:231], v[64:67], v[144:159]
ds_read_b128 a[204:207], v17 offset:40960
ds_read_b128 a[208:211], v18 offset:40960
v_mfma_f32_32x32x16_bf16 v[208:223], a[228:231], v[80:83], v[208:223]
ds_read_b128 a[212:215], v19 offset:40960
ds_read_b128 a[216:219], v20 offset:40960
v_exp_f32 v32, v32
v_mfma_f32_32x32x16_bf16 v[160:175], a[232:235], v[64:67], v[160:175]
buffer_load_dwordx4 a[4:7], v5, s[4:7], s40 offen offset:1024 sc1
s_waitcnt lgkmcnt(14)
ds_read_b128 a[220:223], v21 offset:40960
v_exp_f32 v33, v33
v_add_f32 v26, v26, v32
v_mfma_f32_32x32x16_bf16 v[224:239], a[232:235], v[80:83], v[224:239]
v_exp_f32 v34, v34
v_add_f32 v26, v26, v33
v_cvt_pk_bf16_f32 v32, v32, v33
v_exp_f32 v35, v35
v_mfma_f32_32x32x16_bf16 v[176:191], a[236:239], v[64:67], v[176:191]
v_add_f32 v26, v26, v34
v_exp_f32 v36, v36
v_add_f32 v26, v26, v35
v_cvt_pk_bf16_f32 v33, v34, v35
v_mfma_f32_32x32x16_bf16 v[240:255], a[236:239], v[80:83], v[240:255]
buffer_load_dwordx4 a[8:11], v5, s[4:7], s40 offen offset:2048 sc1
s_waitcnt lgkmcnt(8)
v_exp_f32 v37, v37
v_add_f32 v26, v26, v36
v_mfma_f32_32x32x16_bf16 v[128:143], a[240:243], v[72:75], v[128:143]
v_exp_f32 v38, v38
v_add_f32 v26, v26, v37
v_cvt_pk_bf16_f32 v34, v36, v37
v_exp_f32 v39, v39
v_mfma_f32_32x32x16_bf16 v[192:207], a[240:243], v[88:91], v[192:207]
v_add_f32 v26, v26, v38
v_add_f32 v26, v26, v39
v_cvt_pk_bf16_f32 v35, v38, v39
v_exp_f32 v48, v48
v_mfma_f32_32x32x16_bf16 v[144:159], a[244:247], v[72:75], v[144:159]
buffer_load_dwordx4 a[12:15], v5, s[4:7], s40 offen offset:3072 sc1
s_add_u32 s40, s42, 20480
v_exp_f32 v49, v49
v_add_f32 v28, v28, v48
v_mfma_f32_32x32x16_bf16 v[208:223], a[244:247], v[88:91], v[208:223]
v_exp_f32 v50, v50
v_add_f32 v28, v28, v49
v_cvt_pk_bf16_f32 v48, v48, v49
v_exp_f32 v51, v51
v_mfma_f32_32x32x16_bf16 v[160:175], a[248:251], v[72:75], v[160:175]
v_add_f32 v28, v28, v50
v_exp_f32 v52, v52
v_add_f32 v28, v28, v51
v_cvt_pk_bf16_f32 v49, v50, v51
v_mfma_f32_32x32x16_bf16 v[224:239], a[248:251], v[88:91], v[224:239]
buffer_load_dwordx4 a[16:19], v5, s[4:7], s40 offen offset:0 sc1
v_exp_f32 v53, v53
v_add_f32 v28, v28, v52
v_mfma_f32_32x32x16_bf16 v[176:191], a[252:255], v[72:75], v[176:191]
v_exp_f32 v54, v54
v_add_f32 v28, v28, v53
v_cvt_pk_bf16_f32 v50, v52, v53
v_exp_f32 v55, v55
v_mfma_f32_32x32x16_bf16 v[240:255], a[252:255], v[88:91], v[240:255]
s_waitcnt lgkmcnt(0)
v_add_f32 v28, v28, v54
v_add_f32 v28, v28, v55
v_cvt_pk_bf16_f32 v51, v54, v55
v_mfma_f32_32x32x16_bf16 v[64:79], a[192:195], a[64:67], 0
buffer_load_dwordx4 a[20:23], v5, s[4:7], s40 offen offset:1024 sc1
s_waitcnt vmcnt(31)
s_barrier
v_exp_f32 v40, v40
v_mfma_f32_32x32x16_bf16 v[80:95], a[192:195], a[68:71], 0
ds_read_b64_tr_b16 a[224:225], v22 offset:49152
v_exp_f32 v41, v41
v_add_f32 v26, v26, v40
v_exp_f32 v42, v42
v_mfma_f32_32x32x16_bf16 v[64:79], a[196:199], a[72:75], v[64:79]
ds_read_b64_tr_b16 a[226:227], v22 offset:51200
ds_read_b64_tr_b16 a[228:229], v23 offset:49152
v_xor_b32 v14, 0x10000, v14
v_add_f32 v26, v26, v41
v_cvt_pk_bf16_f32 v40, v40, v41
v_xor_b32 v15, 0x10000, v15
v_mfma_f32_32x32x16_bf16 v[80:95], a[196:199], a[76:79], v[80:95]
buffer_store_dwordx4 a[148:151], v5, s[4:7], s48 offen offset:1024 sc1
ds_read_b64_tr_b16 a[230:231], v23 offset:51200
v_exp_f32 v43, v43
v_add_f32 v26, v26, v42
v_mfma_f32_32x32x16_bf16 v[64:79], a[200:203], a[80:83], v[64:79]
ds_read_b64_tr_b16 a[232:233], v24 offset:49152
ds_read_b64_tr_b16 a[234:235], v24 offset:51200
v_exp_f32 v44, v44
v_add_f32 v26, v26, v43
v_xor_b32 v16, 0x10000, v16
v_mfma_f32_32x32x16_bf16 v[80:95], a[200:203], a[84:87], v[80:95]
ds_read_b64_tr_b16 a[236:237], v25 offset:49152
ds_read_b64_tr_b16 a[238:239], v25 offset:51200
v_cvt_pk_bf16_f32 v41, v42, v43
v_exp_f32 v45, v45
v_add_f32 v26, v26, v44
v_mfma_f32_32x32x16_bf16 v[64:79], a[204:207], a[88:91], v[64:79]
buffer_load_dwordx4 a[24:27], v5, s[4:7], s40 offen offset:2048 sc1
ds_read_b64_tr_b16 a[240:241], v22 offset:53248
v_xor_b32 v17, 0x10000, v17
v_exp_f32 v46, v46
v_mfma_f32_32x32x16_bf16 v[80:95], a[204:207], a[92:95], v[80:95]
ds_read_b64_tr_b16 a[242:243], v22 offset:55296
ds_read_b64_tr_b16 a[244:245], v23 offset:53248
v_add_f32 v26, v26, v45
v_cvt_pk_bf16_f32 v42, v44, v45
v_xor_b32 v18, 0x10000, v18
v_xor_b32 v19, 0x10000, v19
v_mfma_f32_32x32x16_bf16 v[64:79], a[208:211], a[96:99], v[64:79]
ds_read_b64_tr_b16 a[246:247], v23 offset:55296
ds_read_b64_tr_b16 a[248:249], v24 offset:53248
v_exp_f32 v47, v47
v_add_f32 v26, v26, v46
v_add_f32 v26, v26, v47
v_mfma_f32_32x32x16_bf16 v[80:95], a[208:211], a[100:103], v[80:95]
buffer_load_dwordx4 a[28:31], v5, s[4:7], s40 offen offset:3072 sc1
ds_read_b64_tr_b16 a[250:251], v24 offset:55296
v_cvt_pk_bf16_f32 v43, v46, v47
v_exp_f32 v56, v56
v_mfma_f32_32x32x16_bf16 v[64:79], a[212:215], a[104:107], v[64:79]
ds_read_b64_tr_b16 a[252:253], v25 offset:53248
s_waitcnt lgkmcnt(14)
ds_read_b64_tr_b16 a[254:255], v25 offset:55296
v_exp_f32 v57, v57
v_add_f32 v28, v28, v56
v_xor_b32 v20, 0x10000, v20
v_mfma_f32_32x32x16_bf16 v[80:95], a[212:215], a[108:111], v[80:95]
s_add_u32 s40, s42, 24576
v_exp_f32 v58, v58
v_add_f32 v28, v28, v57
v_cvt_pk_bf16_f32 v56, v56, v57
v_xor_b32 v21, 0x10000, v21
v_mfma_f32_32x32x16_bf16 v[64:79], a[216:219], a[112:115], v[64:79]
v_exp_f32 v59, v59
v_add_f32 v28, v28, v58
v_exp_f32 v60, v60
v_add_f32 v28, v28, v59
v_mfma_f32_32x32x16_bf16 v[80:95], a[216:219], a[116:119], v[80:95]
buffer_load_dwordx4 a[32:35], v5, s[4:7], s40 offen offset:0 sc1
v_cvt_pk_bf16_f32 v57, v58, v59
v_exp_f32 v61, v61
v_add_f32 v28, v28, v60
v_mfma_f32_32x32x16_bf16 v[64:79], a[220:223], a[120:123], v[64:79]
v_exp_f32 v62, v62
v_add_f32 v28, v28, v61
v_cvt_pk_bf16_f32 v58, v60, v61
v_exp_f32 v63, v63
v_mfma_f32_32x32x16_bf16 v[80:95], a[220:223], a[124:127], v[80:95]
s_waitcnt lgkmcnt(8)
v_add_f32 v28, v28, v62
v_add_f32 v28, v28, v63
v_cvt_pk_bf16_f32 v59, v62, v63
v_mfma_f32_32x32x16_bf16 v[128:143], a[224:227], v[32:35], v[128:143]
buffer_load_dwordx4 a[36:39], v5, s[4:7], s40 offen offset:1024 sc1
ds_read_b128 a[192:195], v14 offset:0
v_mfma_f32_32x32x16_bf16 v[192:207], a[224:227], v[48:51], v[192:207]
ds_read_b128 a[196:199], v15 offset:0
ds_read_b128 a[200:203], v16 offset:0
v_mfma_f32_32x32x16_bf16 v[144:159], a[228:231], v[32:35], v[144:159]
ds_read_b128 a[204:207], v17 offset:0
ds_read_b128 a[208:211], v18 offset:0
v_mfma_f32_32x32x16_bf16 v[208:223], a[228:231], v[48:51], v[208:223]
buffer_load_dwordx4 a[40:43], v5, s[4:7], s40 offen offset:2048 sc1
ds_read_b128 a[212:215], v19 offset:0
v_exp_f32 v64, v64
v_mfma_f32_32x32x16_bf16 v[160:175], a[232:235], v[32:35], v[160:175]
ds_read_b128 a[216:219], v20 offset:0
s_waitcnt lgkmcnt(14)
ds_read_b128 a[220:223], v21 offset:0
v_exp_f32 v65, v65
v_add_f32 v26, v26, v64
v_mfma_f32_32x32x16_bf16 v[224:239], a[232:235], v[48:51], v[224:239]
v_exp_f32 v66, v66
v_add_f32 v26, v26, v65
v_cvt_pk_bf16_f32 v64, v64, v65
v_exp_f32 v67, v67
v_mfma_f32_32x32x16_bf16 v[176:191], a[236:239], v[32:35], v[176:191]
buffer_load_dwordx4 a[44:47], v5, s[4:7], s40 offen offset:3072 sc1
v_add_f32 v26, v26, v66
v_exp_f32 v68, v68
v_add_f32 v26, v26, v67
v_mfma_f32_32x32x16_bf16 v[240:255], a[236:239], v[48:51], v[240:255]
s_waitcnt lgkmcnt(8)
v_cvt_pk_bf16_f32 v65, v66, v67
v_exp_f32 v69, v69
v_add_f32 v26, v26, v68
v_exp_f32 v70, v70
v_mfma_f32_32x32x16_bf16 v[128:143], a[240:243], v[40:43], v[128:143]
s_add_u32 s40, s42, 28672
v_add_f32 v26, v26, v69
v_cvt_pk_bf16_f32 v66, v68, v69
v_exp_f32 v71, v71
v_add_f32 v26, v26, v70
v_add_f32 v26, v26, v71
v_mfma_f32_32x32x16_bf16 v[192:207], a[240:243], v[56:59], v[192:207]
buffer_store_dwordx4 a[152:155], v5, s[4:7], s3 offen offset:0 sc1
v_cvt_pk_bf16_f32 v67, v70, v71
v_exp_f32 v80, v80
v_mfma_f32_32x32x16_bf16 v[144:159], a[244:247], v[40:43], v[144:159]
v_exp_f32 v81, v81
v_add_f32 v28, v28, v80
v_exp_f32 v82, v82
v_add_f32 v28, v28, v81
v_mfma_f32_32x32x16_bf16 v[208:223], a[244:247], v[56:59], v[208:223]
v_cvt_pk_bf16_f32 v80, v80, v81
v_exp_f32 v83, v83
v_add_f32 v28, v28, v82
v_exp_f32 v84, v84
v_mfma_f32_32x32x16_bf16 v[160:175], a[248:251], v[40:43], v[160:175]
buffer_load_dwordx4 a[48:51], v5, s[4:7], s40 offen offset:0 sc1
v_add_f32 v28, v28, v83
v_cvt_pk_bf16_f32 v81, v82, v83
v_exp_f32 v85, v85
v_mfma_f32_32x32x16_bf16 v[224:239], a[248:251], v[56:59], v[224:239]
v_add_f32 v28, v28, v84
v_exp_f32 v86, v86
v_add_f32 v28, v28, v85
v_cvt_pk_bf16_f32 v82, v84, v85
v_mfma_f32_32x32x16_bf16 v[176:191], a[252:255], v[40:43], v[176:191]
v_exp_f32 v87, v87
v_add_f32 v28, v28, v86
v_add_f32 v28, v28, v87
v_cvt_pk_bf16_f32 v83, v86, v87
v_mfma_f32_32x32x16_bf16 v[240:255], a[252:255], v[56:59], v[240:255]
buffer_load_dwordx4 a[52:55], v5, s[4:7], s40 offen offset:1024 sc1
s_waitcnt lgkmcnt(0)
v_mfma_f32_32x32x16_bf16 v[32:47], a[192:195], a[64:67], 0
ds_read_b64_tr_b16 a[224:225], v22 offset:57344
v_exp_f32 v72, v72
v_mfma_f32_32x32x16_bf16 v[48:63], a[192:195], a[68:71], 0
ds_read_b64_tr_b16 a[226:227], v22 offset:59392
ds_read_b64_tr_b16 a[228:229], v23 offset:57344
v_exp_f32 v73, v73
v_add_f32 v26, v26, v72
v_mfma_f32_32x32x16_bf16 v[32:47], a[196:199], a[72:75], v[32:47]
buffer_load_dwordx4 a[56:59], v5, s[4:7], s40 offen offset:2048 sc1
ds_read_b64_tr_b16 a[230:231], v23 offset:59392
v_exp_f32 v74, v74
v_add_f32 v26, v26, v73
v_mfma_f32_32x32x16_bf16 v[48:63], a[196:199], a[76:79], v[48:63]
ds_read_b64_tr_b16 a[232:233], v24 offset:57344
ds_read_b64_tr_b16 a[234:235], v24 offset:59392
v_cvt_pk_bf16_f32 v72, v72, v73
v_exp_f32 v75, v75
v_add_f32 v26, v26, v74
v_mfma_f32_32x32x16_bf16 v[32:47], a[200:203], a[80:83], v[32:47]
ds_read_b64_tr_b16 a[236:237], v25 offset:57344
ds_read_b64_tr_b16 a[238:239], v25 offset:59392
v_exp_f32 v76, v76
v_add_f32 v26, v26, v75
v_cvt_pk_bf16_f32 v73, v74, v75
v_mfma_f32_32x32x16_bf16 v[48:63], a[200:203], a[84:87], v[48:63]
ds_read_b64_tr_b16 a[240:241], v22 offset:61440
ds_read_b64_tr_b16 a[242:243], v22 offset:63488
v_exp_f32 v77, v77
v_add_f32 v26, v26, v76
v_mfma_f32_32x32x16_bf16 v[32:47], a[204:207], a[88:91], v[32:47]
buffer_load_dwordx4 a[60:63], v5, s[4:7], s40 offen offset:3072 sc1
ds_read_b64_tr_b16 a[244:245], v23 offset:61440
v_exp_f32 v78, v78
v_add_f32 v26, v26, v77
v_mfma_f32_32x32x16_bf16 v[48:63], a[204:207], a[92:95], v[48:63]
ds_read_b64_tr_b16 a[246:247], v23 offset:63488
ds_read_b64_tr_b16 a[248:249], v24 offset:61440
v_cvt_pk_bf16_f32 v74, v76, v77
v_exp_f32 v79, v79
v_add_f32 v26, v26, v78
v_mfma_f32_32x32x16_bf16 v[32:47], a[208:211], a[96:99], v[32:47]
ds_read_b64_tr_b16 a[250:251], v24 offset:63488
ds_read_b64_tr_b16 a[252:253], v25 offset:61440
v_add_f32 v26, v26, v79
v_cvt_pk_bf16_f32 v75, v78, v79
v_exp_f32 v88, v88
v_mfma_f32_32x32x16_bf16 v[48:63], a[208:211], a[100:103], v[48:63]
s_waitcnt lgkmcnt(14)
ds_read_b64_tr_b16 a[254:255], v25 offset:63488
v_exp_f32 v89, v89
v_add_f32 v28, v28, v88
v_exp_f32 v90, v90
v_mfma_f32_32x32x16_bf16 v[32:47], a[212:215], a[104:107], v[32:47]
s_add_u32 m0, s37, 16384
s_mov_b32 s39, 0
v_add_f32 v28, v28, v89
v_cvt_pk_bf16_f32 v88, v88, v89
v_exp_f32 v91, v91
v_add_f32 v28, v28, v90
v_mfma_f32_32x32x16_bf16 v[48:63], a[212:215], a[108:111], v[48:63]
buffer_load_dwordx4 v7, s[16:19], s39 offen offset:0  lds
v_exp_f32 v92, v92
v_add_f32 v28, v28, v91
v_cvt_pk_bf16_f32 v89, v90, v91
v_mfma_f32_32x32x16_bf16 v[32:47], a[216:219], a[112:115], v[32:47]
s_mov_b32 s38, 26624
v_exp_f32 v93, v93
v_add_f32 v28, v28, v92
v_exp_f32 v94, v94
v_add_f32 v28, v28, v93
v_mfma_f32_32x32x16_bf16 v[48:63], a[216:219], a[116:119], v[48:63]
buffer_load_dwordx4 v7, s[16:19], s38 offen offset:1024  lds
v_cvt_pk_bf16_f32 v90, v92, v93
v_exp_f32 v95, v95
v_add_f32 v28, v28, v94
v_mfma_f32_32x32x16_bf16 v[32:47], a[220:223], a[120:123], v[32:47]
s_mov_b32 s39, 53248
v_add_f32 v28, v28, v95
v_cvt_pk_bf16_f32 v91, v94, v95
v_mfma_f32_32x32x16_bf16 v[48:63], a[220:223], a[124:127], v[48:63]
s_waitcnt lgkmcnt(8)
v_mfma_f32_32x32x16_bf16 v[128:143], a[224:227], v[64:67], v[128:143]
buffer_store_dwordx4 a[156:159], v5, s[4:7], s3 offen offset:1024 sc1
ds_read_b128 a[192:195], v14 offset:8192
v_mfma_f32_32x32x16_bf16 v[192:207], a[224:227], v[80:83], v[192:207]
ds_read_b128 a[196:199], v15 offset:8192
ds_read_b128 a[200:203], v16 offset:8192
v_xor_b32 v22, 0x10000, v22
v_mfma_f32_32x32x16_bf16 v[144:159], a[228:231], v[64:67], v[144:159]
ds_read_b128 a[204:207], v17 offset:8192
ds_read_b128 a[208:211], v18 offset:8192
v_xor_b32 v23, 0x10000, v23
v_mfma_f32_32x32x16_bf16 v[208:223], a[228:231], v[80:83], v[208:223]
ds_read_b128 a[212:215], v19 offset:8192
ds_read_b128 a[216:219], v20 offset:8192
v_xor_b32 v24, 0x10000, v24
v_exp_f32 v32, v32
v_mfma_f32_32x32x16_bf16 v[160:175], a[232:235], v[64:67], v[160:175]
buffer_load_dwordx4 v7, s[16:19], s39 offen offset:2048  lds
s_waitcnt lgkmcnt(14)
ds_read_b128 a[220:223], v21 offset:8192
v_exp_f32 v33, v33
v_add_f32 v26, v26, v32
v_mfma_f32_32x32x16_bf16 v[224:239], a[232:235], v[80:83], v[224:239]
s_mov_b32 s38, 79872
v_exp_f32 v34, v34
v_xor_b32 v25, 0x10000, v25
v_add_f32 v26, v26, v33
v_cvt_pk_bf16_f32 v32, v32, v33
v_mfma_f32_32x32x16_bf16 v[176:191], a[236:239], v[64:67], v[176:191]
v_exp_f32 v35, v35
v_add_f32 v26, v26, v34
v_exp_f32 v36, v36
v_add_f32 v26, v26, v35
v_mfma_f32_32x32x16_bf16 v[240:255], a[236:239], v[80:83], v[240:255]
buffer_load_dwordx4 v7, s[16:19], s38 offen offset:3072  lds
s_waitcnt lgkmcnt(8)
v_cvt_pk_bf16_f32 v33, v34, v35
v_exp_f32 v37, v37
v_mfma_f32_32x32x16_bf16 v[128:143], a[240:243], v[72:75], v[128:143]
s_add_u32 m0, s37, 32768
s_mov_b32 s39, 442368
v_add_f32 v26, v26, v36
v_exp_f32 v38, v38
v_add_f32 v26, v26, v37
v_cvt_pk_bf16_f32 v34, v36, v37
v_mfma_f32_32x32x16_bf16 v[192:207], a[240:243], v[88:91], v[192:207]
v_exp_f32 v39, v39
v_add_f32 v26, v26, v38
v_add_f32 v26, v26, v39
v_cvt_pk_bf16_f32 v35, v38, v39
v_mfma_f32_32x32x16_bf16 v[144:159], a[244:247], v[72:75], v[144:159]
buffer_load_dwordx4 v7, s[12:15], s39 offen offset:0  lds
v_exp_f32 v48, v48
v_exp_f32 v49, v49
v_mfma_f32_32x32x16_bf16 v[208:223], a[244:247], v[88:91], v[208:223]
s_mov_b32 s38, 468992
v_add_f32 v28, v28, v48
v_exp_f32 v50, v50
v_add_f32 v28, v28, v49
v_cvt_pk_bf16_f32 v48, v48, v49
v_mfma_f32_32x32x16_bf16 v[160:175], a[248:251], v[72:75], v[160:175]
v_exp_f32 v51, v51
v_add_f32 v28, v28, v50
v_exp_f32 v52, v52
v_add_f32 v28, v28, v51
v_mfma_f32_32x32x16_bf16 v[224:239], a[248:251], v[88:91], v[224:239]
buffer_load_dwordx4 v7, s[12:15], s38 offen offset:1024  lds
v_cvt_pk_bf16_f32 v49, v50, v51
v_exp_f32 v53, v53
v_add_f32 v28, v28, v52
v_mfma_f32_32x32x16_bf16 v[176:191], a[252:255], v[72:75], v[176:191]
s_mov_b32 s39, 495616
v_exp_f32 v54, v54
v_add_f32 v28, v28, v53
v_cvt_pk_bf16_f32 v50, v52, v53
v_exp_f32 v55, v55
v_mfma_f32_32x32x16_bf16 v[240:255], a[252:255], v[88:91], v[240:255]
s_waitcnt lgkmcnt(0)
v_add_f32 v28, v28, v54
v_add_f32 v28, v28, v55
v_cvt_pk_bf16_f32 v51, v54, v55
v_mfma_f32_32x32x16_bf16 v[64:79], a[192:195], a[64:67], 0
buffer_load_dwordx4 v7, s[12:15], s39 offen offset:2048  lds
s_waitcnt vmcnt(5)
s_barrier
s_mov_b32 s38, 522240
v_exp_f32 v40, v40
v_mfma_f32_32x32x16_bf16 v[80:95], a[192:195], a[68:71], 0
ds_read_b64_tr_b16 a[224:225], v22 offset:16384
v_exp_f32 v41, v41
v_add_f32 v26, v26, v40
v_exp_f32 v42, v42
v_mfma_f32_32x32x16_bf16 v[64:79], a[196:199], a[72:75], v[64:79]
ds_read_b64_tr_b16 a[226:227], v22 offset:18432
ds_read_b64_tr_b16 a[228:229], v23 offset:16384
v_add_f32 v26, v26, v41
v_cvt_pk_bf16_f32 v40, v40, v41
v_exp_f32 v43, v43
v_mfma_f32_32x32x16_bf16 v[80:95], a[196:199], a[76:79], v[80:95]
buffer_load_dwordx4 v7, s[12:15], s38 offen offset:3072  lds
ds_read_b64_tr_b16 a[230:231], v23 offset:18432
v_add_f32 v26, v26, v42
v_exp_f32 v44, v44
v_mfma_f32_32x32x16_bf16 v[64:79], a[200:203], a[80:83], v[64:79]
ds_read_b64_tr_b16 a[232:233], v24 offset:16384
ds_read_b64_tr_b16 a[234:235], v24 offset:18432
v_add_f32 v26, v26, v43
v_cvt_pk_bf16_f32 v41, v42, v43
v_exp_f32 v45, v45
v_mfma_f32_32x32x16_bf16 v[80:95], a[200:203], a[84:87], v[80:95]
ds_read_b64_tr_b16 a[236:237], v25 offset:16384
ds_read_b64_tr_b16 a[238:239], v25 offset:18432
v_add_f32 v26, v26, v44
v_exp_f32 v46, v46
v_add_f32 v26, v26, v45
v_mfma_f32_32x32x16_bf16 v[64:79], a[204:207], a[88:91], v[64:79]
ds_read_b64_tr_b16 a[240:241], v22 offset:20480
ds_read_b64_tr_b16 a[242:243], v22 offset:22528
v_cvt_pk_bf16_f32 v42, v44, v45
v_exp_f32 v47, v47
v_add_f32 v26, v26, v46
v_mfma_f32_32x32x16_bf16 v[80:95], a[204:207], a[92:95], v[80:95]
ds_read_b64_tr_b16 a[244:245], v23 offset:20480
ds_read_b64_tr_b16 a[246:247], v23 offset:22528
v_add_f32 v26, v26, v47
v_cvt_pk_bf16_f32 v43, v46, v47
v_exp_f32 v56, v56
v_mfma_f32_32x32x16_bf16 v[64:79], a[208:211], a[96:99], v[64:79]
ds_read_b64_tr_b16 a[248:249], v24 offset:20480
ds_read_b64_tr_b16 a[250:251], v24 offset:22528
v_exp_f32 v57, v57
v_add_f32 v28, v28, v56
v_mov_b32 v9, 0
v_mfma_f32_32x32x16_bf16 v[80:95], a[208:211], a[100:103], v[80:95]
ds_read_b64_tr_b16 a[252:253], v25 offset:20480
s_waitcnt lgkmcnt(14)
ds_read_b64_tr_b16 a[254:255], v25 offset:22528
v_exp_f32 v58, v58
v_add_f32 v28, v28, v57
v_cvt_pk_bf16_f32 v56, v56, v57
v_mfma_f32_32x32x16_bf16 v[64:79], a[212:215], a[104:107], v[64:79]
s_add_u32 s40, s42, 0
v_exp_f32 v59, v59
v_add_f32 v28, v28, v58
v_exp_f32 v60, v60
v_mov_b32 v10, s68
v_mfma_f32_32x32x16_bf16 v[80:95], a[212:215], a[108:111], v[80:95]
buffer_load_dwordx4 a[128:131], v5, s[4:7], s40 offen offset:0 sc1
v_add_f32 v28, v28, v59
v_cvt_pk_bf16_f32 v57, v58, v59
v_exp_f32 v61, v61
v_mfma_f32_32x32x16_bf16 v[64:79], a[216:219], a[112:115], v[64:79]
s_sub_u32 s41, s84, 60817408
v_mov_b32 v11, s69
v_add_f32 v28, v28, v60
v_exp_f32 v62, v62
v_add_f32 v28, v28, v61
v_cvt_pk_bf16_f32 v58, v60, v61
v_mfma_f32_32x32x16_bf16 v[80:95], a[216:219], a[116:119], v[80:95]
buffer_load_dwordx4 a[132:135], v5, s[4:7], s40 offen offset:1024 sc1
v_exp_f32 v63, v63
v_add_f32 v28, v28, v62
v_add_f32 v28, v28, v63
v_mfma_f32_32x32x16_bf16 v[64:79], a[220:223], a[120:123], v[64:79]
s_lshr_b32 s41, s41, 4
s_add_u32 s41, s41, 60919808
s_max_u32 s41, s41, s62
v_cvt_pk_bf16_f32 v59, v62, v63
v_mfma_f32_32x32x16_bf16 v[80:95], a[220:223], a[124:127], v[80:95]
buffer_store_dwordx2 v[10:11], v9, s[4:7], s41 offen sc1
s_waitcnt lgkmcnt(8)
v_mfma_f32_32x32x16_bf16 v[128:143], a[224:227], v[32:35], v[128:143]
buffer_load_dwordx4 a[136:139], v5, s[4:7], s40 offen offset:2048 sc1
ds_read_b128 a[192:195], v14 offset:32768
v_mfma_f32_32x32x16_bf16 v[192:207], a[224:227], v[48:51], v[192:207]
ds_read_b128 a[196:199], v15 offset:32768
ds_read_b128 a[200:203], v16 offset:32768
v_mfma_f32_32x32x16_bf16 v[144:159], a[228:231], v[32:35], v[144:159]
ds_read_b128 a[204:207], v17 offset:32768
ds_read_b128 a[208:211], v18 offset:32768
v_mfma_f32_32x32x16_bf16 v[208:223], a[228:231], v[48:51], v[208:223]
buffer_load_dwordx4 a[140:143], v5, s[4:7], s40 offen offset:3072 sc1
ds_read_b128 a[212:215], v19 offset:32768
s_add_u32 s40, s42, 4096
v_exp_f32 v64, v64
v_mfma_f32_32x32x16_bf16 v[160:175], a[232:235], v[32:35], v[160:175]
ds_read_b128 a[216:219], v20 offset:32768
s_waitcnt lgkmcnt(14)
ds_read_b128 a[220:223], v21 offset:32768
v_exp_f32 v65, v65
v_add_f32 v26, v26, v64
v_mfma_f32_32x32x16_bf16 v[224:239], a[232:235], v[48:51], v[224:239]
v_exp_f32 v66, v66
v_add_f32 v26, v26, v65
v_cvt_pk_bf16_f32 v64, v64, v65
v_exp_f32 v67, v67
v_mfma_f32_32x32x16_bf16 v[176:191], a[236:239], v[32:35], v[176:191]
v_add_f32 v26, v26, v66
v_exp_f32 v68, v68
v_add_f32 v26, v26, v67
v_cvt_pk_bf16_f32 v65, v66, v67
v_mfma_f32_32x32x16_bf16 v[240:255], a[236:239], v[48:51], v[240:255]
buffer_load_dwordx4 a[144:147], v5, s[4:7], s40 offen offset:0 sc1
s_waitcnt lgkmcnt(8)
v_exp_f32 v69, v69
v_add_f32 v26, v26, v68
v_mfma_f32_32x32x16_bf16 v[128:143], a[240:243], v[40:43], v[128:143]
v_exp_f32 v70, v70
v_add_f32 v26, v26, v69
v_cvt_pk_bf16_f32 v66, v68, v69
v_exp_f32 v71, v71
v_mfma_f32_32x32x16_bf16 v[192:207], a[240:243], v[56:59], v[192:207]
v_add_f32 v26, v26, v70
v_add_f32 v26, v26, v71
v_cvt_pk_bf16_f32 v67, v70, v71
v_exp_f32 v80, v80
v_mfma_f32_32x32x16_bf16 v[144:159], a[244:247], v[40:43], v[144:159]
buffer_load_dwordx4 a[148:151], v5, s[4:7], s40 offen offset:1024 sc1
v_exp_f32 v81, v81
v_add_f32 v28, v28, v80
v_mfma_f32_32x32x16_bf16 v[208:223], a[244:247], v[56:59], v[208:223]
v_exp_f32 v82, v82
v_add_f32 v28, v28, v81
v_cvt_pk_bf16_f32 v80, v80, v81
v_exp_f32 v83, v83
v_mfma_f32_32x32x16_bf16 v[160:175], a[248:251], v[40:43], v[160:175]
v_add_f32 v28, v28, v82
v_exp_f32 v84, v84
v_add_f32 v28, v28, v83
v_cvt_pk_bf16_f32 v81, v82, v83
v_mfma_f32_32x32x16_bf16 v[224:239], a[248:251], v[56:59], v[224:239]
buffer_load_dwordx4 a[152:155], v5, s[4:7], s40 offen offset:2048 sc1
v_exp_f32 v85, v85
v_add_f32 v28, v28, v84
v_mfma_f32_32x32x16_bf16 v[176:191], a[252:255], v[40:43], v[176:191]
v_exp_f32 v86, v86
v_add_f32 v28, v28, v85
v_cvt_pk_bf16_f32 v82, v84, v85
v_exp_f32 v87, v87
v_mfma_f32_32x32x16_bf16 v[240:255], a[252:255], v[56:59], v[240:255]
s_waitcnt lgkmcnt(0)
v_add_f32 v28, v28, v86
v_add_f32 v28, v28, v87
v_cvt_pk_bf16_f32 v83, v86, v87
v_mfma_f32_32x32x16_bf16 v[32:47], a[192:195], a[64:67], 0
buffer_load_dwordx4 a[156:159], v5, s[4:7], s40 offen offset:3072 sc1
ds_read_b64_tr_b16 a[224:225], v22 offset:24576
s_add_u32 s40, s42, 8192
v_exp_f32 v72, v72
v_mfma_f32_32x32x16_bf16 v[48:63], a[192:195], a[68:71], 0
ds_read_b64_tr_b16 a[226:227], v22 offset:26624
ds_read_b64_tr_b16 a[228:229], v23 offset:24576
v_exp_f32 v73, v73
v_add_f32 v26, v26, v72
v_mfma_f32_32x32x16_bf16 v[32:47], a[196:199], a[72:75], v[32:47]
ds_read_b64_tr_b16 a[230:231], v23 offset:26624
ds_read_b64_tr_b16 a[232:233], v24 offset:24576
v_exp_f32 v74, v74
v_add_f32 v26, v26, v73
v_cvt_pk_bf16_f32 v72, v72, v73
v_mfma_f32_32x32x16_bf16 v[48:63], a[196:199], a[76:79], v[48:63]
buffer_load_dwordx4 a[160:163], v5, s[4:7], s40 offen offset:0 sc1
ds_read_b64_tr_b16 a[234:235], v24 offset:26624
v_exp_f32 v75, v75
v_add_f32 v26, v26, v74
v_mfma_f32_32x32x16_bf16 v[32:47], a[200:203], a[80:83], v[32:47]
ds_read_b64_tr_b16 a[236:237], v25 offset:24576
ds_read_b64_tr_b16 a[238:239], v25 offset:26624
v_exp_f32 v76, v76
v_add_f32 v26, v26, v75
v_cvt_pk_bf16_f32 v73, v74, v75
v_mfma_f32_32x32x16_bf16 v[48:63], a[200:203], a[84:87], v[48:63]
ds_read_b64_tr_b16 a[240:241], v22 offset:28672
ds_read_b64_tr_b16 a[242:243], v22 offset:30720
v_exp_f32 v77, v77
v_add_f32 v26, v26, v76
v_mfma_f32_32x32x16_bf16 v[32:47], a[204:207], a[88:91], v[32:47]
buffer_load_dwordx4 a[164:167], v5, s[4:7], s40 offen offset:1024 sc1
ds_read_b64_tr_b16 a[244:245], v23 offset:28672
v_exp_f32 v78, v78
v_add_f32 v26, v26, v77
v_mfma_f32_32x32x16_bf16 v[48:63], a[204:207], a[92:95], v[48:63]
ds_read_b64_tr_b16 a[246:247], v23 offset:30720
ds_read_b64_tr_b16 a[248:249], v24 offset:28672
v_cvt_pk_bf16_f32 v74, v76, v77
v_exp_f32 v79, v79
v_add_f32 v26, v26, v78
v_mfma_f32_32x32x16_bf16 v[32:47], a[208:211], a[96:99], v[32:47]
ds_read_b64_tr_b16 a[250:251], v24 offset:30720
ds_read_b64_tr_b16 a[252:253], v25 offset:28672
v_add_f32 v26, v26, v79
v_cvt_pk_bf16_f32 v75, v78, v79
v_exp_f32 v88, v88
v_mfma_f32_32x32x16_bf16 v[48:63], a[208:211], a[100:103], v[48:63]
buffer_load_dwordx4 a[168:171], v5, s[4:7], s40 offen offset:2048 sc1
s_waitcnt lgkmcnt(14)
ds_read_b64_tr_b16 a[254:255], v25 offset:30720
v_exp_f32 v89, v89
v_add_f32 v28, v28, v88
v_mfma_f32_32x32x16_bf16 v[32:47], a[212:215], a[104:107], v[32:47]
v_exp_f32 v90, v90
v_add_f32 v28, v28, v89
v_cvt_pk_bf16_f32 v88, v88, v89
v_exp_f32 v91, v91
v_mfma_f32_32x32x16_bf16 v[48:63], a[212:215], a[108:111], v[48:63]
v_add_f32 v28, v28, v90
v_exp_f32 v92, v92
v_add_f32 v28, v28, v91
v_cvt_pk_bf16_f32 v89, v90, v91
v_mfma_f32_32x32x16_bf16 v[32:47], a[216:219], a[112:115], v[32:47]
buffer_load_dwordx4 a[172:175], v5, s[4:7], s40 offen offset:3072 sc1
s_add_u32 s40, s42, 12288
v_exp_f32 v93, v93
v_add_f32 v28, v28, v92
v_mfma_f32_32x32x16_bf16 v[48:63], a[216:219], a[116:119], v[48:63]
v_exp_f32 v94, v94
v_add_f32 v28, v28, v93
v_cvt_pk_bf16_f32 v90, v92, v93
v_exp_f32 v95, v95
v_mfma_f32_32x32x16_bf16 v[32:47], a[220:223], a[120:123], v[32:47]
v_add_f32 v28, v28, v94
v_add_f32 v28, v28, v95
v_cvt_pk_bf16_f32 v91, v94, v95
v_mfma_f32_32x32x16_bf16 v[48:63], a[220:223], a[124:127], v[48:63]
s_waitcnt lgkmcnt(8)
v_mfma_f32_32x32x16_bf16 v[128:143], a[224:227], v[64:67], v[128:143]
buffer_load_dwordx4 a[176:179], v5, s[4:7], s40 offen offset:0 sc1
ds_read_b128 a[192:195], v14 offset:40960
v_mfma_f32_32x32x16_bf16 v[192:207], a[224:227], v[80:83], v[192:207]
ds_read_b128 a[196:199], v15 offset:40960
ds_read_b128 a[200:203], v16 offset:40960
v_xor_b32 v1, 0x10000, v1
v_mfma_f32_32x32x16_bf16 v[144:159], a[228:231], v[64:67], v[144:159]
ds_read_b128 a[204:207], v17 offset:40960
ds_read_b128 a[208:211], v18 offset:40960
v_xor_b32 v2, 0x10000, v2
v_mfma_f32_32x32x16_bf16 v[208:223], a[228:231], v[80:83], v[208:223]
buffer_load_dwordx4 a[180:183], v5, s[4:7], s40 offen offset:1024 sc1
ds_read_b128 a[212:215], v19 offset:40960
v_xor_b32 v3, 0x10000, v3
v_exp_f32 v32, v32
v_mfma_f32_32x32x16_bf16 v[160:175], a[232:235], v[64:67], v[160:175]
ds_read_b128 a[216:219], v20 offset:40960
s_waitcnt lgkmcnt(14)
ds_read_b128 a[220:223], v21 offset:40960
v_exp_f32 v33, v33
v_add_f32 v26, v26, v32
v_xor_b32 v4, 0x10000, v4
v_mfma_f32_32x32x16_bf16 v[224:239], a[232:235], v[80:83], v[224:239]
v_exp_f32 v34, v34
v_add_f32 v26, v26, v33
v_cvt_pk_bf16_f32 v32, v32, v33
v_exp_f32 v35, v35
v_mfma_f32_32x32x16_bf16 v[176:191], a[236:239], v[64:67], v[176:191]
buffer_load_dwordx4 a[184:187], v5, s[4:7], s40 offen offset:2048 sc1
v_add_f32 v26, v26, v34
v_exp_f32 v36, v36
v_add_f32 v26, v26, v35
v_mfma_f32_32x32x16_bf16 v[240:255], a[236:239], v[80:83], v[240:255]
s_waitcnt lgkmcnt(8)
v_cvt_pk_bf16_f32 v33, v34, v35
v_exp_f32 v37, v37
v_add_f32 v26, v26, v36
v_exp_f32 v38, v38
v_mfma_f32_32x32x16_bf16 v[128:143], a[240:243], v[72:75], v[128:143]
v_add_f32 v26, v26, v37
v_cvt_pk_bf16_f32 v34, v36, v37
v_exp_f32 v39, v39
v_add_f32 v26, v26, v38
v_add_f32 v26, v26, v39
v_mfma_f32_32x32x16_bf16 v[192:207], a[240:243], v[88:91], v[192:207]
buffer_load_dwordx4 a[188:191], v5, s[4:7], s40 offen offset:3072 sc1
s_add_u32 m0, s37, 49152
v_cvt_pk_bf16_f32 v35, v38, v39
v_exp_f32 v48, v48
v_mfma_f32_32x32x16_bf16 v[144:159], a[244:247], v[72:75], v[144:159]
s_mov_b32 s39, 442368
v_exp_f32 v49, v49
v_add_f32 v28, v28, v48
v_exp_f32 v50, v50
v_add_f32 v28, v28, v49
v_mfma_f32_32x32x16_bf16 v[208:223], a[244:247], v[88:91], v[208:223]
v_cvt_pk_bf16_f32 v48, v48, v49
v_exp_f32 v51, v51
v_add_f32 v28, v28, v50
v_exp_f32 v52, v52
v_mfma_f32_32x32x16_bf16 v[160:175], a[248:251], v[72:75], v[160:175]
buffer_load_dwordx4 v7, s[16:19], s39 offen offset:0  lds
v_add_f32 v28, v28, v51
v_cvt_pk_bf16_f32 v49, v50, v51
v_exp_f32 v53, v53
v_mfma_f32_32x32x16_bf16 v[224:239], a[248:251], v[88:91], v[224:239]
s_mov_b32 s38, 468992
v_add_f32 v28, v28, v52
v_exp_f32 v54, v54
v_add_f32 v28, v28, v53
v_cvt_pk_bf16_f32 v50, v52, v53
v_mfma_f32_32x32x16_bf16 v[176:191], a[252:255], v[72:75], v[176:191]
v_exp_f32 v55, v55
v_add_f32 v28, v28, v54
v_add_f32 v28, v28, v55
v_cvt_pk_bf16_f32 v51, v54, v55
v_mfma_f32_32x32x16_bf16 v[240:255], a[252:255], v[88:91], v[240:255]
buffer_load_dwordx4 v7, s[16:19], s38 offen offset:1024  lds
s_mov_b32 s39, 495616
s_waitcnt lgkmcnt(0)
v_mfma_f32_32x32x16_bf16 v[64:79], a[192:195], a[64:67], 0
s_barrier
v_exp_f32 v40, v40
v_mfma_f32_32x32x16_bf16 v[80:95], a[192:195], a[68:71], 0
ds_read_b64_tr_b16 a[224:225], v22 offset:49152
v_exp_f32 v41, v41
v_add_f32 v26, v26, v40
v_exp_f32 v42, v42
v_mfma_f32_32x32x16_bf16 v[64:79], a[196:199], a[72:75], v[64:79]
buffer_load_dwordx4 v7, s[16:19], s39 offen offset:2048  lds
ds_read_b64_tr_b16 a[226:227], v22 offset:51200
s_mov_b32 s38, 522240
v_add_f32 v26, v26, v41
v_cvt_pk_bf16_f32 v40, v40, v41
v_mfma_f32_32x32x16_bf16 v[80:95], a[196:199], a[76:79], v[80:95]
ds_read_b64_tr_b16 a[228:229], v23 offset:49152
ds_read_b64_tr_b16 a[230:231], v23 offset:51200
v_exp_f32 v43, v43
v_add_f32 v26, v26, v42
v_mfma_f32_32x32x16_bf16 v[64:79], a[200:203], a[80:83], v[64:79]
ds_read_b64_tr_b16 a[232:233], v24 offset:49152
ds_read_b64_tr_b16 a[234:235], v24 offset:51200
v_exp_f32 v44, v44
v_add_f32 v26, v26, v43
v_cvt_pk_bf16_f32 v41, v42, v43
v_mfma_f32_32x32x16_bf16 v[80:95], a[200:203], a[84:87], v[80:95]
buffer_load_dwordx4 v7, s[16:19], s38 offen offset:3072  lds
ds_read_b64_tr_b16 a[236:237], v25 offset:49152
v_exp_f32 v45, v45
v_add_f32 v26, v26, v44
v_mfma_f32_32x32x16_bf16 v[64:79], a[204:207], a[88:91], v[64:79]
ds_read_b64_tr_b16 a[238:239], v25 offset:51200
ds_read_b64_tr_b16 a[240:241], v22 offset:53248
v_exp_f32 v46, v46
v_add_f32 v26, v26, v45
v_cvt_pk_bf16_f32 v42, v44, v45
v_mfma_f32_32x32x16_bf16 v[80:95], a[204:207], a[92:95], v[80:95]
ds_read_b64_tr_b16 a[242:243], v22 offset:55296
ds_read_b64_tr_b16 a[244:245], v23 offset:53248
v_exp_f32 v47, v47
v_add_f32 v26, v26, v46
v_add_f32 v26, v26, v47
v_mfma_f32_32x32x16_bf16 v[64:79], a[208:211], a[96:99], v[64:79]
ds_read_b64_tr_b16 a[246:247], v23 offset:55296
ds_read_b64_tr_b16 a[248:249], v24 offset:53248
s_add_u32 m0, s37, 65536
v_cvt_pk_bf16_f32 v43, v46, v47
v_exp_f32 v56, v56
v_mfma_f32_32x32x16_bf16 v[80:95], a[208:211], a[100:103], v[80:95]
ds_read_b64_tr_b16 a[250:251], v24 offset:55296
ds_read_b64_tr_b16 a[252:253], v25 offset:53248
v_exp_f32 v57, v57
v_add_f32 v28, v28, v56
v_add_u32 v16, 4096, v5
v_mfma_f32_32x32x16_bf16 v[64:79], a[212:215], a[104:107], v[64:79]
s_waitcnt lgkmcnt(14)
ds_read_b64_tr_b16 a[254:255], v25 offset:55296
s_mov_b32 s39, 884736
v_exp_f32 v58, v58
v_add_f32 v28, v28, v57
v_cvt_pk_bf16_f32 v56, v56, v57
v_mfma_f32_32x32x16_bf16 v[80:95], a[212:215], a[108:111], v[80:95]
buffer_load_dwordx4 v7, s[12:15], s39 offen offset:0  lds
s_mov_b32 s38, 911360
v_exp_f32 v59, v59
v_add_f32 v28, v28, v58
v_mfma_f32_32x32x16_bf16 v[64:79], a[216:219], a[112:115], v[64:79]
v_exp_f32 v60, v60
v_add_f32 v28, v28, v59
v_cvt_pk_bf16_f32 v57, v58, v59
v_exp_f32 v61, v61
v_mfma_f32_32x32x16_bf16 v[80:95], a[216:219], a[116:119], v[80:95]
buffer_load_dwordx4 v7, s[12:15], s38 offen offset:1024  lds
v_add_f32 v28, v28, v60
v_exp_f32 v62, v62
v_add_f32 v28, v28, v61
v_mfma_f32_32x32x16_bf16 v[64:79], a[220:223], a[120:123], v[64:79]
s_mov_b32 s39, 937984
v_cvt_pk_bf16_f32 v58, v60, v61
v_exp_f32 v63, v63
v_add_f32 v28, v28, v62
v_add_f32 v28, v28, v63
v_cvt_pk_bf16_f32 v59, v62, v63
v_mfma_f32_32x32x16_bf16 v[80:95], a[220:223], a[124:127], v[80:95]
s_waitcnt lgkmcnt(8)
v_mfma_f32_32x32x16_bf16 v[128:143], a[224:227], v[32:35], v[128:143]
buffer_load_dwordx4 v7, s[12:15], s39 offen offset:2048  lds
s_mov_b32 s38, 964608
v_mfma_f32_32x32x16_bf16 v[192:207], a[224:227], v[48:51], v[192:207]
ds_read_b64_tr_b16 a[224:225], v22 offset:57344
ds_read_b64_tr_b16 a[226:227], v22 offset:59392
v_mfma_f32_32x32x16_bf16 v[144:159], a[228:231], v[32:35], v[144:159]
v_exp_f32 v64, v64
v_mfma_f32_32x32x16_bf16 v[208:223], a[228:231], v[48:51], v[208:223]
ds_read_b64_tr_b16 a[228:229], v23 offset:57344
ds_read_b64_tr_b16 a[230:231], v23 offset:59392
v_exp_f32 v65, v65
v_add_f32 v26, v26, v64
v_mfma_f32_32x32x16_bf16 v[160:175], a[232:235], v[32:35], v[160:175]
buffer_load_dwordx4 v7, s[12:15], s38 offen offset:3072  lds
v_exp_f32 v66, v66
v_add_f32 v26, v26, v65
v_cvt_pk_bf16_f32 v64, v64, v65
v_mfma_f32_32x32x16_bf16 v[224:239], a[232:235], v[48:51], v[224:239]
ds_read_b64_tr_b16 a[232:233], v24 offset:57344
ds_read_b64_tr_b16 a[234:235], v24 offset:59392
v_exp_f32 v67, v67
v_add_f32 v26, v26, v66
v_mfma_f32_32x32x16_bf16 v[176:191], a[236:239], v[32:35], v[176:191]
v_exp_f32 v68, v68
v_add_f32 v26, v26, v67
v_cvt_pk_bf16_f32 v65, v66, v67
v_exp_f32 v69, v69
v_mfma_f32_32x32x16_bf16 v[240:255], a[236:239], v[48:51], v[240:255]
ds_read_b64_tr_b16 a[236:237], v25 offset:57344
s_waitcnt lgkmcnt(14)
ds_read_b64_tr_b16 a[238:239], v25 offset:59392
s_waitcnt lgkmcnt(8)
v_add_f32 v26, v26, v68
v_exp_f32 v70, v70
v_mfma_f32_32x32x16_bf16 v[128:143], a[240:243], v[40:43], v[128:143]
v_add_f32 v26, v26, v69
v_cvt_pk_bf16_f32 v66, v68, v69
v_exp_f32 v71, v71
v_add_f32 v26, v26, v70
v_add_f32 v26, v26, v71
v_mfma_f32_32x32x16_bf16 v[192:207], a[240:243], v[56:59], v[192:207]
ds_read_b64_tr_b16 a[240:241], v22 offset:61440
ds_read_b64_tr_b16 a[242:243], v22 offset:63488
v_cvt_pk_bf16_f32 v67, v70, v71
v_exp_f32 v80, v80
v_mfma_f32_32x32x16_bf16 v[144:159], a[244:247], v[40:43], v[144:159]
v_exp_f32 v81, v81
v_add_f32 v28, v28, v80
v_exp_f32 v82, v82
v_add_f32 v28, v28, v81
v_mfma_f32_32x32x16_bf16 v[208:223], a[244:247], v[56:59], v[208:223]
ds_read_b64_tr_b16 a[244:245], v23 offset:61440
ds_read_b64_tr_b16 a[246:247], v23 offset:63488
v_cvt_pk_bf16_f32 v80, v80, v81
v_exp_f32 v83, v83
v_add_f32 v28, v28, v82
v_mfma_f32_32x32x16_bf16 v[160:175], a[248:251], v[40:43], v[160:175]
v_exp_f32 v84, v84
v_add_f32 v28, v28, v83
v_cvt_pk_bf16_f32 v81, v82, v83
v_exp_f32 v85, v85
v_mfma_f32_32x32x16_bf16 v[224:239], a[248:251], v[56:59], v[224:239]
ds_read_b64_tr_b16 a[248:249], v24 offset:61440
ds_read_b64_tr_b16 a[250:251], v24 offset:63488
v_add_f32 v28, v28, v84
v_exp_f32 v86, v86
v_add_f32 v28, v28, v85
v_mfma_f32_32x32x16_bf16 v[176:191], a[252:255], v[40:43], v[176:191]
v_cvt_pk_bf16_f32 v82, v84, v85
v_exp_f32 v87, v87
v_add_f32 v28, v28, v86
v_add_f32 v28, v28, v87
v_cvt_pk_bf16_f32 v83, v86, v87
v_mfma_f32_32x32x16_bf16 v[240:255], a[252:255], v[56:59], v[240:255]
ds_read_b64_tr_b16 a[252:253], v25 offset:61440
s_waitcnt lgkmcnt(14)
ds_read_b64_tr_b16 a[254:255], v25 offset:63488
v_exp_f32 v72, v72
v_exp_f32 v73, v73
v_add_f32 v26, v26, v72
v_exp_f32 v74, v74
v_add_f32 v26, v26, v73
v_cvt_pk_bf16_f32 v72, v72, v73
v_exp_f32 v75, v75
v_add_f32 v26, v26, v74
v_exp_f32 v76, v76
v_add_f32 v26, v26, v75
v_cvt_pk_bf16_f32 v73, v74, v75
v_exp_f32 v77, v77
v_add_f32 v26, v26, v76
v_exp_f32 v78, v78
v_add_f32 v26, v26, v77
v_cvt_pk_bf16_f32 v74, v76, v77
v_exp_f32 v79, v79
v_add_f32 v26, v26, v78
v_add_f32 v26, v26, v79
v_cvt_pk_bf16_f32 v75, v78, v79
v_exp_f32 v88, v88
v_exp_f32 v89, v89
v_add_f32 v28, v28, v88
v_exp_f32 v90, v90
v_add_f32 v28, v28, v89
v_cvt_pk_bf16_f32 v88, v88, v89
v_exp_f32 v91, v91
v_add_f32 v28, v28, v90
v_exp_f32 v92, v92
v_add_f32 v28, v28, v91
v_cvt_pk_bf16_f32 v89, v90, v91
v_exp_f32 v93, v93
v_add_f32 v28, v28, v92
v_exp_f32 v94, v94
v_add_f32 v28, v28, v93
v_cvt_pk_bf16_f32 v90, v92, v93
v_exp_f32 v95, v95
v_add_f32 v28, v28, v94
v_add_f32 v28, v28, v95
v_cvt_pk_bf16_f32 v91, v94, v95
v_mov_b32 v29, v26
v_mov_b32 v30, v28
s_nop 0
v_permlane32_swap_b32 v26, v29
v_permlane32_swap_b32 v28, v30
v_add_f32 v26, v26, v29
v_add_f32 v28, v28, v30
v_add_f32 v29, v26, v28
v_min_f32 v30, v26, v28
s_mov_b32 s55, 0x21800000
v_cmp_nge_f32 vcc, s53, v29
v_cmp_gt_f32 s[56:57], s55, v30
s_nop 3
s_or_b64 vcc, vcc, s[56:57]
s_cbranch_vccnz Lfb
Lfb_r:
s_waitcnt lgkmcnt(8)
v_mfma_f32_32x32x16_bf16 v[128:143], a[224:227], v[64:67], v[128:143]
s_add_u32 s40, s42, 36864
v_rcp_f32 v26, v26
v_rcp_f32 v28, v28
v_add_u32 v14, 61440, v5
s_waitcnt lgkmcnt(0)
s_barrier
v_mfma_f32_32x32x16_bf16 v[192:207], a[224:227], v[80:83], v[192:207]
buffer_load_dwordx4 a[64:67], v5, s[4:7], s40 offen offset:0 sc1
ds_read_b64_tr_b16 a[192:193], v1 offset:0
v_add_u32 v15, 122880, v5
v_lshrrev_b32 v29, 6, v0
v_add_u32 v29, 0, v29
v_mfma_f32_32x32x16_bf16 v[144:159], a[228:231], v[64:67], v[144:159]
buffer_load_dwordx4 a[68:71], v5, s[4:7], s40 offen offset:1024 sc1
ds_read_b64_tr_b16 a[194:195], v1 offset:2048
v_bfe_u32 v30, v29, 1, 1
v_mul_u32_u24 v30, 110592, v30
v_and_b32 v29, 1, v29
v_mfma_f32_32x32x16_bf16 v[208:223], a[228:231], v[80:83], v[208:223]
ds_read_b64_tr_b16 a[196:197], v1 offset:4096
ds_read_b64_tr_b16 a[198:199], v1 offset:6144
v_lshl_add_u32 v30, v29, 10, v30
v_add_u32 v17, v30, v5
v_lshrrev_b32 v29, 6, v0
v_add_u32 v29, 1, v29
v_mfma_f32_32x32x16_bf16 v[160:175], a[232:235], v[64:67], v[160:175]
buffer_load_dwordx4 a[72:75], v5, s[4:7], s40 offen offset:2048 sc1
ds_read_b64_tr_b16 a[200:201], v1 offset:8192
v_bfe_u32 v30, v29, 1, 1
v_mul_u32_u24 v30, 110592, v30
v_and_b32 v29, 1, v29
v_mfma_f32_32x32x16_bf16 v[224:239], a[232:235], v[80:83], v[224:239]
ds_read_b64_tr_b16 a[202:203], v1 offset:10240
ds_read_b64_tr_b16 a[204:205], v1 offset:12288
v_lshl_add_u32 v30, v29, 10, v30
v_add_u32 v18, v30, v5
v_lshrrev_b32 v29, 6, v0
v_add_u32 v29, 2, v29
v_mfma_f32_32x32x16_bf16 v[176:191], a[236:239], v[64:67], v[176:191]
buffer_load_dwordx4 a[76:79], v5, s[4:7], s40 offen offset:3072 sc1
ds_read_b64_tr_b16 a[206:207], v1 offset:14336
v_bfe_u32 v30, v29, 1, 1
v_mul_u32_u24 v30, 110592, v30
v_and_b32 v29, 1, v29
v_mfma_f32_32x32x16_bf16 v[240:255], a[236:239], v[80:83], v[240:255]
s_add_u32 s40, s42, 40960
v_lshl_add_u32 v30, v29, 10, v30
v_add_u32 v19, v30, v5
v_lshrrev_b32 v29, 6, v0
v_add_u32 v29, 3, v29
v_bfe_u32 v30, v29, 1, 1
v_mul_u32_u24 v30, 110592, v30
v_mfma_f32_32x32x16_bf16 v[128:143], a[240:243], v[72:75], v[128:143]
buffer_load_dwordx4 a[80:83], v5, s[4:7], s40 offen offset:0 sc1
v_and_b32 v29, 1, v29
v_lshl_add_u32 v30, v29, 10, v30
v_add_u32 v20, v30, v5
v_and_b32 v29, 7, v0
v_mfma_f32_32x32x16_bf16 v[192:207], a[240:243], v[88:91], v[192:207]
v_lshlrev_b32 v22, 7, v29
v_and_b32 v29, 31, v0
v_lshlrev_b32 v23, 4, v29
v_lshrrev_b32 v29, 6, v0
v_and_b32 v30, 15, v0
v_lshl_add_u32 v29, v29, 4, v30
v_mfma_f32_32x32x16_bf16 v[144:159], a[244:247], v[72:75], v[144:159]
buffer_load_dwordx4 a[84:87], v5, s[4:7], s40 offen offset:1024 sc1
s_and_b32 s56, s65, 1
v_mul_u32_u24 v29, 1280, v29
v_bfe_u32 v30, v0, 4, 2
v_lshl_add_u32 v29, v30, 3, v29
v_mfma_f32_32x32x16_bf16 v[208:223], a[244:247], v[88:91], v[208:223]
s_xor_b32 s57, s56, 1
s_lshl_b32 s58, s56, 5
s_lshl_b32 s59, s57, 7
v_add_u32 v21, s58, v29
v_add_u32 v27, s59, v29
s_lshl_b32 s58, s56, 10
v_add_u32 v6, s58, v5
v_mfma_f32_32x32x16_bf16 v[160:175], a[248:251], v[72:75], v[160:175]
buffer_load_dwordx4 a[88:91], v5, s[4:7], s40 offen offset:2048 sc1
s_lshl_b32 s59, s57, 12
v_add_u32 v8, s59, v5
v_bfe_u32 v29, v0, 5, 1
v_and_b32 v30, 15, v0
v_mfma_f32_32x32x16_bf16 v[224:239], a[248:251], v[88:91], v[224:239]
v_lshl_add_u32 v29, v29, 4, v30
v_bfe_u32 v30, v0, 4, 1
v_mul_u32_u24 v30, 5120, v30
v_lshl_add_u32 v12, v29, 4, v30
v_lshl_add_u32 v13, v29, 3, v30
v_mfma_f32_32x32x16_bf16 v[176:191], a[252:255], v[72:75], v[176:191]
buffer_load_dwordx4 a[92:95], v5, s[4:7], s40 offen offset:3072 sc1
v_mfma_f32_32x32x16_bf16 v[240:255], a[252:255], v[88:91], v[240:255]
s_cmp_ge_u32 s51, 27
s_cbranch_scc1 L1_noffn
s_mov_b32 s59, 60919808
v_lshlrev_b32 v30, 3, v0
buffer_load_dwordx2 v[24:25], v30, s[4:7], s59 offen sc1
v_pk_mul_f32 v[128:129], v[128:129], v[26:27] op_sel_hi:[1,0]
v_pk_mul_f32 v[130:131], v[130:131], v[26:27] op_sel_hi:[1,0]
v_pk_mul_f32 v[132:133], v[132:133], v[26:27] op_sel_hi:[1,0]
v_pk_mul_f32 v[134:135], v[134:135], v[26:27] op_sel_hi:[1,0]
v_pk_mul_f32 v[136:137], v[136:137], v[26:27] op_sel_hi:[1,0]
v_pk_mul_f32 v[138:139], v[138:139], v[26:27] op_sel_hi:[1,0]
v_pk_mul_f32 v[140:141], v[140:141], v[26:27] op_sel_hi:[1,0]
v_pk_mul_f32 v[142:143], v[142:143], v[26:27] op_sel_hi:[1,0]
v_cvt_pk_bf16_f32 v32, v128, v129
v_cvt_pk_bf16_f32 v33, v130, v131
v_cvt_pk_bf16_f32 v34, v132, v133
v_cvt_pk_bf16_f32 v35, v134, v135
v_cvt_pk_bf16_f32 v36, v136, v137
v_cvt_pk_bf16_f32 v37, v138, v139
v_cvt_pk_bf16_f32 v38, v140, v141
v_cvt_pk_bf16_f32 v39, v142, v143
s_add_u32 s41, s44, 0
buffer_store_dwordx4 v[32:35], v5, s[4:7], s41 offen offset:0 sc1
v_pk_mul_f32 v[144:145], v[144:145], v[26:27] op_sel_hi:[1,0]
v_pk_mul_f32 v[146:147], v[146:147], v[26:27] op_sel_hi:[1,0]
v_pk_mul_f32 v[148:149], v[148:149], v[26:27] op_sel_hi:[1,0]
v_pk_mul_f32 v[150:151], v[150:151], v[26:27] op_sel_hi:[1,0]
v_pk_mul_f32 v[152:153], v[152:153], v[26:27] op_sel_hi:[1,0]
v_pk_mul_f32 v[154:155], v[154:155], v[26:27] op_sel_hi:[1,0]
v_pk_mul_f32 v[156:157], v[156:157], v[26:27] op_sel_hi:[1,0]
v_pk_mul_f32 v[158:159], v[158:159], v[26:27] op_sel_hi:[1,0]
v_cvt_pk_bf16_f32 v40, v144, v145
v_cvt_pk_bf16_f32 v41, v146, v147
v_cvt_pk_bf16_f32 v42, v148, v149
v_cvt_pk_bf16_f32 v43, v150, v151
v_cvt_pk_bf16_f32 v44, v152, v153
v_cvt_pk_bf16_f32 v45, v154, v155
v_cvt_pk_bf16_f32 v46, v156, v157
v_cvt_pk_bf16_f32 v47, v158, v159
v_pk_mul_f32 v[160:161], v[160:161], v[26:27] op_sel_hi:[1,0]
v_pk_mul_f32 v[162:163], v[162:163], v[26:27] op_sel_hi:[1,0]
v_pk_mul_f32 v[164:165], v[164:165], v[26:27] op_sel_hi:[1,0]
v_pk_mul_f32 v[166:167], v[166:167], v[26:27] op_sel_hi:[1,0]
v_pk_mul_f32 v[168:169], v[168:169], v[26:27] op_sel_hi:[1,0]
v_pk_mul_f32 v[170:171], v[170:171], v[26:27] op_sel_hi:[1,0]
v_pk_mul_f32 v[172:173], v[172:173], v[26:27] op_sel_hi:[1,0]
v_pk_mul_f32 v[174:175], v[174:175], v[26:27] op_sel_hi:[1,0]
v_cvt_pk_bf16_f32 v48, v160, v161
v_cvt_pk_bf16_f32 v49, v162, v163
v_cvt_pk_bf16_f32 v50, v164, v165
v_cvt_pk_bf16_f32 v51, v166, v167
v_cvt_pk_bf16_f32 v52, v168, v169
v_cvt_pk_bf16_f32 v53, v170, v171
v_cvt_pk_bf16_f32 v54, v172, v173
v_cvt_pk_bf16_f32 v55, v174, v175
v_pk_mul_f32 v[176:177], v[176:177], v[26:27] op_sel_hi:[1,0]
v_pk_mul_f32 v[178:179], v[178:179], v[26:27] op_sel_hi:[1,0]
v_pk_mul_f32 v[180:181], v[180:181], v[26:27] op_sel_hi:[1,0]
v_pk_mul_f32 v[182:183], v[182:183], v[26:27] op_sel_hi:[1,0]
v_pk_mul_f32 v[184:185], v[184:185], v[26:27] op_sel_hi:[1,0]
v_pk_mul_f32 v[186:187], v[186:187], v[26:27] op_sel_hi:[1,0]
v_pk_mul_f32 v[188:189], v[188:189], v[26:27] op_sel_hi:[1,0]
v_pk_mul_f32 v[190:191], v[190:191], v[26:27] op_sel_hi:[1,0]
buffer_store_dwordx4 v[36:39], v5, s[4:7], s41 offen offset:1024 sc1
v_cvt_pk_bf16_f32 v56, v176, v177
v_cvt_pk_bf16_f32 v57, v178, v179
v_cvt_pk_bf16_f32 v58, v180, v181
v_cvt_pk_bf16_f32 v59, v182, v183
v_cvt_pk_bf16_f32 v60, v184, v185
v_cvt_pk_bf16_f32 v61, v186, v187
v_cvt_pk_bf16_f32 v62, v188, v189
v_cvt_pk_bf16_f32 v63, v190, v191
v_pk_mul_f32 v[192:193], v[192:193], v[28:29] op_sel_hi:[1,0]
v_pk_mul_f32 v[194:195], v[194:195], v[28:29] op_sel_hi:[1,0]
v_pk_mul_f32 v[196:197], v[196:197], v[28:29] op_sel_hi:[1,0]
v_pk_mul_f32 v[198:199], v[198:199], v[28:29] op_sel_hi:[1,0]
v_pk_mul_f32 v[200:201], v[200:201], v[28:29] op_sel_hi:[1,0]
v_pk_mul_f32 v[202:203], v[202:203], v[28:29] op_sel_hi:[1,0]
v_pk_mul_f32 v[204:205], v[204:205], v[28:29] op_sel_hi:[1,0]
v_pk_mul_f32 v[206:207], v[206:207], v[28:29] op_sel_hi:[1,0]
v_cvt_pk_bf16_f32 v64, v192, v193
v_cvt_pk_bf16_f32 v65, v194, v195
v_cvt_pk_bf16_f32 v66, v196, v197
v_cvt_pk_bf16_f32 v67, v198, v199
v_cvt_pk_bf16_f32 v68, v200, v201
v_cvt_pk_bf16_f32 v69, v202, v203
v_cvt_pk_bf16_f32 v70, v204, v205
v_cvt_pk_bf16_f32 v71, v206, v207
v_pk_mul_f32 v[208:209], v[208:209], v[28:29] op_sel_hi:[1,0]
v_pk_mul_f32 v[210:211], v[210:211], v[28:29] op_sel_hi:[1,0]
v_pk_mul_f32 v[212:213], v[212:213], v[28:29] op_sel_hi:[1,0]
v_pk_mul_f32 v[214:215], v[214:215], v[28:29] op_sel_hi:[1,0]
v_pk_mul_f32 v[216:217], v[216:217], v[28:29] op_sel_hi:[1,0]
v_pk_mul_f32 v[218:219], v[218:219], v[28:29] op_sel_hi:[1,0]
v_pk_mul_f32 v[220:221], v[220:221], v[28:29] op_sel_hi:[1,0]
v_pk_mul_f32 v[222:223], v[222:223], v[28:29] op_sel_hi:[1,0]
v_cvt_pk_bf16_f32 v72, v208, v209
v_cvt_pk_bf16_f32 v73, v210, v211
v_cvt_pk_bf16_f32 v74, v212, v213
v_cvt_pk_bf16_f32 v75, v214, v215
v_cvt_pk_bf16_f32 v76, v216, v217
v_cvt_pk_bf16_f32 v77, v218, v219
v_cvt_pk_bf16_f32 v78, v220, v221
v_cvt_pk_bf16_f32 v79, v222, v223
buffer_store_dwordx4 v[40:43], v5, s[4:7], s41 offen offset:2048 sc1
v_pk_mul_f32 v[224:225], v[224:225], v[28:29] op_sel_hi:[1,0]
v_pk_mul_f32 v[226:227], v[226:227], v[28:29] op_sel_hi:[1,0]
v_pk_mul_f32 v[228:229], v[228:229], v[28:29] op_sel_hi:[1,0]
v_pk_mul_f32 v[230:231], v[230:231], v[28:29] op_sel_hi:[1,0]
v_pk_mul_f32 v[232:233], v[232:233], v[28:29] op_sel_hi:[1,0]
v_pk_mul_f32 v[234:235], v[234:235], v[28:29] op_sel_hi:[1,0]
v_pk_mul_f32 v[236:237], v[236:237], v[28:29] op_sel_hi:[1,0]
v_pk_mul_f32 v[238:239], v[238:239], v[28:29] op_sel_hi:[1,0]
v_cvt_pk_bf16_f32 v80, v224, v225
v_cvt_pk_bf16_f32 v81, v226, v227
v_cvt_pk_bf16_f32 v82, v228, v229
v_cvt_pk_bf16_f32 v83, v230, v231
v_cvt_pk_bf16_f32 v84, v232, v233
v_cvt_pk_bf16_f32 v85, v234, v235
v_cvt_pk_bf16_f32 v86, v236, v237
v_cvt_pk_bf16_f32 v87, v238, v239
v_pk_mul_f32 v[240:241], v[240:241], v[28:29] op_sel_hi:[1,0]
v_pk_mul_f32 v[242:243], v[242:243], v[28:29] op_sel_hi:[1,0]
v_pk_mul_f32 v[244:245], v[244:245], v[28:29] op_sel_hi:[1,0]
v_pk_mul_f32 v[246:247], v[246:247], v[28:29] op_sel_hi:[1,0]
v_pk_mul_f32 v[248:249], v[248:249], v[28:29] op_sel_hi:[1,0]
v_pk_mul_f32 v[250:251], v[250:251], v[28:29] op_sel_hi:[1,0]
v_pk_mul_f32 v[252:253], v[252:253], v[28:29] op_sel_hi:[1,0]
v_pk_mul_f32 v[254:255], v[254:255], v[28:29] op_sel_hi:[1,0]
v_cvt_pk_bf16_f32 v88, v240, v241
v_cvt_pk_bf16_f32 v89, v242, v243
v_cvt_pk_bf16_f32 v90, v244, v245
v_cvt_pk_bf16_f32 v91, v246, v247
v_cvt_pk_bf16_f32 v92, v248, v249
v_cvt_pk_bf16_f32 v93, v250, v251
v_cvt_pk_bf16_f32 v94, v252, v253
v_cvt_pk_bf16_f32 v95, v254, v255
s_waitcnt vmcnt(3)
v_cmp_ne_u64 vcc, s[68:69], v[24:25]
s_nop 3
s_cbranch_vccnz Lp_gF
Lr_gF:
s_waitcnt lgkmcnt(4)
v_mfma_f32_16x16x32_bf16 v[128:131], a[192:195], a[128:131], 0
ds_read_b64_tr_b16 a[208:209], v2 offset:0
v_mfma_f32_16x16x32_bf16 v[128:131], a[196:199], a[132:135], v[128:131]
s_waitcnt lgkmcnt(1)
v_mfma_f32_16x16x32_bf16 v[128:131], a[200:203], a[136:139], v[128:131]
buffer_store_dwordx4 v[44:47], v5, s[4:7], s41 offen offset:3072 sc1
v_mfma_f32_16x16x32_bf16 v[128:131], a[204:207], a[140:143], v[128:131]
ds_read_b64_tr_b16 a[210:211], v2 offset:2048
s_add_u32 s41, s44, 4096
v_mfma_f32_16x16x32_bf16 v[132:135], a[192:195], a[144:147], 0
ds_read_b64_tr_b16 a[212:213], v2 offset:4096
v_mfma_f32_16x16x32_bf16 v[132:135], a[196:199], a[148:151], v[132:135]
ds_read_b64_tr_b16 a[214:215], v2 offset:6144
v_mfma_f32_16x16x32_bf16 v[132:135], a[200:203], a[152:155], v[132:135]
ds_read_b64_tr_b16 a[216:217], v2 offset:8192
v_mfma_f32_16x16x32_bf16 v[132:135], a[204:207], a[156:159], v[132:135]
v_mfma_f32_16x16x32_bf16 v[136:139], a[192:195], a[160:163], 0
ds_read_b64_tr_b16 a[218:219], v2 offset:10240
v_mfma_f32_16x16x32_bf16 v[136:139], a[196:199], a[164:167], v[136:139]
ds_read_b64_tr_b16 a[220:221], v2 offset:12288
v_mfma_f32_16x16x32_bf16 v[136:139], a[200:203], a[168:171], v[136:139]
v_mfma_f32_16x16x32_bf16 v[136:139], a[204:207], a[172:175], v[136:139]
ds_read_b64_tr_b16 a[222:223], v2 offset:14336
v_mfma_f32_16x16x32_bf16 v[140:143], a[192:195], a[176:179], 0
v_mfma_f32_16x16x32_bf16 v[140:143], a[196:199], a[180:183], v[140:143]
v_mfma_f32_16x16x32_bf16 v[140:143], a[200:203], a[184:187], v[140:143]
v_mfma_f32_16x16x32_bf16 v[140:143], a[204:207], a[188:191], v[140:143]
s_waitcnt lgkmcnt(0)
v_mfma_f32_16x16x32_bf16 v[144:147], a[208:211], a[128:131], 0
buffer_store_dwordx4 v[48:51], v5, s[4:7], s41 offen offset:0 sc1
v_mfma_f32_16x16x32_bf16 v[144:147], a[212:215], a[132:135], v[144:147]
ds_read_b64_tr_b16 a[192:193], v3 offset:0
v_mfma_f32_16x16x32_bf16 v[144:147], a[216:219], a[136:139], v[144:147]
ds_read_b64_tr_b16 a[194:195], v3 offset:2048
v_mfma_f32_16x16x32_bf16 v[144:147], a[220:223], a[140:143], v[144:147]
ds_read_b64_tr_b16 a[196:197], v3 offset:4096
v_mfma_f32_16x16x32_bf16 v[148:151], a[208:211], a[144:147], 0
v_mfma_f32_16x16x32_bf16 v[148:151], a[212:215], a[148:151], v[148:151]
ds_read_b64_tr_b16 a[198:199], v3 offset:6144
v_mfma_f32_16x16x32_bf16 v[148:151], a[216:219], a[152:155], v[148:151]
ds_read_b64_tr_b16 a[200:201], v3 offset:8192
v_mfma_f32_16x16x32_bf16 v[148:151], a[220:223], a[156:159], v[148:151]
v_mfma_f32_16x16x32_bf16 v[152:155], a[208:211], a[160:163], 0
ds_read_b64_tr_b16 a[202:203], v3 offset:10240
v_mfma_f32_16x16x32_bf16 v[152:155], a[212:215], a[164:167], v[152:155]
ds_read_b64_tr_b16 a[204:205], v3 offset:12288
v_mfma_f32_16x16x32_bf16 v[152:155], a[216:219], a[168:171], v[152:155]
v_mfma_f32_16x16x32_bf16 v[152:155], a[220:223], a[172:175], v[152:155]
ds_read_b64_tr_b16 a[206:207], v3 offset:14336
v_mfma_f32_16x16x32_bf16 v[156:159], a[208:211], a[176:179], 0
v_mfma_f32_16x16x32_bf16 v[156:159], a[212:215], a[180:183], v[156:159]
buffer_store_dwordx4 v[52:55], v5, s[4:7], s41 offen offset:1024 sc1
v_mfma_f32_16x16x32_bf16 v[156:159], a[216:219], a[184:187], v[156:159]
v_mfma_f32_16x16x32_bf16 v[156:159], a[220:223], a[188:191], v[156:159]
s_waitcnt lgkmcnt(0)
v_mfma_f32_16x16x32_bf16 v[160:163], a[192:195], a[128:131], 0
ds_read_b64_tr_b16 a[208:209], v4 offset:0
v_mfma_f32_16x16x32_bf16 v[160:163], a[196:199], a[132:135], v[160:163]
v_mfma_f32_16x16x32_bf16 v[160:163], a[200:203], a[136:139], v[160:163]
ds_read_b64_tr_b16 a[210:211], v4 offset:2048
v_mfma_f32_16x16x32_bf16 v[160:163], a[204:207], a[140:143], v[160:163]
ds_read_b64_tr_b16 a[212:213], v4 offset:4096
v_mfma_f32_16x16x32_bf16 v[164:167], a[192:195], a[144:147], 0
v_mfma_f32_16x16x32_bf16 v[164:167], a[196:199], a[148:151], v[164:167]
ds_read_b64_tr_b16 a[214:215], v4 offset:6144
v_mfma_f32_16x16x32_bf16 v[164:167], a[200:203], a[152:155], v[164:167]
ds_read_b64_tr_b16 a[216:217], v4 offset:8192
v_mfma_f32_16x16x32_bf16 v[164:167], a[204:207], a[156:159], v[164:167]
v_mfma_f32_16x16x32_bf16 v[168:171], a[192:195], a[160:163], 0
ds_read_b64_tr_b16 a[218:219], v4 offset:10240
v_mfma_f32_16x16x32_bf16 v[168:171], a[196:199], a[164:167], v[168:171]
ds_read_b64_tr_b16 a[220:221], v4 offset:12288
v_mfma_f32_16x16x32_bf16 v[168:171], a[200:203], a[168:171], v[168:171]
buffer_store_dwordx4 v[56:59], v5, s[4:7], s41 offen offset:2048 sc1
v_mfma_f32_16x16x32_bf16 v[168:171], a[204:207], a[172:175], v[168:171]
ds_read_b64_tr_b16 a[222:223], v4 offset:14336
v_mfma_f32_16x16x32_bf16 v[172:175], a[192:195], a[176:179], 0
v_mfma_f32_16x16x32_bf16 v[172:175], a[196:199], a[180:183], v[172:175]
v_mfma_f32_16x16x32_bf16 v[172:175], a[200:203], a[184:187], v[172:175]
v_mfma_f32_16x16x32_bf16 v[172:175], a[204:207], a[188:191], v[172:175]
s_waitcnt lgkmcnt(0)
v_mfma_f32_16x16x32_bf16 v[176:179], a[208:211], a[128:131], 0
v_mfma_f32_16x16x32_bf16 v[176:179], a[212:215], a[132:135], v[176:179]
v_mfma_f32_16x16x32_bf16 v[176:179], a[216:219], a[136:139], v[176:179]
s_barrier
v_mfma_f32_16x16x32_bf16 v[176:179], a[220:223], a[140:143], v[176:179]
ds_read_b64_tr_b16 a[192:193], v1 offset:16384
v_mfma_f32_16x16x32_bf16 v[180:183], a[208:211], a[144:147], 0
v_mfma_f32_16x16x32_bf16 v[180:183], a[212:215], a[148:151], v[180:183]
ds_read_b64_tr_b16 a[194:195], v1 offset:18432
v_mfma_f32_16x16x32_bf16 v[180:183], a[216:219], a[152:155], v[180:183]
ds_read_b64_tr_b16 a[196:197], v1 offset:20480
v_mfma_f32_16x16x32_bf16 v[180:183], a[220:223], a[156:159], v[180:183]
buffer_store_dwordx4 v[60:63], v5, s[4:7], s41 offen offset:3072 sc1
v_mfma_f32_16x16x32_bf16 v[184:187], a[208:211], a[160:163], 0
ds_read_b64_tr_b16 a[198:199], v1 offset:22528
s_add_u32 s41, s44, 266496
v_mfma_f32_16x16x32_bf16 v[184:187], a[212:215], a[164:167], v[184:187]
ds_read_b64_tr_b16 a[200:201], v1 offset:24576
v_mfma_f32_16x16x32_bf16 v[184:187], a[216:219], a[168:171], v[184:187]
ds_read_b64_tr_b16 a[202:203], v1 offset:26624
v_mfma_f32_16x16x32_bf16 v[184:187], a[220:223], a[172:175], v[184:187]
ds_read_b64_tr_b16 a[204:205], v1 offset:28672
v_mfma_f32_16x16x32_bf16 v[188:191], a[208:211], a[176:179], 0
ds_read_b64_tr_b16 a[206:207], v1 offset:30720
v_mfma_f32_16x16x32_bf16 v[188:191], a[212:215], a[180:183], v[188:191]
v_mfma_f32_16x16x32_bf16 v[188:191], a[216:219], a[184:187], v[188:191]
v_mfma_f32_16x16x32_bf16 v[188:191], a[220:223], a[188:191], v[188:191]
s_waitcnt lgkmcnt(4)
v_mfma_f32_16x16x32_bf16 v[192:195], a[192:195], a[128:131], 0
ds_read_b64_tr_b16 a[208:209], v2 offset:16384
v_mfma_f32_16x16x32_bf16 v[192:195], a[196:199], a[132:135], v[192:195]
s_waitcnt lgkmcnt(1)
v_mfma_f32_16x16x32_bf16 v[192:195], a[200:203], a[136:139], v[192:195]
ds_read_b64_tr_b16 a[210:211], v2 offset:18432
v_mfma_f32_16x16x32_bf16 v[192:195], a[204:207], a[140:143], v[192:195]
ds_read_b64_tr_b16 a[212:213], v2 offset:20480
v_mfma_f32_16x16x32_bf16 v[196:199], a[192:195], a[144:147], 0
buffer_store_dwordx4 v[64:67], v5, s[4:7], s41 offen offset:0 sc1
v_mfma_f32_16x16x32_bf16 v[196:199], a[196:199], a[148:151], v[196:199]
ds_read_b64_tr_b16 a[214:215], v2 offset:22528
v_mfma_f32_16x16x32_bf16 v[196:199], a[200:203], a[152:155], v[196:199]
ds_read_b64_tr_b16 a[216:217], v2 offset:24576
v_mfma_f32_16x16x32_bf16 v[196:199], a[204:207], a[156:159], v[196:199]
v_mfma_f32_16x16x32_bf16 v[200:203], a[192:195], a[160:163], 0
ds_read_b64_tr_b16 a[218:219], v2 offset:26624
v_mfma_f32_16x16x32_bf16 v[200:203], a[196:199], a[164:167], v[200:203]
ds_read_b64_tr_b16 a[220:221], v2 offset:28672
v_mfma_f32_16x16x32_bf16 v[200:203], a[200:203], a[168:171], v[200:203]
v_mfma_f32_16x16x32_bf16 v[200:203], a[204:207], a[172:175], v[200:203]
ds_read_b64_tr_b16 a[222:223], v2 offset:30720
v_mfma_f32_16x16x32_bf16 v[204:207], a[192:195], a[176:179], 0
v_mfma_f32_16x16x32_bf16 v[204:207], a[196:199], a[180:183], v[204:207]
v_mfma_f32_16x16x32_bf16 v[204:207], a[200:203], a[184:187], v[204:207]
v_mfma_f32_16x16x32_bf16 v[204:207], a[204:207], a[188:191], v[204:207]
s_waitcnt lgkmcnt(0)
v_mfma_f32_16x16x32_bf16 v[208:211], a[208:211], a[128:131], 0
ds_read_b64_tr_b16 a[192:193], v3 offset:16384
v_mfma_f32_16x16x32_bf16 v[208:211], a[212:215], a[132:135], v[208:211]
buffer_store_dwordx4 v[68:71], v5, s[4:7], s41 offen offset:1024 sc1
v_mfma_f32_16x16x32_bf16 v[208:211], a[216:219], a[136:139], v[208:211]
ds_read_b64_tr_b16 a[194:195], v3 offset:18432
v_mfma_f32_16x16x32_bf16 v[208:211], a[220:223], a[140:143], v[208:211]
ds_read_b64_tr_b16 a[196:197], v3 offset:20480
v_mfma_f32_16x16x32_bf16 v[212:215], a[208:211], a[144:147], 0
v_mfma_f32_16x16x32_bf16 v[212:215], a[212:215], a[148:151], v[212:215]
ds_read_b64_tr_b16 a[198:199], v3 offset:22528
v_mfma_f32_16x16x32_bf16 v[212:215], a[216:219], a[152:155], v[212:215]
ds_read_b64_tr_b16 a[200:201], v3 offset:24576
v_mfma_f32_16x16x32_bf16 v[212:215], a[220:223], a[156:159], v[212:215]
v_mfma_f32_16x16x32_bf16 v[216:219], a[208:211], a[160:163], 0
ds_read_b64_tr_b16 a[202:203], v3 offset:26624
v_mfma_f32_16x16x32_bf16 v[216:219], a[212:215], a[164:167], v[216:219]
ds_read_b64_tr_b16 a[204:205], v3 offset:28672
v_mfma_f32_16x16x32_bf16 v[216:219], a[216:219], a[168:171], v[216:219]
v_mfma_f32_16x16x32_bf16 v[216:219], a[220:223], a[172:175], v[216:219]
ds_read_b64_tr_b16 a[206:207], v3 offset:30720
v_mfma_f32_16x16x32_bf16 v[220:223], a[208:211], a[176:179], 0
v_mfma_f32_16x16x32_bf16 v[220:223], a[212:215], a[180:183], v[220:223]
v_mfma_f32_16x16x32_bf16 v[220:223], a[216:219], a[184:187], v[220:223]
buffer_store_dwordx4 v[72:75], v5, s[4:7], s41 offen offset:2048 sc1
v_mfma_f32_16x16x32_bf16 v[220:223], a[220:223], a[188:191], v[220:223]
s_waitcnt lgkmcnt(0)
v_mfma_f32_16x16x32_bf16 v[224:227], a[192:195], a[128:131], 0
ds_read_b64_tr_b16 a[208:209], v4 offset:16384
v_mfma_f32_16x16x32_bf16 v[224:227], a[196:199], a[132:135], v[224:227]
v_mfma_f32_16x16x32_bf16 v[224:227], a[200:203], a[136:139], v[224:227]
ds_read_b64_tr_b16 a[210:211], v4 offset:18432
v_mfma_f32_16x16x32_bf16 v[224:227], a[204:207], a[140:143], v[224:227]
ds_read_b64_tr_b16 a[212:213], v4 offset:20480
v_mfma_f32_16x16x32_bf16 v[228:231], a[192:195], a[144:147], 0
v_mfma_f32_16x16x32_bf16 v[228:231], a[196:199], a[148:151], v[228:231]
ds_read_b64_tr_b16 a[214:215], v4 offset:22528
v_mfma_f32_16x16x32_bf16 v[228:231], a[200:203], a[152:155], v[228:231]
ds_read_b64_tr_b16 a[216:217], v4 offset:24576
v_mfma_f32_16x16x32_bf16 v[228:231], a[204:207], a[156:159], v[228:231]
v_mfma_f32_16x16x32_bf16 v[232:235], a[192:195], a[160:163], 0
ds_read_b64_tr_b16 a[218:219], v4 offset:26624
v_mfma_f32_16x16x32_bf16 v[232:235], a[196:199], a[164:167], v[232:235]
ds_read_b64_tr_b16 a[220:221], v4 offset:28672
v_mfma_f32_16x16x32_bf16 v[232:235], a[200:203], a[168:171], v[232:235]
v_mfma_f32_16x16x32_bf16 v[232:235], a[204:207], a[172:175], v[232:235]
buffer_store_dwordx4 v[76:79], v5, s[4:7], s41 offen offset:3072 sc1
v_mfma_f32_16x16x32_bf16 v[236:239], a[192:195], a[176:179], 0
ds_read_b64_tr_b16 a[222:223], v4 offset:30720
s_add_u32 s41, s44, 270592
v_mfma_f32_16x16x32_bf16 v[236:239], a[196:199], a[180:183], v[236:239]
v_mfma_f32_16x16x32_bf16 v[236:239], a[200:203], a[184:187], v[236:239]
v_mfma_f32_16x16x32_bf16 v[236:239], a[204:207], a[188:191], v[236:239]
s_waitcnt lgkmcnt(0)
v_mfma_f32_16x16x32_bf16 v[240:243], a[208:211], a[128:131], 0
v_mfma_f32_16x16x32_bf16 v[240:243], a[212:215], a[132:135], v[240:243]
v_mfma_f32_16x16x32_bf16 v[240:243], a[216:219], a[136:139], v[240:243]
s_barrier
v_mfma_f32_16x16x32_bf16 v[240:243], a[220:223], a[140:143], v[240:243]
ds_read_b64_tr_b16 a[192:193], v1 offset:32768
v_mfma_f32_16x16x32_bf16 v[244:247], a[208:211], a[144:147], 0
v_mfma_f32_16x16x32_bf16 v[244:247], a[212:215], a[148:151], v[244:247]
ds_read_b64_tr_b16 a[194:195], v1 offset:34816
v_mfma_f32_16x16x32_bf16 v[244:247], a[216:219], a[152:155], v[244:247]
ds_read_b64_tr_b16 a[196:197], v1 offset:36864
v_mfma_f32_16x16x32_bf16 v[244:247], a[220:223], a[156:159], v[244:247]
ds_read_b64_tr_b16 a[198:199], v1 offset:38912
v_mfma_f32_16x16x32_bf16 v[248:251], a[208:211], a[160:163], 0
buffer_store_dwordx4 v[80:83], v5, s[4:7], s41 offen offset:0 sc1
v_mfma_f32_16x16x32_bf16 v[248:251], a[212:215], a[164:167], v[248:251]
ds_read_b64_tr_b16 a[200:201], v1 offset:40960
v_mfma_f32_16x16x32_bf16 v[248:251], a[216:219], a[168:171], v[248:251]
ds_read_b64_tr_b16 a[202:203], v1 offset:43008
v_mfma_f32_16x16x32_bf16 v[248:251], a[220:223], a[172:175], v[248:251]
ds_read_b64_tr_b16 a[204:205], v1 offset:45056
v_mfma_f32_16x16x32_bf16 v[252:255], a[208:211], a[176:179], 0
ds_read_b64_tr_b16 a[206:207], v1 offset:47104
v_mfma_f32_16x16x32_bf16 v[252:255], a[212:215], a[180:183], v[252:255]
v_mfma_f32_16x16x32_bf16 v[252:255], a[216:219], a[184:187], v[252:255]
v_mfma_f32_16x16x32_bf16 v[252:255], a[220:223], a[188:191], v[252:255]
s_waitcnt lgkmcnt(4)
v_mfma_f32_16x16x32_bf16 v[128:131], a[192:195], a[0:3], v[128:131]
ds_read_b64_tr_b16 a[208:209], v2 offset:32768
v_mfma_f32_16x16x32_bf16 v[128:131], a[196:199], a[4:7], v[128:131]
s_waitcnt lgkmcnt(1)
v_mfma_f32_16x16x32_bf16 v[128:131], a[200:203], a[8:11], v[128:131]
ds_read_b64_tr_b16 a[210:211], v2 offset:34816
v_mfma_f32_16x16x32_bf16 v[128:131], a[204:207], a[12:15], v[128:131]
ds_read_b64_tr_b16 a[212:213], v2 offset:36864
v_mfma_f32_16x16x32_bf16 v[132:135], a[192:195], a[16:19], v[132:135]
v_mfma_f32_16x16x32_bf16 v[132:135], a[196:199], a[20:23], v[132:135]
buffer_store_dwordx4 v[84:87], v5, s[4:7], s41 offen offset:1024 sc1
v_mfma_f32_16x16x32_bf16 v[132:135], a[200:203], a[24:27], v[132:135]
ds_read_b64_tr_b16 a[214:215], v2 offset:38912
v_mfma_f32_16x16x32_bf16 v[132:135], a[204:207], a[28:31], v[132:135]
ds_read_b64_tr_b16 a[216:217], v2 offset:40960
v_mfma_f32_16x16x32_bf16 v[136:139], a[192:195], a[32:35], v[136:139]
ds_read_b64_tr_b16 a[218:219], v2 offset:43008
v_mfma_f32_16x16x32_bf16 v[136:139], a[196:199], a[36:39], v[136:139]
ds_read_b64_tr_b16 a[220:221], v2 offset:45056
v_mfma_f32_16x16x32_bf16 v[136:139], a[200:203], a[40:43], v[136:139]
v_mfma_f32_16x16x32_bf16 v[136:139], a[204:207], a[44:47], v[136:139]
ds_read_b64_tr_b16 a[222:223], v2 offset:47104
v_mfma_f32_16x16x32_bf16 v[140:143], a[192:195], a[48:51], v[140:143]
v_mfma_f32_16x16x32_bf16 v[140:143], a[196:199], a[52:55], v[140:143]
v_mfma_f32_16x16x32_bf16 v[140:143], a[200:203], a[56:59], v[140:143]
v_mfma_f32_16x16x32_bf16 v[140:143], a[204:207], a[60:63], v[140:143]
s_waitcnt lgkmcnt(0)
v_mfma_f32_16x16x32_bf16 v[144:147], a[208:211], a[0:3], v[144:147]
ds_read_b64_tr_b16 a[192:193], v3 offset:32768
v_mfma_f32_16x16x32_bf16 v[144:147], a[212:215], a[4:7], v[144:147]
v_mfma_f32_16x16x32_bf16 v[144:147], a[216:219], a[8:11], v[144:147]
buffer_store_dwordx4 v[88:91], v5, s[4:7], s41 offen offset:2048 sc1
v_mfma_f32_16x16x32_bf16 v[144:147], a[220:223], a[12:15], v[144:147]
ds_read_b64_tr_b16 a[194:195], v3 offset:34816
v_mfma_f32_16x16x32_bf16 v[148:151], a[208:211], a[16:19], v[148:151]
ds_read_b64_tr_b16 a[196:197], v3 offset:36864
v_mfma_f32_16x16x32_bf16 v[148:151], a[212:215], a[20:23], v[148:151]
ds_read_b64_tr_b16 a[198:199], v3 offset:38912
v_mfma_f32_16x16x32_bf16 v[148:151], a[216:219], a[24:27], v[148:151]
ds_read_b64_tr_b16 a[200:201], v3 offset:40960
v_mfma_f32_16x16x32_bf16 v[148:151], a[220:223], a[28:31], v[148:151]
v_mfma_f32_16x16x32_bf16 v[152:155], a[208:211], a[32:35], v[152:155]
ds_read_b64_tr_b16 a[202:203], v3 offset:43008
v_mfma_f32_16x16x32_bf16 v[152:155], a[212:215], a[36:39], v[152:155]
ds_read_b64_tr_b16 a[204:205], v3 offset:45056
v_mfma_f32_16x16x32_bf16 v[152:155], a[216:219], a[40:43], v[152:155]
v_mfma_f32_16x16x32_bf16 v[152:155], a[220:223], a[44:47], v[152:155]
ds_read_b64_tr_b16 a[206:207], v3 offset:47104
v_mfma_f32_16x16x32_bf16 v[156:159], a[208:211], a[48:51], v[156:159]
v_mfma_f32_16x16x32_bf16 v[156:159], a[212:215], a[52:55], v[156:159]
v_mfma_f32_16x16x32_bf16 v[156:159], a[216:219], a[56:59], v[156:159]
v_mfma_f32_16x16x32_bf16 v[156:159], a[220:223], a[60:63], v[156:159]
s_waitcnt lgkmcnt(0)
v_mfma_f32_16x16x32_bf16 v[160:163], a[192:195], a[0:3], v[160:163]
buffer_store_dwordx4 v[92:95], v5, s[4:7], s41 offen offset:3072 sc1
v_mfma_f32_16x16x32_bf16 v[160:163], a[196:199], a[4:7], v[160:163]
ds_read_b64_tr_b16 a[208:209], v4 offset:32768
v_mfma_f32_16x16x32_bf16 v[160:163], a[200:203], a[8:11], v[160:163]
ds_read_b64_tr_b16 a[210:211], v4 offset:34816
v_mfma_f32_16x16x32_bf16 v[160:163], a[204:207], a[12:15], v[160:163]
ds_read_b64_tr_b16 a[212:213], v4 offset:36864
v_mfma_f32_16x16x32_bf16 v[164:167], a[192:195], a[16:19], v[164:167]
v_mfma_f32_16x16x32_bf16 v[164:167], a[196:199], a[20:23], v[164:167]
ds_read_b64_tr_b16 a[214:215], v4 offset:38912
v_mfma_f32_16x16x32_bf16 v[164:167], a[200:203], a[24:27], v[164:167]
ds_read_b64_tr_b16 a[216:217], v4 offset:40960
v_mfma_f32_16x16x32_bf16 v[164:167], a[204:207], a[28:31], v[164:167]
v_mfma_f32_16x16x32_bf16 v[168:171], a[192:195], a[32:35], v[168:171]
ds_read_b64_tr_b16 a[218:219], v4 offset:43008
v_mfma_f32_16x16x32_bf16 v[168:171], a[196:199], a[36:39], v[168:171]
ds_read_b64_tr_b16 a[220:221], v4 offset:45056
v_mfma_f32_16x16x32_bf16 v[168:171], a[200:203], a[40:43], v[168:171]
v_mfma_f32_16x16x32_bf16 v[168:171], a[204:207], a[44:47], v[168:171]
ds_read_b64_tr_b16 a[222:223], v4 offset:47104
v_mfma_f32_16x16x32_bf16 v[172:175], a[192:195], a[48:51], v[172:175]
v_mfma_f32_16x16x32_bf16 v[172:175], a[196:199], a[52:55], v[172:175]
v_mfma_f32_16x16x32_bf16 v[172:175], a[200:203], a[56:59], v[172:175]
v_mfma_f32_16x16x32_bf16 v[172:175], a[204:207], a[60:63], v[172:175]
s_waitcnt lgkmcnt(0)
v_mfma_f32_16x16x32_bf16 v[176:179], a[208:211], a[0:3], v[176:179]
v_mfma_f32_16x16x32_bf16 v[176:179], a[212:215], a[4:7], v[176:179]
v_mfma_f32_16x16x32_bf16 v[176:179], a[216:219], a[8:11], v[176:179]
s_barrier
v_mfma_f32_16x16x32_bf16 v[176:179], a[220:223], a[12:15], v[176:179]
ds_read_b64_tr_b16 a[192:193], v1 offset:49152
v_mfma_f32_16x16x32_bf16 v[180:183], a[208:211], a[16:19], v[180:183]
v_mfma_f32_16x16x32_bf16 v[180:183], a[212:215], a[20:23], v[180:183]
ds_read_b64_tr_b16 a[194:195], v1 offset:51200
v_mfma_f32_16x16x32_bf16 v[180:183], a[216:219], a[24:27], v[180:183]
ds_read_b64_tr_b16 a[196:197], v1 offset:53248
v_mfma_f32_16x16x32_bf16 v[180:183], a[220:223], a[28:31], v[180:183]
ds_read_b64_tr_b16 a[198:199], v1 offset:55296
v_mfma_f32_16x16x32_bf16 v[184:187], a[208:211], a[32:35], v[184:187]
ds_read_b64_tr_b16 a[200:201], v1 offset:57344
v_mfma_f32_16x16x32_bf16 v[184:187], a[212:215], a[36:39], v[184:187]
ds_read_b64_tr_b16 a[202:203], v1 offset:59392
v_mfma_f32_16x16x32_bf16 v[184:187], a[216:219], a[40:43], v[184:187]
ds_read_b64_tr_b16 a[204:205], v1 offset:61440
v_mfma_f32_16x16x32_bf16 v[184:187], a[220:223], a[44:47], v[184:187]
ds_read_b64_tr_b16 a[206:207], v1 offset:63488
v_mfma_f32_16x16x32_bf16 v[188:191], a[208:211], a[48:51], v[188:191]
v_mfma_f32_16x16x32_bf16 v[188:191], a[212:215], a[52:55], v[188:191]
v_mfma_f32_16x16x32_bf16 v[188:191], a[216:219], a[56:59], v[188:191]
v_mfma_f32_16x16x32_bf16 v[188:191], a[220:223], a[60:63], v[188:191]
s_waitcnt lgkmcnt(4)
v_mfma_f32_16x16x32_bf16 v[192:195], a[192:195], a[0:3], v[192:195]
ds_read_b64_tr_b16 a[208:209], v2 offset:49152
v_mfma_f32_16x16x32_bf16 v[192:195], a[196:199], a[4:7], v[192:195]
s_waitcnt lgkmcnt(1)
v_mfma_f32_16x16x32_bf16 v[192:195], a[200:203], a[8:11], v[192:195]
ds_read_b64_tr_b16 a[210:211], v2 offset:51200
v_mfma_f32_16x16x32_bf16 v[192:195], a[204:207], a[12:15], v[192:195]
ds_read_b64_tr_b16 a[212:213], v2 offset:53248
v_mfma_f32_16x16x32_bf16 v[196:199], a[192:195], a[16:19], v[196:199]
v_mfma_f32_16x16x32_bf16 v[196:199], a[196:199], a[20:23], v[196:199]
ds_read_b64_tr_b16 a[214:215], v2 offset:55296
v_mfma_f32_16x16x32_bf16 v[196:199], a[200:203], a[24:27], v[196:199]
ds_read_b64_tr_b16 a[216:217], v2 offset:57344
v_mfma_f32_16x16x32_bf16 v[196:199], a[204:207], a[28:31], v[196:199]
v_mfma_f32_16x16x32_bf16 v[200:203], a[192:195], a[32:35], v[200:203]
ds_read_b64_tr_b16 a[218:219], v2 offset:59392
v_mfma_f32_16x16x32_bf16 v[200:203], a[196:199], a[36:39], v[200:203]
ds_read_b64_tr_b16 a[220:221], v2 offset:61440
v_mfma_f32_16x16x32_bf16 v[200:203], a[200:203], a[40:43], v[200:203]
v_mfma_f32_16x16x32_bf16 v[200:203], a[204:207], a[44:47], v[200:203]
ds_read_b64_tr_b16 a[222:223], v2 offset:63488
v_mfma_f32_16x16x32_bf16 v[204:207], a[192:195], a[48:51], v[204:207]
v_mfma_f32_16x16x32_bf16 v[204:207], a[196:199], a[52:55], v[204:207]
v_mfma_f32_16x16x32_bf16 v[204:207], a[200:203], a[56:59], v[204:207]
v_mfma_f32_16x16x32_bf16 v[204:207], a[204:207], a[60:63], v[204:207]
s_waitcnt lgkmcnt(0)
v_mfma_f32_16x16x32_bf16 v[208:211], a[208:211], a[0:3], v[208:211]
ds_read_b64_tr_b16 a[192:193], v3 offset:49152
s_add_u32 s40, s42, 45056
v_mfma_f32_16x16x32_bf16 v[208:211], a[212:215], a[4:7], v[208:211]
buffer_load_dwordx4 a[96:99], v5, s[4:7], s40 offen offset:0 sc1
v_mfma_f32_16x16x32_bf16 v[208:211], a[216:219], a[8:11], v[208:211]
ds_read_b64_tr_b16 a[194:195], v3 offset:51200
v_mfma_f32_16x16x32_bf16 v[208:211], a[220:223], a[12:15], v[208:211]
buffer_load_dwordx4 a[100:103], v5, s[4:7], s40 offen offset:1024 sc1
v_mfma_f32_16x16x32_bf16 v[212:215], a[208:211], a[16:19], v[212:215]
ds_read_b64_tr_b16 a[196:197], v3 offset:53248
v_mfma_f32_16x16x32_bf16 v[212:215], a[212:215], a[20:23], v[212:215]
ds_read_b64_tr_b16 a[198:199], v3 offset:55296
v_mfma_f32_16x16x32_bf16 v[212:215], a[216:219], a[24:27], v[212:215]
ds_read_b64_tr_b16 a[200:201], v3 offset:57344
v_mfma_f32_16x16x32_bf16 v[212:215], a[220:223], a[28:31], v[212:215]
buffer_load_dwordx4 a[104:107], v5, s[4:7], s40 offen offset:2048 sc1
v_mfma_f32_16x16x32_bf16 v[216:219], a[208:211], a[32:35], v[216:219]
ds_read_b64_tr_b16 a[202:203], v3 offset:59392
v_mfma_f32_16x16x32_bf16 v[216:219], a[212:215], a[36:39], v[216:219]
ds_read_b64_tr_b16 a[204:205], v3 offset:61440
v_mfma_f32_16x16x32_bf16 v[216:219], a[216:219], a[40:43], v[216:219]
v_mfma_f32_16x16x32_bf16 v[216:219], a[220:223], a[44:47], v[216:219]
buffer_load_dwordx4 a[108:111], v5, s[4:7], s40 offen offset:3072 sc1
v_mfma_f32_16x16x32_bf16 v[220:223], a[208:211], a[48:51], v[220:223]
ds_read_b64_tr_b16 a[206:207], v3 offset:63488
s_add_u32 m0, s37, 81920
v_mfma_f32_16x16x32_bf16 v[220:223], a[212:215], a[52:55], v[220:223]
s_mov_b32 s39, 884736
v_mfma_f32_16x16x32_bf16 v[220:223], a[216:219], a[56:59], v[220:223]
v_mfma_f32_16x16x32_bf16 v[220:223], a[220:223], a[60:63], v[220:223]
s_waitcnt lgkmcnt(0)
v_mfma_f32_16x16x32_bf16 v[224:227], a[192:195], a[0:3], v[224:227]
buffer_load_dwordx4 v7, s[16:19], s39 offen offset:0  lds
v_mfma_f32_16x16x32_bf16 v[224:227], a[196:199], a[4:7], v[224:227]
ds_read_b64_tr_b16 a[208:209], v4 offset:49152
s_mov_b32 s38, 911360
v_mfma_f32_16x16x32_bf16 v[224:227], a[200:203], a[8:11], v[224:227]
ds_read_b64_tr_b16 a[210:211], v4 offset:51200
v_mfma_f32_16x16x32_bf16 v[224:227], a[204:207], a[12:15], v[224:227]
buffer_load_dwordx4 v7, s[16:19], s38 offen offset:1024  lds
v_mfma_f32_16x16x32_bf16 v[228:231], a[192:195], a[16:19], v[228:231]
ds_read_b64_tr_b16 a[212:213], v4 offset:53248
s_mov_b32 s39, 937984
v_mfma_f32_16x16x32_bf16 v[228:231], a[196:199], a[20:23], v[228:231]
ds_read_b64_tr_b16 a[214:215], v4 offset:55296
v_mfma_f32_16x16x32_bf16 v[228:231], a[200:203], a[24:27], v[228:231]
ds_read_b64_tr_b16 a[216:217], v4 offset:57344
v_mfma_f32_16x16x32_bf16 v[228:231], a[204:207], a[28:31], v[228:231]
buffer_load_dwordx4 v7, s[16:19], s39 offen offset:2048  lds
v_mfma_f32_16x16x32_bf16 v[232:235], a[192:195], a[32:35], v[232:235]
ds_read_b64_tr_b16 a[218:219], v4 offset:59392
s_mov_b32 s38, 964608
v_mfma_f32_16x16x32_bf16 v[232:235], a[196:199], a[36:39], v[232:235]
ds_read_b64_tr_b16 a[220:221], v4 offset:61440
v_mfma_f32_16x16x32_bf16 v[232:235], a[200:203], a[40:43], v[232:235]
v_mfma_f32_16x16x32_bf16 v[232:235], a[204:207], a[44:47], v[232:235]
buffer_load_dwordx4 v7, s[16:19], s38 offen offset:3072  lds
v_mfma_f32_16x16x32_bf16 v[236:239], a[192:195], a[48:51], v[236:239]
ds_read_b64_tr_b16 a[222:223], v4 offset:63488
s_add_u32 s40, s42, 49152
v_mfma_f32_16x16x32_bf16 v[236:239], a[196:199], a[52:55], v[236:239]
v_mfma_f32_16x16x32_bf16 v[236:239], a[200:203], a[56:59], v[236:239]
v_mfma_f32_16x16x32_bf16 v[236:239], a[204:207], a[60:63], v[236:239]
s_waitcnt lgkmcnt(0)
v_mfma_f32_16x16x32_bf16 v[240:243], a[208:211], a[0:3], v[240:243]
buffer_load_dwordx4 a[128:131], v5, s[4:7], s40 offen offset:0 sc1
v_mfma_f32_16x16x32_bf16 v[240:243], a[212:215], a[4:7], v[240:243]
v_xor_b32 v1, 0x10000, v1
v_xor_b32 v2, 0x10000, v2
v_mfma_f32_16x16x32_bf16 v[240:243], a[216:219], a[8:11], v[240:243]
v_xor_b32 v3, 0x10000, v3
v_xor_b32 v4, 0x10000, v4
v_mfma_f32_16x16x32_bf16 v[240:243], a[220:223], a[12:15], v[240:243]
buffer_load_dwordx4 a[132:135], v5, s[4:7], s40 offen offset:1024 sc1
v_mfma_f32_16x16x32_bf16 v[244:247], a[208:211], a[16:19], v[244:247]
s_barrier
v_mfma_f32_16x16x32_bf16 v[244:247], a[212:215], a[20:23], v[244:247]
ds_read_b64_tr_b16 a[192:193], v1 offset:0
v_mfma_f32_16x16x32_bf16 v[244:247], a[216:219], a[24:27], v[244:247]
ds_read_b64_tr_b16 a[194:195], v1 offset:2048
v_mfma_f32_16x16x32_bf16 v[244:247], a[220:223], a[28:31], v[244:247]
ds_read_b64_tr_b16 a[196:197], v1 offset:4096
v_mfma_f32_16x16x32_bf16 v[248:251], a[208:211], a[32:35], v[248:251]
ds_read_b64_tr_b16 a[198:199], v1 offset:6144
v_mfma_f32_16x16x32_bf16 v[248:251], a[212:215], a[36:39], v[248:251]
ds_read_b64_tr_b16 a[200:201], v1 offset:8192
v_mfma_f32_16x16x32_bf16 v[248:251], a[216:219], a[40:43], v[248:251]
ds_read_b64_tr_b16 a[202:203], v1 offset:10240
v_mfma_f32_16x16x32_bf16 v[248:251], a[220:223], a[44:47], v[248:251]
ds_read_b64_tr_b16 a[204:205], v1 offset:12288
v_mfma_f32_16x16x32_bf16 v[252:255], a[208:211], a[48:51], v[252:255]
ds_read_b64_tr_b16 a[206:207], v1 offset:14336
v_mfma_f32_16x16x32_bf16 v[252:255], a[212:215], a[52:55], v[252:255]
buffer_load_dwordx4 a[136:139], v5, s[4:7], s40 offen offset:2048 sc1
v_mfma_f32_16x16x32_bf16 v[252:255], a[216:219], a[56:59], v[252:255]
v_mfma_f32_16x16x32_bf16 v[252:255], a[220:223], a[60:63], v[252:255]
s_waitcnt lgkmcnt(4)
v_mfma_f32_16x16x32_bf16 v[128:131], a[192:195], v[112:115], v[128:131]
buffer_load_dwordx4 a[140:143], v5, s[4:7], s40 offen offset:3072 sc1
v_mfma_f32_16x16x32_bf16 v[128:131], a[196:199], v[116:119], v[128:131]
ds_read_b64_tr_b16 a[208:209], v2 offset:0
s_waitcnt lgkmcnt(1)
v_mfma_f32_16x16x32_bf16 v[128:131], a[200:203], v[120:123], v[128:131]
ds_read_b64_tr_b16 a[210:211], v2 offset:2048
s_add_u32 s40, s42, 53248
v_mfma_f32_16x16x32_bf16 v[128:131], a[204:207], v[124:127], v[128:131]
buffer_load_dwordx4 a[144:147], v5, s[4:7], s40 offen offset:0 sc1
v_mfma_f32_16x16x32_bf16 v[132:135], a[192:195], a[64:67], v[132:135]
ds_read_b64_tr_b16 a[212:213], v2 offset:4096
v_mfma_f32_16x16x32_bf16 v[132:135], a[196:199], a[68:71], v[132:135]
ds_read_b64_tr_b16 a[214:215], v2 offset:6144
v_mfma_f32_16x16x32_bf16 v[132:135], a[200:203], a[72:75], v[132:135]
ds_read_b64_tr_b16 a[216:217], v2 offset:8192
v_mfma_f32_16x16x32_bf16 v[132:135], a[204:207], a[76:79], v[132:135]
buffer_load_dwordx4 a[148:151], v5, s[4:7], s40 offen offset:1024 sc1
v_mfma_f32_16x16x32_bf16 v[136:139], a[192:195], a[80:83], v[136:139]
ds_read_b64_tr_b16 a[218:219], v2 offset:10240
v_mfma_f32_16x16x32_bf16 v[136:139], a[196:199], a[84:87], v[136:139]
ds_read_b64_tr_b16 a[220:221], v2 offset:12288
v_mfma_f32_16x16x32_bf16 v[136:139], a[200:203], a[88:91], v[136:139]
v_mfma_f32_16x16x32_bf16 v[136:139], a[204:207], a[92:95], v[136:139]
ds_read_b64_tr_b16 a[222:223], v2 offset:14336
s_waitcnt vmcnt(13)
v_mfma_f32_16x16x32_bf16 v[140:143], a[192:195], a[96:99], v[140:143]
s_waitcnt vmcnt(12)
v_mfma_f32_16x16x32_bf16 v[140:143], a[196:199], a[100:103], v[140:143]
s_waitcnt vmcnt(11)
v_mfma_f32_16x16x32_bf16 v[140:143], a[200:203], a[104:107], v[140:143]
s_waitcnt vmcnt(10)
v_mfma_f32_16x16x32_bf16 v[140:143], a[204:207], a[108:111], v[140:143]
s_waitcnt lgkmcnt(0)
v_mfma_f32_16x16x32_bf16 v[144:147], a[208:211], v[112:115], v[144:147]
buffer_load_dwordx4 a[152:155], v5, s[4:7], s40 offen offset:2048 sc1
v_mfma_f32_16x16x32_bf16 v[144:147], a[212:215], v[116:119], v[144:147]
ds_read_b64_tr_b16 a[192:193], v3 offset:0
v_mfma_f32_16x16x32_bf16 v[144:147], a[216:219], v[120:123], v[144:147]
buffer_load_dwordx4 a[156:159], v5, s[4:7], s40 offen offset:3072 sc1
v_mfma_f32_16x16x32_bf16 v[144:147], a[220:223], v[124:127], v[144:147]
ds_read_b64_tr_b16 a[194:195], v3 offset:2048
s_add_u32 s40, s42, 57344
v_mfma_f32_16x16x32_bf16 v[148:151], a[208:211], a[64:67], v[148:151]
ds_read_b64_tr_b16 a[196:197], v3 offset:4096
v_mfma_f32_16x16x32_bf16 v[148:151], a[212:215], a[68:71], v[148:151]
ds_read_b64_tr_b16 a[198:199], v3 offset:6144
v_mfma_f32_16x16x32_bf16 v[148:151], a[216:219], a[72:75], v[148:151]
buffer_load_dwordx4 a[160:163], v5, s[4:7], s40 offen offset:0 sc1
v_mfma_f32_16x16x32_bf16 v[148:151], a[220:223], a[76:79], v[148:151]
ds_read_b64_tr_b16 a[200:201], v3 offset:8192
v_mfma_f32_16x16x32_bf16 v[152:155], a[208:211], a[80:83], v[152:155]
ds_read_b64_tr_b16 a[202:203], v3 offset:10240
v_mfma_f32_16x16x32_bf16 v[152:155], a[212:215], a[84:87], v[152:155]
ds_read_b64_tr_b16 a[204:205], v3 offset:12288
v_mfma_f32_16x16x32_bf16 v[152:155], a[216:219], a[88:91], v[152:155]
buffer_load_dwordx4 a[164:167], v5, s[4:7], s40 offen offset:1024 sc1
v_mfma_f32_16x16x32_bf16 v[152:155], a[220:223], a[92:95], v[152:155]
ds_read_b64_tr_b16 a[206:207], v3 offset:14336
v_mfma_f32_16x16x32_bf16 v[156:159], a[208:211], a[96:99], v[156:159]
v_mfma_f32_16x16x32_bf16 v[156:159], a[212:215], a[100:103], v[156:159]
v_mfma_f32_16x16x32_bf16 v[156:159], a[216:219], a[104:107], v[156:159]
buffer_load_dwordx4 a[168:171], v5, s[4:7], s40 offen offset:2048 sc1
v_mfma_f32_16x16x32_bf16 v[156:159], a[220:223], a[108:111], v[156:159]
s_waitcnt lgkmcnt(0)
v_mfma_f32_16x16x32_bf16 v[160:163], a[192:195], v[112:115], v[160:163]
ds_read_b64_tr_b16 a[208:209], v4 offset:0
v_mfma_f32_16x16x32_bf16 v[160:163], a[196:199], v[116:119], v[160:163]
v_mfma_f32_16x16x32_bf16 v[160:163], a[200:203], v[120:123], v[160:163]
buffer_load_dwordx4 a[172:175], v5, s[4:7], s40 offen offset:3072 sc1
v_mfma_f32_16x16x32_bf16 v[160:163], a[204:207], v[124:127], v[160:163]
ds_read_b64_tr_b16 a[210:211], v4 offset:2048
s_add_u32 s40, s42, 61440
v_mfma_f32_16x16x32_bf16 v[164:167], a[192:195], a[64:67], v[164:167]
ds_read_b64_tr_b16 a[212:213], v4 offset:4096
v_mfma_f32_16x16x32_bf16 v[164:167], a[196:199], a[68:71], v[164:167]
ds_read_b64_tr_b16 a[214:215], v4 offset:6144
v_mfma_f32_16x16x32_bf16 v[164:167], a[200:203], a[72:75], v[164:167]
buffer_load_dwordx4 a[176:179], v5, s[4:7], s40 offen offset:0 sc1
v_mfma_f32_16x16x32_bf16 v[164:167], a[204:207], a[76:79], v[164:167]
ds_read_b64_tr_b16 a[216:217], v4 offset:8192
v_mfma_f32_16x16x32_bf16 v[168:171], a[192:195], a[80:83], v[168:171]
ds_read_b64_tr_b16 a[218:219], v4 offset:10240
v_mfma_f32_16x16x32_bf16 v[168:171], a[196:199], a[84:87], v[168:171]
ds_read_b64_tr_b16 a[220:221], v4 offset:12288
v_mfma_f32_16x16x32_bf16 v[168:171], a[200:203], a[88:91], v[168:171]
buffer_load_dwordx4 a[180:183], v5, s[4:7], s40 offen offset:1024 sc1
v_mfma_f32_16x16x32_bf16 v[168:171], a[204:207], a[92:95], v[168:171]
ds_read_b64_tr_b16 a[222:223], v4 offset:14336
v_mfma_f32_16x16x32_bf16 v[172:175], a[192:195], a[96:99], v[172:175]
v_mfma_f32_16x16x32_bf16 v[172:175], a[196:199], a[100:103], v[172:175]
v_mfma_f32_16x16x32_bf16 v[172:175], a[200:203], a[104:107], v[172:175]
buffer_load_dwordx4 a[184:187], v5, s[4:7], s40 offen offset:2048 sc1
v_mfma_f32_16x16x32_bf16 v[172:175], a[204:207], a[108:111], v[172:175]
s_waitcnt lgkmcnt(0)
v_mfma_f32_16x16x32_bf16 v[176:179], a[208:211], v[112:115], v[176:179]
v_mfma_f32_16x16x32_bf16 v[176:179], a[212:215], v[116:119], v[176:179]
v_mfma_f32_16x16x32_bf16 v[176:179], a[216:219], v[120:123], v[176:179]
buffer_load_dwordx4 a[188:191], v5, s[4:7], s40 offen offset:3072 sc1
v_mfma_f32_16x16x32_bf16 v[176:179], a[220:223], v[124:127], v[176:179]
s_waitcnt vmcnt(16)
s_barrier
s_add_u32 m0, s37, 98304
s_mov_b32 s39, 1327104
v_mfma_f32_16x16x32_bf16 v[180:183], a[208:211], a[64:67], v[180:183]
ds_read_b64_tr_b16 a[192:193], v1 offset:16384
v_mfma_f32_16x16x32_bf16 v[180:183], a[212:215], a[68:71], v[180:183]
ds_read_b64_tr_b16 a[194:195], v1 offset:18432
v_mfma_f32_16x16x32_bf16 v[180:183], a[216:219], a[72:75], v[180:183]
buffer_load_dwordx4 v7, s[12:15], s39 offen offset:0  lds
v_mfma_f32_16x16x32_bf16 v[180:183], a[220:223], a[76:79], v[180:183]
ds_read_b64_tr_b16 a[196:197], v1 offset:20480
s_mov_b32 s38, 1353728
v_mfma_f32_16x16x32_bf16 v[184:187], a[208:211], a[80:83], v[184:187]
ds_read_b64_tr_b16 a[198:199], v1 offset:22528
v_mfma_f32_16x16x32_bf16 v[184:187], a[212:215], a[84:87], v[184:187]
ds_read_b64_tr_b16 a[200:201], v1 offset:24576
v_mfma_f32_16x16x32_bf16 v[184:187], a[216:219], a[88:91], v[184:187]
ds_read_b64_tr_b16 a[202:203], v1 offset:26624
v_mfma_f32_16x16x32_bf16 v[184:187], a[220:223], a[92:95], v[184:187]
ds_read_b64_tr_b16 a[204:205], v1 offset:28672
v_mfma_f32_16x16x32_bf16 v[188:191], a[208:211], a[96:99], v[188:191]
ds_read_b64_tr_b16 a[206:207], v1 offset:30720
s_add_u32 s41, s84, 0
v_mfma_f32_16x16x32_bf16 v[188:191], a[212:215], a[100:103], v[188:191]
buffer_load_dwordx4 v7, s[12:15], s38 offen offset:1024  lds
v_mfma_f32_16x16x32_bf16 v[188:191], a[216:219], a[104:107], v[188:191]
s_mov_b32 s39, 1380352
v_mfma_f32_16x16x32_bf16 v[188:191], a[220:223], a[108:111], v[188:191]
buffer_store_dwordx2 v[10:11], v9, s[4:7], s41 offen sc1
s_min_u32 s41, s2, 1
s_lshl_b32 s41, s41, 26
s_or_b32 s41, s41, s62
s_add_u32 s41, s41, 60923904
buffer_store_dwordx2 v[10:11], v9, s[4:7], s41 offen sc1
s_waitcnt lgkmcnt(4)
v_mfma_f32_16x16x32_bf16 v[192:195], a[192:195], v[112:115], v[192:195]
buffer_load_dwordx4 v7, s[12:15], s39 offen offset:2048  lds
v_mfma_f32_16x16x32_bf16 v[192:195], a[196:199], v[116:119], v[192:195]
ds_read_b64_tr_b16 a[208:209], v2 offset:16384
s_waitcnt lgkmcnt(1)
v_mfma_f32_16x16x32_bf16 v[192:195], a[200:203], v[120:123], v[192:195]
ds_read_b64_tr_b16 a[210:211], v2 offset:18432
s_mov_b32 s38, 1406976
v_mfma_f32_16x16x32_bf16 v[192:195], a[204:207], v[124:127], v[192:195]
buffer_load_dwordx4 v7, s[12:15], s38 offen offset:3072  lds
v_mfma_f32_16x16x32_bf16 v[196:199], a[192:195], a[64:67], v[196:199]
ds_read_b64_tr_b16 a[212:213], v2 offset:20480
s_add_u32 m0, s37, 114688
v_mfma_f32_16x16x32_bf16 v[196:199], a[196:199], a[68:71], v[196:199]
ds_read_b64_tr_b16 a[214:215], v2 offset:22528
s_mov_b32 s39, 1327104
v_mfma_f32_16x16x32_bf16 v[196:199], a[200:203], a[72:75], v[196:199]
buffer_load_dwordx4 v7, s[16:19], s39 offen offset:0  lds
v_mfma_f32_16x16x32_bf16 v[196:199], a[204:207], a[76:79], v[196:199]
ds_read_b64_tr_b16 a[216:217], v2 offset:24576
s_mov_b32 s38, 1353728
v_mfma_f32_16x16x32_bf16 v[200:203], a[192:195], a[80:83], v[200:203]
ds_read_b64_tr_b16 a[218:219], v2 offset:26624
v_mfma_f32_16x16x32_bf16 v[200:203], a[196:199], a[84:87], v[200:203]
ds_read_b64_tr_b16 a[220:221], v2 offset:28672
v_mfma_f32_16x16x32_bf16 v[200:203], a[200:203], a[88:91], v[200:203]
buffer_load_dwordx4 v7, s[16:19], s38 offen offset:1024  lds
v_mfma_f32_16x16x32_bf16 v[200:203], a[204:207], a[92:95], v[200:203]
ds_read_b64_tr_b16 a[222:223], v2 offset:30720
s_mov_b32 s39, 1380352
v_mfma_f32_16x16x32_bf16 v[204:207], a[192:195], a[96:99], v[204:207]
v_mfma_f32_16x16x32_bf16 v[204:207], a[196:199], a[100:103], v[204:207]
v_mfma_f32_16x16x32_bf16 v[204:207], a[200:203], a[104:107], v[204:207]
buffer_load_dwordx4 v7, s[16:19], s39 offen offset:2048  lds
v_mfma_f32_16x16x32_bf16 v[204:207], a[204:207], a[108:111], v[204:207]
s_mov_b32 s38, 1406976
s_waitcnt lgkmcnt(0)
v_mfma_f32_16x16x32_bf16 v[208:211], a[208:211], v[112:115], v[208:211]
ds_read_b64_tr_b16 a[192:193], v3 offset:16384
v_mfma_f32_16x16x32_bf16 v[208:211], a[212:215], v[116:119], v[208:211]
v_mfma_f32_16x16x32_bf16 v[208:211], a[216:219], v[120:123], v[208:211]
buffer_load_dwordx4 v7, s[16:19], s38 offen offset:3072  lds
v_mfma_f32_16x16x32_bf16 v[208:211], a[220:223], v[124:127], v[208:211]
ds_read_b64_tr_b16 a[194:195], v3 offset:18432
s_add_u32 m0, s37, 0
v_mfma_f32_16x16x32_bf16 v[212:215], a[208:211], a[64:67], v[212:215]
ds_read_b64_tr_b16 a[196:197], v3 offset:20480
s_mov_b32 s39, 1769472
v_mfma_f32_16x16x32_bf16 v[212:215], a[212:215], a[68:71], v[212:215]
ds_read_b64_tr_b16 a[198:199], v3 offset:22528
v_mfma_f32_16x16x32_bf16 v[212:215], a[216:219], a[72:75], v[212:215]
buffer_load_dwordx4 v7, s[12:15], s39 offen offset:0  lds
v_mfma_f32_16x16x32_bf16 v[212:215], a[220:223], a[76:79], v[212:215]
ds_read_b64_tr_b16 a[200:201], v3 offset:24576
s_mov_b32 s38, 1796096
v_mfma_f32_16x16x32_bf16 v[216:219], a[208:211], a[80:83], v[216:219]
ds_read_b64_tr_b16 a[202:203], v3 offset:26624
v_mfma_f32_16x16x32_bf16 v[216:219], a[212:215], a[84:87], v[216:219]
ds_read_b64_tr_b16 a[204:205], v3 offset:28672
v_mfma_f32_16x16x32_bf16 v[216:219], a[216:219], a[88:91], v[216:219]
buffer_load_dwordx4 v7, s[12:15], s38 offen offset:1024  lds
v_mfma_f32_16x16x32_bf16 v[216:219], a[220:223], a[92:95], v[216:219]
ds_read_b64_tr_b16 a[206:207], v3 offset:30720
s_mov_b32 s39, 1822720
v_mfma_f32_16x16x32_bf16 v[220:223], a[208:211], a[96:99], v[220:223]
v_mfma_f32_16x16x32_bf16 v[220:223], a[212:215], a[100:103], v[220:223]
v_mfma_f32_16x16x32_bf16 v[220:223], a[216:219], a[104:107], v[220:223]
buffer_load_dwordx4 v7, s[12:15], s39 offen offset:2048  lds
v_mfma_f32_16x16x32_bf16 v[220:223], a[220:223], a[108:111], v[220:223]
s_mov_b32 s38, 1849344
s_waitcnt lgkmcnt(0)
v_mfma_f32_16x16x32_bf16 v[224:227], a[192:195], v[112:115], v[224:227]
ds_read_b64_tr_b16 a[208:209], v4 offset:16384
v_mfma_f32_16x16x32_bf16 v[224:227], a[196:199], v[116:119], v[224:227]
v_mfma_f32_16x16x32_bf16 v[224:227], a[200:203], v[120:123], v[224:227]
buffer_load_dwordx4 v7, s[12:15], s38 offen offset:3072  lds
v_mfma_f32_16x16x32_bf16 v[224:227], a[204:207], v[124:127], v[224:227]
ds_read_b64_tr_b16 a[210:211], v4 offset:18432
s_add_u32 m0, s37, 16384
v_mfma_f32_16x16x32_bf16 v[228:231], a[192:195], a[64:67], v[228:231]
ds_read_b64_tr_b16 a[212:213], v4 offset:20480
s_mov_b32 s39, 1769472
v_mfma_f32_16x16x32_bf16 v[228:231], a[196:199], a[68:71], v[228:231]
ds_read_b64_tr_b16 a[214:215], v4 offset:22528
v_mfma_f32_16x16x32_bf16 v[228:231], a[200:203], a[72:75], v[228:231]
buffer_load_dwordx4 v7, s[16:19], s39 offen offset:0  lds
v_mfma_f32_16x16x32_bf16 v[228:231], a[204:207], a[76:79], v[228:231]
ds_read_b64_tr_b16 a[216:217], v4 offset:24576
s_mov_b32 s38, 1796096
v_mfma_f32_16x16x32_bf16 v[232:235], a[192:195], a[80:83], v[232:235]
ds_read_b64_tr_b16 a[218:219], v4 offset:26624
v_mfma_f32_16x16x32_bf16 v[232:235], a[196:199], a[84:87], v[232:235]
ds_read_b64_tr_b16 a[220:221], v4 offset:28672
v_mfma_f32_16x16x32_bf16 v[232:235], a[200:203], a[88:91], v[232:235]
buffer_load_dwordx4 v7, s[16:19], s38 offen offset:1024  lds
v_mfma_f32_16x16x32_bf16 v[232:235], a[204:207], a[92:95], v[232:235]
ds_read_b64_tr_b16 a[222:223], v4 offset:30720
s_mov_b32 s39, 1822720
v_mfma_f32_16x16x32_bf16 v[236:239], a[192:195], a[96:99], v[236:239]
v_mfma_f32_16x16x32_bf16 v[236:239], a[196:199], a[100:103], v[236:239]
v_mfma_f32_16x16x32_bf16 v[236:239], a[200:203], a[104:107], v[236:239]
buffer_load_dwordx4 v7, s[16:19], s39 offen offset:2048  lds
v_mfma_f32_16x16x32_bf16 v[236:239], a[204:207], a[108:111], v[236:239]
s_mov_b32 s38, 1849344
s_waitcnt lgkmcnt(0)
v_mfma_f32_16x16x32_bf16 v[240:243], a[208:211], v[112:115], v[240:243]
v_mfma_f32_16x16x32_bf16 v[240:243], a[212:215], v[116:119], v[240:243]
v_mfma_f32_16x16x32_bf16 v[240:243], a[216:219], v[120:123], v[240:243]
buffer_load_dwordx4 v7, s[16:19], s38 offen offset:3072  lds
v_mfma_f32_16x16x32_bf16 v[240:243], a[220:223], v[124:127], v[240:243]
s_waitcnt vmcnt(12)
s_barrier
s_add_u32 s40, s42, 65536
v_mfma_f32_16x16x32_bf16 v[244:247], a[208:211], a[64:67], v[244:247]
ds_read_b64_tr_b16 a[192:193], v1 offset:32768
v_mfma_f32_16x16x32_bf16 v[244:247], a[212:215], a[68:71], v[244:247]
ds_read_b64_tr_b16 a[194:195], v1 offset:34816
v_mfma_f32_16x16x32_bf16 v[244:247], a[216:219], a[72:75], v[244:247]
buffer_load_dwordx4 a[0:3], v5, s[4:7], s40 offen offset:0 sc1
v_mfma_f32_16x16x32_bf16 v[244:247], a[220:223], a[76:79], v[244:247]
ds_read_b64_tr_b16 a[196:197], v1 offset:36864
v_mfma_f32_16x16x32_bf16 v[248:251], a[208:211], a[80:83], v[248:251]
ds_read_b64_tr_b16 a[198:199], v1 offset:38912
v_mfma_f32_16x16x32_bf16 v[248:251], a[212:215], a[84:87], v[248:251]
ds_read_b64_tr_b16 a[200:201], v1 offset:40960
v_mfma_f32_16x16x32_bf16 v[248:251], a[216:219], a[88:91], v[248:251]
ds_read_b64_tr_b16 a[202:203], v1 offset:43008
v_mfma_f32_16x16x32_bf16 v[248:251], a[220:223], a[92:95], v[248:251]
ds_read_b64_tr_b16 a[204:205], v1 offset:45056
v_mfma_f32_16x16x32_bf16 v[252:255], a[208:211], a[96:99], v[252:255]
ds_read_b64_tr_b16 a[206:207], v1 offset:47104
v_mfma_f32_16x16x32_bf16 v[252:255], a[212:215], a[100:103], v[252:255]
buffer_load_dwordx4 a[4:7], v5, s[4:7], s40 offen offset:1024 sc1
v_mfma_f32_16x16x32_bf16 v[252:255], a[216:219], a[104:107], v[252:255]
v_mfma_f32_16x16x32_bf16 v[252:255], a[220:223], a[108:111], v[252:255]
s_waitcnt lgkmcnt(4)
v_mfma_f32_16x16x32_bf16 v[128:131], a[192:195], a[128:131], v[128:131]
buffer_load_dwordx4 a[8:11], v5, s[4:7], s40 offen offset:2048 sc1
v_mfma_f32_16x16x32_bf16 v[128:131], a[196:199], a[132:135], v[128:131]
ds_read_b64_tr_b16 a[208:209], v2 offset:32768
s_waitcnt lgkmcnt(1)
v_mfma_f32_16x16x32_bf16 v[128:131], a[200:203], a[136:139], v[128:131]
ds_read_b64_tr_b16 a[210:211], v2 offset:34816
v_mfma_f32_16x16x32_bf16 v[128:131], a[204:207], a[140:143], v[128:131]
buffer_load_dwordx4 a[12:15], v5, s[4:7], s40 offen offset:3072 sc1
v_mfma_f32_16x16x32_bf16 v[132:135], a[192:195], a[144:147], v[132:135]
ds_read_b64_tr_b16 a[212:213], v2 offset:36864
s_add_u32 s40, s42, 69632
v_mfma_f32_16x16x32_bf16 v[132:135], a[196:199], a[148:151], v[132:135]
ds_read_b64_tr_b16 a[214:215], v2 offset:38912
v_mfma_f32_16x16x32_bf16 v[132:135], a[200:203], a[152:155], v[132:135]
ds_read_b64_tr_b16 a[216:217], v2 offset:40960
v_mfma_f32_16x16x32_bf16 v[132:135], a[204:207], a[156:159], v[132:135]
buffer_load_dwordx4 a[16:19], v5, s[4:7], s40 offen offset:0 sc1
v_mfma_f32_16x16x32_bf16 v[136:139], a[192:195], a[160:163], v[136:139]
ds_read_b64_tr_b16 a[218:219], v2 offset:43008
v_mfma_f32_16x16x32_bf16 v[136:139], a[196:199], a[164:167], v[136:139]
ds_read_b64_tr_b16 a[220:221], v2 offset:45056
v_mfma_f32_16x16x32_bf16 v[136:139], a[200:203], a[168:171], v[136:139]
v_mfma_f32_16x16x32_bf16 v[136:139], a[204:207], a[172:175], v[136:139]
buffer_load_dwordx4 a[20:23], v5, s[4:7], s40 offen offset:1024 sc1
v_mfma_f32_16x16x32_bf16 v[140:143], a[192:195], a[176:179], v[140:143]
ds_read_b64_tr_b16 a[222:223], v2 offset:47104
v_mfma_f32_16x16x32_bf16 v[140:143], a[196:199], a[180:183], v[140:143]
v_mfma_f32_16x16x32_bf16 v[140:143], a[200:203], a[184:187], v[140:143]
v_mfma_f32_16x16x32_bf16 v[140:143], a[204:207], a[188:191], v[140:143]
s_waitcnt lgkmcnt(0)
v_mfma_f32_16x16x32_bf16 v[144:147], a[208:211], a[128:131], v[144:147]
buffer_load_dwordx4 a[24:27], v5, s[4:7], s40 offen offset:2048 sc1
v_mfma_f32_16x16x32_bf16 v[144:147], a[212:215], a[132:135], v[144:147]
ds_read_b64_tr_b16 a[192:193], v3 offset:32768
v_mfma_f32_16x16x32_bf16 v[144:147], a[216:219], a[136:139], v[144:147]
ds_read_b64_tr_b16 a[194:195], v3 offset:34816
v_mfma_f32_16x16x32_bf16 v[144:147], a[220:223], a[140:143], v[144:147]
buffer_load_dwordx4 a[28:31], v5, s[4:7], s40 offen offset:3072 sc1
v_mfma_f32_16x16x32_bf16 v[148:151], a[208:211], a[144:147], v[148:151]
ds_read_b64_tr_b16 a[196:197], v3 offset:36864
s_add_u32 s40, s42, 73728
v_mfma_f32_16x16x32_bf16 v[148:151], a[212:215], a[148:151], v[148:151]
ds_read_b64_tr_b16 a[198:199], v3 offset:38912
v_mfma_f32_16x16x32_bf16 v[148:151], a[216:219], a[152:155], v[148:151]
ds_read_b64_tr_b16 a[200:201], v3 offset:40960
v_mfma_f32_16x16x32_bf16 v[148:151], a[220:223], a[156:159], v[148:151]
buffer_load_dwordx4 a[32:35], v5, s[4:7], s40 offen offset:0 sc1
v_mfma_f32_16x16x32_bf16 v[152:155], a[208:211], a[160:163], v[152:155]
ds_read_b64_tr_b16 a[202:203], v3 offset:43008
v_mfma_f32_16x16x32_bf16 v[152:155], a[212:215], a[164:167], v[152:155]
ds_read_b64_tr_b16 a[204:205], v3 offset:45056
v_mfma_f32_16x16x32_bf16 v[152:155], a[216:219], a[168:171], v[152:155]
v_mfma_f32_16x16x32_bf16 v[152:155], a[220:223], a[172:175], v[152:155]
buffer_load_dwordx4 a[36:39], v5, s[4:7], s40 offen offset:1024 sc1
v_mfma_f32_16x16x32_bf16 v[156:159], a[208:211], a[176:179], v[156:159]
ds_read_b64_tr_b16 a[206:207], v3 offset:47104
v_mfma_f32_16x16x32_bf16 v[156:159], a[212:215], a[180:183], v[156:159]
v_mfma_f32_16x16x32_bf16 v[156:159], a[216:219], a[184:187], v[156:159]
v_mfma_f32_16x16x32_bf16 v[156:159], a[220:223], a[188:191], v[156:159]
s_waitcnt lgkmcnt(0)
v_mfma_f32_16x16x32_bf16 v[160:163], a[192:195], a[128:131], v[160:163]
buffer_load_dwordx4 a[40:43], v5, s[4:7], s40 offen offset:2048 sc1
v_mfma_f32_16x16x32_bf16 v[160:163], a[196:199], a[132:135], v[160:163]
ds_read_b64_tr_b16 a[208:209], v4 offset:32768
v_mfma_f32_16x16x32_bf16 v[160:163], a[200:203], a[136:139], v[160:163]
ds_read_b64_tr_b16 a[210:211], v4 offset:34816
v_mfma_f32_16x16x32_bf16 v[160:163], a[204:207], a[140:143], v[160:163]
buffer_load_dwordx4 a[44:47], v5, s[4:7], s40 offen offset:3072 sc1
v_mfma_f32_16x16x32_bf16 v[164:167], a[192:195], a[144:147], v[164:167]
ds_read_b64_tr_b16 a[212:213], v4 offset:36864
s_add_u32 s40, s42, 77824
v_mfma_f32_16x16x32_bf16 v[164:167], a[196:199], a[148:151], v[164:167]
ds_read_b64_tr_b16 a[214:215], v4 offset:38912
v_mfma_f32_16x16x32_bf16 v[164:167], a[200:203], a[152:155], v[164:167]
ds_read_b64_tr_b16 a[216:217], v4 offset:40960
v_mfma_f32_16x16x32_bf16 v[164:167], a[204:207], a[156:159], v[164:167]
buffer_load_dwordx4 a[48:51], v5, s[4:7], s40 offen offset:0 sc1
v_mfma_f32_16x16x32_bf16 v[168:171], a[192:195], a[160:163], v[168:171]
ds_read_b64_tr_b16 a[218:219], v4 offset:43008
v_mfma_f32_16x16x32_bf16 v[168:171], a[196:199], a[164:167], v[168:171]
ds_read_b64_tr_b16 a[220:221], v4 offset:45056
v_mfma_f32_16x16x32_bf16 v[168:171], a[200:203], a[168:171], v[168:171]
v_mfma_f32_16x16x32_bf16 v[168:171], a[204:207], a[172:175], v[168:171]
buffer_load_dwordx4 a[52:55], v5, s[4:7], s40 offen offset:1024 sc1
v_mfma_f32_16x16x32_bf16 v[172:175], a[192:195], a[176:179], v[172:175]
ds_read_b64_tr_b16 a[222:223], v4 offset:47104
v_mfma_f32_16x16x32_bf16 v[172:175], a[196:199], a[180:183], v[172:175]
v_mfma_f32_16x16x32_bf16 v[172:175], a[200:203], a[184:187], v[172:175]
v_mfma_f32_16x16x32_bf16 v[172:175], a[204:207], a[188:191], v[172:175]
s_waitcnt lgkmcnt(0)
v_mfma_f32_16x16x32_bf16 v[176:179], a[208:211], a[128:131], v[176:179]
buffer_load_dwordx4 a[56:59], v5, s[4:7], s40 offen offset:2048 sc1
v_mfma_f32_16x16x32_bf16 v[176:179], a[212:215], a[132:135], v[176:179]
v_mfma_f32_16x16x32_bf16 v[176:179], a[216:219], a[136:139], v[176:179]
s_waitcnt vmcnt(23)
s_barrier
v_mfma_f32_16x16x32_bf16 v[176:179], a[220:223], a[140:143], v[176:179]
buffer_load_dwordx4 a[60:63], v5, s[4:7], s40 offen offset:3072 sc1
v_mfma_f32_16x16x32_bf16 v[180:183], a[208:211], a[144:147], v[180:183]
ds_read_b64_tr_b16 a[192:193], v1 offset:49152
s_add_u32 m0, s54, 143360
v_mfma_f32_16x16x32_bf16 v[180:183], a[212:215], a[148:151], v[180:183]
ds_read_b64_tr_b16 a[194:195], v1 offset:51200
s_add_u32 s39, s67, 0
v_mfma_f32_16x16x32_bf16 v[180:183], a[216:219], a[152:155], v[180:183]
ds_read_b64_tr_b16 a[196:197], v1 offset:53248
v_mfma_f32_16x16x32_bf16 v[180:183], a[220:223], a[156:159], v[180:183]
buffer_load_dwordx4 v5, s[4:7], s39 offen offset:0  sc1 lds
v_mfma_f32_16x16x32_bf16 v[184:187], a[208:211], a[160:163], v[184:187]
ds_read_b64_tr_b16 a[198:199], v1 offset:55296
v_mfma_f32_16x16x32_bf16 v[184:187], a[212:215], a[164:167], v[184:187]
ds_read_b64_tr_b16 a[200:201], v1 offset:57344
v_mfma_f32_16x16x32_bf16 v[184:187], a[216:219], a[168:171], v[184:187]
ds_read_b64_tr_b16 a[202:203], v1 offset:59392
v_mfma_f32_16x16x32_bf16 v[184:187], a[220:223], a[172:175], v[184:187]
ds_read_b64_tr_b16 a[204:205], v1 offset:61440
v_mfma_f32_16x16x32_bf16 v[188:191], a[208:211], a[176:179], v[188:191]
ds_read_b64_tr_b16 a[206:207], v1 offset:63488
v_mfma_f32_16x16x32_bf16 v[188:191], a[212:215], a[180:183], v[188:191]
buffer_load_dwordx4 v5, s[4:7], s39 offen offset:1024  sc1 lds
v_mfma_f32_16x16x32_bf16 v[188:191], a[216:219], a[184:187], v[188:191]
v_mfma_f32_16x16x32_bf16 v[188:191], a[220:223], a[188:191], v[188:191]
s_waitcnt lgkmcnt(4)
v_mfma_f32_16x16x32_bf16 v[192:195], a[192:195], a[128:131], v[192:195]
buffer_load_dwordx4 v5, s[4:7], s39 offen offset:2048  sc1 lds
v_mfma_f32_16x16x32_bf16 v[192:195], a[196:199], a[132:135], v[192:195]
ds_read_b64_tr_b16 a[208:209], v2 offset:49152
s_waitcnt lgkmcnt(1)
v_mfma_f32_16x16x32_bf16 v[192:195], a[200:203], a[136:139], v[192:195]
ds_read_b64_tr_b16 a[210:211], v2 offset:51200
v_mfma_f32_16x16x32_bf16 v[192:195], a[204:207], a[140:143], v[192:195]
buffer_load_dwordx4 v5, s[4:7], s39 offen offset:3072  sc1 lds
v_mfma_f32_16x16x32_bf16 v[196:199], a[192:195], a[144:147], v[196:199]
ds_read_b64_tr_b16 a[212:213], v2 offset:53248
s_add_u32 m0, s54, 147456
v_mfma_f32_16x16x32_bf16 v[196:199], a[196:199], a[148:151], v[196:199]
ds_read_b64_tr_b16 a[214:215], v2 offset:55296
v_mfma_f32_16x16x32_bf16 v[196:199], a[200:203], a[152:155], v[196:199]
ds_read_b64_tr_b16 a[216:217], v2 offset:57344
v_mfma_f32_16x16x32_bf16 v[196:199], a[204:207], a[156:159], v[196:199]
buffer_load_dwordx4 v16, s[4:7], s39 offen  sc1 lds
v_mfma_f32_16x16x32_bf16 v[200:203], a[192:195], a[160:163], v[200:203]
ds_read_b64_tr_b16 a[218:219], v2 offset:59392
s_add_u32 m0, s54, 40960
v_mfma_f32_16x16x32_bf16 v[200:203], a[196:199], a[164:167], v[200:203]
ds_read_b64_tr_b16 a[220:221], v2 offset:61440
s_add_u32 s38, s67, 81920
v_mfma_f32_16x16x32_bf16 v[200:203], a[200:203], a[168:171], v[200:203]
v_mfma_f32_16x16x32_bf16 v[200:203], a[204:207], a[172:175], v[200:203]
buffer_load_dwordx4 v5, s[4:7], s38 offen offset:0  sc1 lds
v_mfma_f32_16x16x32_bf16 v[204:207], a[192:195], a[176:179], v[204:207]
ds_read_b64_tr_b16 a[222:223], v2 offset:63488
v_mfma_f32_16x16x32_bf16 v[204:207], a[196:199], a[180:183], v[204:207]
v_mfma_f32_16x16x32_bf16 v[204:207], a[200:203], a[184:187], v[204:207]
v_mfma_f32_16x16x32_bf16 v[204:207], a[204:207], a[188:191], v[204:207]
s_waitcnt lgkmcnt(0)
v_mfma_f32_16x16x32_bf16 v[208:211], a[208:211], a[128:131], v[208:211]
buffer_load_dwordx4 v5, s[4:7], s38 offen offset:1024  sc1 lds
v_mfma_f32_16x16x32_bf16 v[208:211], a[212:215], a[132:135], v[208:211]
ds_read_b64_tr_b16 a[192:193], v3 offset:49152
v_mfma_f32_16x16x32_bf16 v[208:211], a[216:219], a[136:139], v[208:211]
ds_read_b64_tr_b16 a[194:195], v3 offset:51200
v_mfma_f32_16x16x32_bf16 v[208:211], a[220:223], a[140:143], v[208:211]
buffer_load_dwordx4 v5, s[4:7], s38 offen offset:2048  sc1 lds
v_mfma_f32_16x16x32_bf16 v[212:215], a[208:211], a[144:147], v[212:215]
ds_read_b64_tr_b16 a[196:197], v3 offset:53248
v_mfma_f32_16x16x32_bf16 v[212:215], a[212:215], a[148:151], v[212:215]
ds_read_b64_tr_b16 a[198:199], v3 offset:55296
v_mfma_f32_16x16x32_bf16 v[212:215], a[216:219], a[152:155], v[212:215]
ds_read_b64_tr_b16 a[200:201], v3 offset:57344
v_mfma_f32_16x16x32_bf16 v[212:215], a[220:223], a[156:159], v[212:215]
buffer_load_dwordx4 v5, s[4:7], s38 offen offset:3072  sc1 lds
v_mfma_f32_16x16x32_bf16 v[216:219], a[208:211], a[160:163], v[216:219]
ds_read_b64_tr_b16 a[202:203], v3 offset:59392
s_add_u32 m0, s54, 45056
v_mfma_f32_16x16x32_bf16 v[216:219], a[212:215], a[164:167], v[216:219]
ds_read_b64_tr_b16 a[204:205], v3 offset:61440
v_mfma_f32_16x16x32_bf16 v[216:219], a[216:219], a[168:171], v[216:219]
v_mfma_f32_16x16x32_bf16 v[216:219], a[220:223], a[172:175], v[216:219]
buffer_load_dwordx4 v16, s[4:7], s38 offen  sc1 lds
v_mfma_f32_16x16x32_bf16 v[220:223], a[208:211], a[176:179], v[220:223]
ds_read_b64_tr_b16 a[206:207], v3 offset:63488
s_add_u32 m0, s54, 61440
v_mfma_f32_16x16x32_bf16 v[220:223], a[212:215], a[180:183], v[220:223]
s_add_u32 s39, s67, 163840
v_mfma_f32_16x16x32_bf16 v[220:223], a[216:219], a[184:187], v[220:223]
v_mfma_f32_16x16x32_bf16 v[220:223], a[220:223], a[188:191], v[220:223]
s_waitcnt lgkmcnt(0)
v_mfma_f32_16x16x32_bf16 v[224:227], a[192:195], a[128:131], v[224:227]
buffer_load_dwordx4 v5, s[4:7], s39 offen offset:0  sc1 lds
v_mfma_f32_16x16x32_bf16 v[224:227], a[196:199], a[132:135], v[224:227]
ds_read_b64_tr_b16 a[208:209], v4 offset:49152
v_mfma_f32_16x16x32_bf16 v[224:227], a[200:203], a[136:139], v[224:227]
ds_read_b64_tr_b16 a[210:211], v4 offset:51200
v_mfma_f32_16x16x32_bf16 v[224:227], a[204:207], a[140:143], v[224:227]
buffer_load_dwordx4 v5, s[4:7], s39 offen offset:1024  sc1 lds
v_mfma_f32_16x16x32_bf16 v[228:231], a[192:195], a[144:147], v[228:231]
ds_read_b64_tr_b16 a[212:213], v4 offset:53248
v_mfma_f32_16x16x32_bf16 v[228:231], a[196:199], a[148:151], v[228:231]
ds_read_b64_tr_b16 a[214:215], v4 offset:55296
v_mfma_f32_16x16x32_bf16 v[228:231], a[200:203], a[152:155], v[228:231]
ds_read_b64_tr_b16 a[216:217], v4 offset:57344
v_mfma_f32_16x16x32_bf16 v[228:231], a[204:207], a[156:159], v[228:231]
buffer_load_dwordx4 v5, s[4:7], s39 offen offset:2048  sc1 lds
v_mfma_f32_16x16x32_bf16 v[232:235], a[192:195], a[160:163], v[232:235]
ds_read_b64_tr_b16 a[218:219], v4 offset:59392
v_mfma_f32_16x16x32_bf16 v[232:235], a[196:199], a[164:167], v[232:235]
ds_read_b64_tr_b16 a[220:221], v4 offset:61440
v_mfma_f32_16x16x32_bf16 v[232:235], a[200:203], a[168:171], v[232:235]
v_mfma_f32_16x16x32_bf16 v[232:235], a[204:207], a[172:175], v[232:235]
buffer_load_dwordx4 v5, s[4:7], s39 offen offset:3072  sc1 lds
v_mfma_f32_16x16x32_bf16 v[236:239], a[192:195], a[176:179], v[236:239]
ds_read_b64_tr_b16 a[222:223], v4 offset:63488
s_add_u32 m0, s54, 65536
v_mfma_f32_16x16x32_bf16 v[236:239], a[196:199], a[180:183], v[236:239]
v_mfma_f32_16x16x32_bf16 v[236:239], a[200:203], a[184:187], v[236:239]
v_mfma_f32_16x16x32_bf16 v[236:239], a[204:207], a[188:191], v[236:239]
buffer_load_dwordx2 v[24:25], v22, s[4:7], s85 offen sc1
s_waitcnt lgkmcnt(0)
v_mfma_f32_16x16x32_bf16 v[240:243], a[208:211], a[128:131], v[240:243]
buffer_load_dwordx4 v16, s[4:7], s39 offen  sc1 lds
v_mfma_f32_16x16x32_bf16 v[240:243], a[212:215], a[132:135], v[240:243]
s_add_u32 m0, s54, 81920
v_xor_b32 v1, 0x10000, v1
v_xor_b32 v2, 0x10000, v2
v_mfma_f32_16x16x32_bf16 v[240:243], a[216:219], a[136:139], v[240:243]
s_add_u32 s38, s67, 245760
v_xor_b32 v3, 0x10000, v3
v_xor_b32 v4, 0x10000, v4
v_mfma_f32_16x16x32_bf16 v[240:243], a[220:223], a[140:143], v[240:243]
buffer_load_dwordx4 v5, s[4:7], s38 offen offset:0  sc1 lds
v_mfma_f32_16x16x32_bf16 v[244:247], a[208:211], a[144:147], v[244:247]
s_waitcnt vmcnt(37)
s_barrier
v_mfma_f32_16x16x32_bf16 v[244:247], a[212:215], a[148:151], v[244:247]
ds_read_b64_tr_b16 a[192:193], v1 offset:0
v_mfma_f32_16x16x32_bf16 v[244:247], a[216:219], a[152:155], v[244:247]
ds_read_b64_tr_b16 a[194:195], v1 offset:2048
v_mfma_f32_16x16x32_bf16 v[244:247], a[220:223], a[156:159], v[244:247]
ds_read_b64_tr_b16 a[196:197], v1 offset:4096
v_mfma_f32_16x16x32_bf16 v[248:251], a[208:211], a[160:163], v[248:251]
ds_read_b64_tr_b16 a[198:199], v1 offset:6144
v_mfma_f32_16x16x32_bf16 v[248:251], a[212:215], a[164:167], v[248:251]
ds_read_b64_tr_b16 a[200:201], v1 offset:8192
v_mfma_f32_16x16x32_bf16 v[248:251], a[216:219], a[168:171], v[248:251]
ds_read_b64_tr_b16 a[202:203], v1 offset:10240
v_mfma_f32_16x16x32_bf16 v[248:251], a[220:223], a[172:175], v[248:251]
ds_read_b64_tr_b16 a[204:205], v1 offset:12288
v_mfma_f32_16x16x32_bf16 v[252:255], a[208:211], a[176:179], v[252:255]
ds_read_b64_tr_b16 a[206:207], v1 offset:14336
v_mfma_f32_16x16x32_bf16 v[252:255], a[212:215], a[180:183], v[252:255]
buffer_load_dwordx4 v5, s[4:7], s38 offen offset:1024  sc1 lds
v_mfma_f32_16x16x32_bf16 v[252:255], a[216:219], a[184:187], v[252:255]
v_mfma_f32_16x16x32_bf16 v[252:255], a[220:223], a[188:191], v[252:255]
s_waitcnt vmcnt(3)
v_cmp_ne_u64 vcc, s[68:69], v[24:25]
s_nop 3
s_cbranch_vccnz Lp_oF
Lr_oF:
s_waitcnt lgkmcnt(4)
v_mfma_f32_16x16x32_bf16 v[128:131], a[192:195], a[0:3], v[128:131]
ds_read_b64_tr_b16 a[208:209], v2 offset:0
s_add_u32 s40, s66, 0
v_mfma_f32_16x16x32_bf16 v[128:131], a[196:199], a[4:7], v[128:131]
s_waitcnt lgkmcnt(1)
v_mfma_f32_16x16x32_bf16 v[128:131], a[200:203], a[8:11], v[128:131]
buffer_load_dwordx4 a[128:131], v5, s[4:7], s40 offen offset:0  sc1
v_mfma_f32_16x16x32_bf16 v[128:131], a[204:207], a[12:15], v[128:131]
ds_read_b64_tr_b16 a[210:211], v2 offset:2048
v_mfma_f32_16x16x32_bf16 v[132:135], a[192:195], a[16:19], v[132:135]
ds_read_b64_tr_b16 a[212:213], v2 offset:4096
v_mfma_f32_16x16x32_bf16 v[132:135], a[196:199], a[20:23], v[132:135]
buffer_load_dwordx4 a[132:135], v5, s[4:7], s40 offen offset:1024  sc1
v_mfma_f32_16x16x32_bf16 v[132:135], a[200:203], a[24:27], v[132:135]
ds_read_b64_tr_b16 a[214:215], v2 offset:6144
v_mfma_f32_16x16x32_bf16 v[132:135], a[204:207], a[28:31], v[132:135]
ds_read_b64_tr_b16 a[216:217], v2 offset:8192
v_mfma_f32_16x16x32_bf16 v[136:139], a[192:195], a[32:35], v[136:139]
buffer_load_dwordx4 a[136:139], v5, s[4:7], s40 offen offset:2048  sc1
v_mfma_f32_16x16x32_bf16 v[136:139], a[196:199], a[36:39], v[136:139]
ds_read_b64_tr_b16 a[218:219], v2 offset:10240
v_mfma_f32_16x16x32_bf16 v[136:139], a[200:203], a[40:43], v[136:139]
ds_read_b64_tr_b16 a[220:221], v2 offset:12288
v_mfma_f32_16x16x32_bf16 v[136:139], a[204:207], a[44:47], v[136:139]
ds_read_b64_tr_b16 a[222:223], v2 offset:14336
v_mfma_f32_16x16x32_bf16 v[140:143], a[192:195], a[48:51], v[140:143]
buffer_load_dwordx4 a[140:143], v5, s[4:7], s40 offen offset:3072  sc1
v_mfma_f32_16x16x32_bf16 v[140:143], a[196:199], a[52:55], v[140:143]
s_add_u32 s40, s66, 4096
v_mfma_f32_16x16x32_bf16 v[140:143], a[200:203], a[56:59], v[140:143]
v_mfma_f32_16x16x32_bf16 v[140:143], a[204:207], a[60:63], v[140:143]
s_waitcnt lgkmcnt(0)
v_mfma_f32_16x16x32_bf16 v[144:147], a[208:211], a[0:3], v[144:147]
buffer_load_dwordx4 a[144:147], v5, s[4:7], s40 offen offset:0  sc1
v_mfma_f32_16x16x32_bf16 v[144:147], a[212:215], a[4:7], v[144:147]
ds_read_b64_tr_b16 a[192:193], v3 offset:0
v_mfma_f32_16x16x32_bf16 v[144:147], a[216:219], a[8:11], v[144:147]
ds_read_b64_tr_b16 a[194:195], v3 offset:2048
v_mfma_f32_16x16x32_bf16 v[144:147], a[220:223], a[12:15], v[144:147]
ds_read_b64_tr_b16 a[196:197], v3 offset:4096
v_mfma_f32_16x16x32_bf16 v[148:151], a[208:211], a[16:19], v[148:151]
buffer_load_dwordx4 a[148:151], v5, s[4:7], s40 offen offset:1024  sc1
v_mfma_f32_16x16x32_bf16 v[148:151], a[212:215], a[20:23], v[148:151]
ds_read_b64_tr_b16 a[198:199], v3 offset:6144
v_mfma_f32_16x16x32_bf16 v[148:151], a[216:219], a[24:27], v[148:151]
ds_read_b64_tr_b16 a[200:201], v3 offset:8192
v_mfma_f32_16x16x32_bf16 v[148:151], a[220:223], a[28:31], v[148:151]
v_mfma_f32_16x16x32_bf16 v[152:155], a[208:211], a[32:35], v[152:155]
buffer_load_dwordx4 a[152:155], v5, s[4:7], s40 offen offset:2048  sc1
v_mfma_f32_16x16x32_bf16 v[152:155], a[212:215], a[36:39], v[152:155]
ds_read_b64_tr_b16 a[202:203], v3 offset:10240
v_mfma_f32_16x16x32_bf16 v[152:155], a[216:219], a[40:43], v[152:155]
ds_read_b64_tr_b16 a[204:205], v3 offset:12288
v_mfma_f32_16x16x32_bf16 v[152:155], a[220:223], a[44:47], v[152:155]
ds_read_b64_tr_b16 a[206:207], v3 offset:14336
v_mfma_f32_16x16x32_bf16 v[156:159], a[208:211], a[48:51], v[156:159]
buffer_load_dwordx4 a[156:159], v5, s[4:7], s40 offen offset:3072  sc1
v_mfma_f32_16x16x32_bf16 v[156:159], a[212:215], a[52:55], v[156:159]
s_add_u32 s40, s66, 8192
v_mfma_f32_16x16x32_bf16 v[156:159], a[216:219], a[56:59], v[156:159]
v_mfma_f32_16x16x32_bf16 v[156:159], a[220:223], a[60:63], v[156:159]
s_waitcnt lgkmcnt(0)
v_mfma_f32_16x16x32_bf16 v[160:163], a[192:195], a[0:3], v[160:163]
buffer_load_dwordx4 a[160:163], v5, s[4:7], s40 offen offset:0  sc1
v_mfma_f32_16x16x32_bf16 v[160:163], a[196:199], a[4:7], v[160:163]
ds_read_b64_tr_b16 a[208:209], v4 offset:0
v_mfma_f32_16x16x32_bf16 v[160:163], a[200:203], a[8:11], v[160:163]
ds_read_b64_tr_b16 a[210:211], v4 offset:2048
v_mfma_f32_16x16x32_bf16 v[160:163], a[204:207], a[12:15], v[160:163]
ds_read_b64_tr_b16 a[212:213], v4 offset:4096
v_mfma_f32_16x16x32_bf16 v[164:167], a[192:195], a[16:19], v[164:167]
buffer_load_dwordx4 a[164:167], v5, s[4:7], s40 offen offset:1024  sc1
v_mfma_f32_16x16x32_bf16 v[164:167], a[196:199], a[20:23], v[164:167]
ds_read_b64_tr_b16 a[214:215], v4 offset:6144
v_mfma_f32_16x16x32_bf16 v[164:167], a[200:203], a[24:27], v[164:167]
ds_read_b64_tr_b16 a[216:217], v4 offset:8192
v_mfma_f32_16x16x32_bf16 v[164:167], a[204:207], a[28:31], v[164:167]
v_mfma_f32_16x16x32_bf16 v[168:171], a[192:195], a[32:35], v[168:171]
buffer_load_dwordx4 a[168:171], v5, s[4:7], s40 offen offset:2048  sc1
v_mfma_f32_16x16x32_bf16 v[168:171], a[196:199], a[36:39], v[168:171]
ds_read_b64_tr_b16 a[218:219], v4 offset:10240
v_mfma_f32_16x16x32_bf16 v[168:171], a[200:203], a[40:43], v[168:171]
ds_read_b64_tr_b16 a[220:221], v4 offset:12288
v_mfma_f32_16x16x32_bf16 v[168:171], a[204:207], a[44:47], v[168:171]
ds_read_b64_tr_b16 a[222:223], v4 offset:14336
v_mfma_f32_16x16x32_bf16 v[172:175], a[192:195], a[48:51], v[172:175]
buffer_load_dwordx4 a[172:175], v5, s[4:7], s40 offen offset:3072  sc1
v_mfma_f32_16x16x32_bf16 v[172:175], a[196:199], a[52:55], v[172:175]
s_add_u32 s40, s66, 12288
v_mfma_f32_16x16x32_bf16 v[172:175], a[200:203], a[56:59], v[172:175]
v_mfma_f32_16x16x32_bf16 v[172:175], a[204:207], a[60:63], v[172:175]
s_waitcnt lgkmcnt(0)
v_mfma_f32_16x16x32_bf16 v[176:179], a[208:211], a[0:3], v[176:179]
buffer_load_dwordx4 a[176:179], v5, s[4:7], s40 offen offset:0  sc1
v_mfma_f32_16x16x32_bf16 v[176:179], a[212:215], a[4:7], v[176:179]
v_mfma_f32_16x16x32_bf16 v[176:179], a[216:219], a[8:11], v[176:179]
s_barrier
v_mfma_f32_16x16x32_bf16 v[176:179], a[220:223], a[12:15], v[176:179]
ds_read_b64_tr_b16 a[192:193], v1 offset:16384
v_mfma_f32_16x16x32_bf16 v[180:183], a[208:211], a[16:19], v[180:183]
buffer_load_dwordx4 a[180:183], v5, s[4:7], s40 offen offset:1024  sc1
v_mfma_f32_16x16x32_bf16 v[180:183], a[212:215], a[20:23], v[180:183]
ds_read_b64_tr_b16 a[194:195], v1 offset:18432
v_mfma_f32_16x16x32_bf16 v[180:183], a[216:219], a[24:27], v[180:183]
ds_read_b64_tr_b16 a[196:197], v1 offset:20480
v_mfma_f32_16x16x32_bf16 v[180:183], a[220:223], a[28:31], v[180:183]
ds_read_b64_tr_b16 a[198:199], v1 offset:22528
v_mfma_f32_16x16x32_bf16 v[184:187], a[208:211], a[32:35], v[184:187]
buffer_load_dwordx4 a[184:187], v5, s[4:7], s40 offen offset:2048  sc1
v_mfma_f32_16x16x32_bf16 v[184:187], a[212:215], a[36:39], v[184:187]
ds_read_b64_tr_b16 a[200:201], v1 offset:24576
v_mfma_f32_16x16x32_bf16 v[184:187], a[216:219], a[40:43], v[184:187]
ds_read_b64_tr_b16 a[202:203], v1 offset:26624
v_mfma_f32_16x16x32_bf16 v[184:187], a[220:223], a[44:47], v[184:187]
ds_read_b64_tr_b16 a[204:205], v1 offset:28672
v_mfma_f32_16x16x32_bf16 v[188:191], a[208:211], a[48:51], v[188:191]
ds_read_b64_tr_b16 a[206:207], v1 offset:30720
v_mfma_f32_16x16x32_bf16 v[188:191], a[212:215], a[52:55], v[188:191]
buffer_load_dwordx4 a[188:191], v5, s[4:7], s40 offen offset:3072  sc1
v_mfma_f32_16x16x32_bf16 v[188:191], a[216:219], a[56:59], v[188:191]
s_add_u32 s40, s66, 16384
v_mfma_f32_16x16x32_bf16 v[188:191], a[220:223], a[60:63], v[188:191]
s_waitcnt lgkmcnt(4)
v_mfma_f32_16x16x32_bf16 v[192:195], a[192:195], a[0:3], v[192:195]
buffer_load_dwordx4 v[112:115], v5, s[4:7], s40 offen offset:0  sc1
v_mfma_f32_16x16x32_bf16 v[192:195], a[196:199], a[4:7], v[192:195]
ds_read_b64_tr_b16 a[208:209], v2 offset:16384
s_waitcnt lgkmcnt(1)
v_mfma_f32_16x16x32_bf16 v[192:195], a[200:203], a[8:11], v[192:195]
ds_read_b64_tr_b16 a[210:211], v2 offset:18432
v_mfma_f32_16x16x32_bf16 v[192:195], a[204:207], a[12:15], v[192:195]
ds_read_b64_tr_b16 a[212:213], v2 offset:20480
v_mfma_f32_16x16x32_bf16 v[196:199], a[192:195], a[16:19], v[196:199]
buffer_load_dwordx4 v[116:119], v5, s[4:7], s40 offen offset:1024  sc1
v_mfma_f32_16x16x32_bf16 v[196:199], a[196:199], a[20:23], v[196:199]
ds_read_b64_tr_b16 a[214:215], v2 offset:22528
v_mfma_f32_16x16x32_bf16 v[196:199], a[200:203], a[24:27], v[196:199]
ds_read_b64_tr_b16 a[216:217], v2 offset:24576
v_mfma_f32_16x16x32_bf16 v[196:199], a[204:207], a[28:31], v[196:199]
v_mfma_f32_16x16x32_bf16 v[200:203], a[192:195], a[32:35], v[200:203]
buffer_load_dwordx4 v[120:123], v5, s[4:7], s40 offen offset:2048  sc1
v_mfma_f32_16x16x32_bf16 v[200:203], a[196:199], a[36:39], v[200:203]
ds_read_b64_tr_b16 a[218:219], v2 offset:26624
v_mfma_f32_16x16x32_bf16 v[200:203], a[200:203], a[40:43], v[200:203]
ds_read_b64_tr_b16 a[220:221], v2 offset:28672
v_mfma_f32_16x16x32_bf16 v[200:203], a[204:207], a[44:47], v[200:203]
ds_read_b64_tr_b16 a[222:223], v2 offset:30720
v_mfma_f32_16x16x32_bf16 v[204:207], a[192:195], a[48:51], v[204:207]
buffer_load_dwordx4 v[124:127], v5, s[4:7], s40 offen offset:3072  sc1
v_mfma_f32_16x16x32_bf16 v[204:207], a[196:199], a[52:55], v[204:207]
v_mfma_f32_16x16x32_bf16 v[204:207], a[200:203], a[56:59], v[204:207]
v_mfma_f32_16x16x32_bf16 v[204:207], a[204:207], a[60:63], v[204:207]
s_waitcnt lgkmcnt(0)
v_mfma_f32_16x16x32_bf16 v[208:211], a[208:211], a[0:3], v[208:211]
buffer_load_dwordx4 v5, s[4:7], s38 offen offset:2048  sc1 lds
v_mfma_f32_16x16x32_bf16 v[208:211], a[212:215], a[4:7], v[208:211]
ds_read_b64_tr_b16 a[192:193], v3 offset:16384
v_mfma_f32_16x16x32_bf16 v[208:211], a[216:219], a[8:11], v[208:211]
ds_read_b64_tr_b16 a[194:195], v3 offset:18432
v_mfma_f32_16x16x32_bf16 v[208:211], a[220:223], a[12:15], v[208:211]
ds_read_b64_tr_b16 a[196:197], v3 offset:20480
v_mfma_f32_16x16x32_bf16 v[212:215], a[208:211], a[16:19], v[212:215]
buffer_load_dwordx4 v5, s[4:7], s38 offen offset:3072  sc1 lds
v_mfma_f32_16x16x32_bf16 v[212:215], a[212:215], a[20:23], v[212:215]
ds_read_b64_tr_b16 a[198:199], v3 offset:22528
s_add_u32 m0, s54, 86016
v_mfma_f32_16x16x32_bf16 v[212:215], a[216:219], a[24:27], v[212:215]
ds_read_b64_tr_b16 a[200:201], v3 offset:24576
v_mfma_f32_16x16x32_bf16 v[212:215], a[220:223], a[28:31], v[212:215]
v_mfma_f32_16x16x32_bf16 v[216:219], a[208:211], a[32:35], v[216:219]
buffer_load_dwordx4 v16, s[4:7], s38 offen  sc1 lds
v_mfma_f32_16x16x32_bf16 v[216:219], a[212:215], a[36:39], v[216:219]
ds_read_b64_tr_b16 a[202:203], v3 offset:26624
s_add_u32 m0, s54, 102400
v_mfma_f32_16x16x32_bf16 v[216:219], a[216:219], a[40:43], v[216:219]
ds_read_b64_tr_b16 a[204:205], v3 offset:28672
s_add_u32 s39, s67, 327680
v_mfma_f32_16x16x32_bf16 v[216:219], a[220:223], a[44:47], v[216:219]
ds_read_b64_tr_b16 a[206:207], v3 offset:30720
v_mfma_f32_16x16x32_bf16 v[220:223], a[208:211], a[48:51], v[220:223]
buffer_load_dwordx4 v5, s[4:7], s39 offen offset:0  sc1 lds
v_mfma_f32_16x16x32_bf16 v[220:223], a[212:215], a[52:55], v[220:223]
v_mfma_f32_16x16x32_bf16 v[220:223], a[216:219], a[56:59], v[220:223]
v_mfma_f32_16x16x32_bf16 v[220:223], a[220:223], a[60:63], v[220:223]
s_waitcnt lgkmcnt(0)
v_mfma_f32_16x16x32_bf16 v[224:227], a[192:195], a[0:3], v[224:227]
buffer_load_dwordx4 v5, s[4:7], s39 offen offset:1024  sc1 lds
v_mfma_f32_16x16x32_bf16 v[224:227], a[196:199], a[4:7], v[224:227]
ds_read_b64_tr_b16 a[208:209], v4 offset:16384
v_mul_f32 v192, v128, v192
v_mfma_f32_16x16x32_bf16 v[224:227], a[200:203], a[8:11], v[224:227]
ds_read_b64_tr_b16 a[210:211], v4 offset:18432
v_mul_f32 v193, v129, v193
v_mfma_f32_16x16x32_bf16 v[224:227], a[204:207], a[12:15], v[224:227]
ds_read_b64_tr_b16 a[212:213], v4 offset:20480
v_mul_f32 v194, v130, v194
v_mfma_f32_16x16x32_bf16 v[228:231], a[192:195], a[16:19], v[228:231]
buffer_load_dwordx4 v5, s[4:7], s39 offen offset:2048  sc1 lds
v_mfma_f32_16x16x32_bf16 v[228:231], a[196:199], a[20:23], v[228:231]
ds_read_b64_tr_b16 a[214:215], v4 offset:22528
v_mul_f32 v195, v131, v195
v_mfma_f32_16x16x32_bf16 v[228:231], a[200:203], a[24:27], v[228:231]
ds_read_b64_tr_b16 a[216:217], v4 offset:24576
v_mul_f32 v128, s49, v128
v_mfma_f32_16x16x32_bf16 v[228:231], a[204:207], a[28:31], v[228:231]
v_mul_f32 v129, s49, v129
v_mul_f32 v130, s49, v130
v_mfma_f32_16x16x32_bf16 v[232:235], a[192:195], a[32:35], v[232:235]
buffer_load_dwordx4 v5, s[4:7], s39 offen offset:3072  sc1 lds
v_mfma_f32_16x16x32_bf16 v[232:235], a[196:199], a[36:39], v[232:235]
ds_read_b64_tr_b16 a[218:219], v4 offset:26624
s_add_u32 m0, s54, 106496
v_mfma_f32_16x16x32_bf16 v[232:235], a[200:203], a[40:43], v[232:235]
ds_read_b64_tr_b16 a[220:221], v4 offset:28672
v_mul_f32 v131, s49, v131
v_mfma_f32_16x16x32_bf16 v[232:235], a[204:207], a[44:47], v[232:235]
ds_read_b64_tr_b16 a[222:223], v4 offset:30720
v_mfma_f32_16x16x32_bf16 v[236:239], a[192:195], a[48:51], v[236:239]
buffer_load_dwordx4 v16, s[4:7], s39 offen  sc1 lds
v_mfma_f32_16x16x32_bf16 v[236:239], a[196:199], a[52:55], v[236:239]
s_add_u32 m0, s54, 122880
s_add_u32 s38, s67, 409600
v_mfma_f32_16x16x32_bf16 v[236:239], a[200:203], a[56:59], v[236:239]
v_exp_f32 v128, v128
v_mfma_f32_16x16x32_bf16 v[236:239], a[204:207], a[60:63], v[236:239]
s_waitcnt lgkmcnt(0)
v_mul_f32 v208, v144, v208
v_mfma_f32_16x16x32_bf16 v[240:243], a[208:211], a[0:3], v[240:243]
buffer_load_dwordx4 v5, s[4:7], s38 offen offset:0  sc1 lds
v_mfma_f32_16x16x32_bf16 v[240:243], a[212:215], a[4:7], v[240:243]
v_exp_f32 v129, v129
v_mfma_f32_16x16x32_bf16 v[240:243], a[216:219], a[8:11], v[240:243]
s_barrier
v_mul_f32 v209, v145, v209
v_mfma_f32_16x16x32_bf16 v[240:243], a[220:223], a[12:15], v[240:243]
ds_read_b128 a[224:227], v15 offset:20480
v_mfma_f32_16x16x32_bf16 v[244:247], a[208:211], a[16:19], v[244:247]
buffer_load_dwordx4 v5, s[4:7], s38 offen offset:1024  sc1 lds
v_mfma_f32_16x16x32_bf16 v[244:247], a[212:215], a[20:23], v[244:247]
ds_read_b128 a[228:231], v15 offset:21504
v_mfma_f32_16x16x32_bf16 v[244:247], a[216:219], a[24:27], v[244:247]
ds_read_b128 a[232:235], v15 offset:22528
v_mfma_f32_16x16x32_bf16 v[244:247], a[220:223], a[28:31], v[244:247]
ds_read_b128 a[236:239], v15 offset:23552
v_mfma_f32_16x16x32_bf16 v[248:251], a[208:211], a[32:35], v[248:251]
ds_read_b128 a[240:243], v15 offset:24576
v_mfma_f32_16x16x32_bf16 v[248:251], a[212:215], a[36:39], v[248:251]
ds_read_b128 a[244:247], v15 offset:25600
v_mfma_f32_16x16x32_bf16 v[248:251], a[216:219], a[40:43], v[248:251]
ds_read_b128 a[248:251], v15 offset:26624
v_mfma_f32_16x16x32_bf16 v[248:251], a[220:223], a[44:47], v[248:251]
ds_read_b128 a[252:255], v15 offset:27648
v_mfma_f32_16x16x32_bf16 v[252:255], a[208:211], a[48:51], v[252:255]
buffer_load_dwordx4 v5, s[4:7], s38 offen offset:2048  sc1 lds
v_mfma_f32_16x16x32_bf16 v[252:255], a[212:215], a[52:55], v[252:255]
v_exp_f32 v130, v130
v_mfma_f32_16x16x32_bf16 v[252:255], a[216:219], a[56:59], v[252:255]
buffer_load_dwordx4 v5, s[4:7], s38 offen offset:3072  sc1 lds
v_mfma_f32_16x16x32_bf16 v[252:255], a[220:223], a[60:63], v[252:255]
s_add_u32 m0, s54, 126976
v_mul_f32 v210, v146, v210
buffer_load_dwordx4 v16, s[4:7], s38 offen  sc1 lds
L1_spart:
s_waitcnt vmcnt(16) lgkmcnt(4)
v_mfma_f32_32x32x16_bf16 v[32:47], a[224:227], a[128:131], 0
ds_read_b128 a[208:211], v15 offset:28672
ds_read_b128 a[212:215], v15 offset:29696
s_add_u32 m0, s54, 0
s_add_u32 s39, s67, 491520
v_mfma_f32_32x32x16_bf16 v[48:63], a[228:231], a[128:131], 0
buffer_load_dwordx4 v5, s[4:7], s39 offen offset:0  sc1 lds
v_and_b32 v29, 63, v0
v_lshlrev_b32 v1, 3, v29
v_add_u32 v1, 2048, v1
v_and_b32 v29, 3, v0
v_lshlrev_b32 v3, 10, v29
v_mfma_f32_32x32x16_bf16 v[64:79], a[232:235], a[128:131], 0
ds_read_b128 a[216:219], v15 offset:30720
ds_read_b128 a[220:223], v15 offset:31744
v_and_b32 v29, 63, v0
v_min_u32 v29, 39, v29
v_lshlrev_b32 v29, 7, v29
v_exp_f32 v131, v131
v_mfma_f32_32x32x16_bf16 v[80:95], a[236:239], a[128:131], 0
buffer_load_dwordx4 v5, s[4:7], s39 offen offset:1024  sc1 lds
s_waitcnt lgkmcnt(4)
v_mul_f32 v211, v147, v211
v_add_f32 v128, 1.0, v128
v_add_f32 v129, 1.0, v129
v_mul_f32 v144, s49, v144
v_mfma_f32_32x32x16_bf16 v[96:111], a[240:243], a[128:131], 0
ds_read_b128 a[224:227], v15 offset:32768
ds_read_b128 a[228:231], v15 offset:33792
v_add_f32 v130, 1.0, v130
v_add_f32 v131, 1.0, v131
v_mul_f32 v145, s49, v145
v_rcp_f32 v128, v128
v_mfma_f32_32x32x16_bf16 v[32:47], a[244:247], a[132:135], v[32:47]
buffer_load_dwordx4 v5, s[4:7], s39 offen offset:2048  sc1 lds
v_mul_f32 v146, s49, v146
v_rcp_f32 v129, v129
v_mul_f32 v147, s49, v147
v_mfma_f32_32x32x16_bf16 v[48:63], a[248:251], a[132:135], v[48:63]
ds_read_b128 a[232:235], v15 offset:34816
ds_read_b128 a[236:239], v15 offset:35840
v_rcp_f32 v130, v130
v_rcp_f32 v131, v131
v_mfma_f32_32x32x16_bf16 v[64:79], a[252:255], a[132:135], v[64:79]
buffer_load_dwordx4 v5, s[4:7], s39 offen offset:3072  sc1 lds
s_add_u32 m0, s54, 4096
v_exp_f32 v144, v144
v_mul_f32 v192, v192, v128
s_waitcnt lgkmcnt(4)
v_mfma_f32_32x32x16_bf16 v[80:95], a[208:211], a[132:135], v[80:95]
ds_read_b128 a[240:243], v15 offset:36864
ds_read_b128 a[244:247], v15 offset:37888
v_exp_f32 v145, v145
v_mul_f32 v193, v193, v129
v_exp_f32 v146, v146
v_mfma_f32_32x32x16_bf16 v[96:111], a[212:215], a[132:135], v[96:111]
buffer_load_dwordx4 v16, s[4:7], s39 offen  sc1 lds
s_add_u32 m0, s54, 20480
s_add_u32 s38, s67, 573440
v_mul_f32 v194, v194, v130
v_exp_f32 v147, v147
v_mfma_f32_32x32x16_bf16 v[32:47], a[216:219], a[136:139], v[32:47]
ds_read_b128 a[248:251], v15 offset:38912
ds_read_b128 a[252:255], v15 offset:39936
v_mul_f32 v195, v195, v131
v_add_f32 v144, 1.0, v144
v_cvt_pk_bf16_f32 v128, v192, v193
v_add_f32 v145, 1.0, v145
v_cvt_pk_bf16_f32 v129, v194, v195
v_mfma_f32_32x32x16_bf16 v[48:63], a[220:223], a[136:139], v[48:63]
buffer_load_dwordx4 v5, s[4:7], s38 offen offset:0  sc1 lds
v_add_f32 v146, 1.0, v146
v_add_f32 v147, 1.0, v147
v_rcp_f32 v144, v144
s_barrier
s_waitcnt lgkmcnt(4)
v_mfma_f32_32x32x16_bf16 v[64:79], a[224:227], a[136:139], v[64:79]
ds_read_b128 a[208:211], v5 offset:40960
ds_read_b128 a[212:215], v5 offset:41984
v_mfma_f32_32x32x16_bf16 v[80:95], a[228:231], a[136:139], v[80:95]
buffer_load_dwordx4 v5, s[4:7], s38 offen offset:1024  sc1 lds
v_rcp_f32 v145, v145
v_rcp_f32 v146, v146
v_mfma_f32_32x32x16_bf16 v[96:111], a[232:235], a[136:139], v[96:111]
ds_read_b128 a[216:219], v5 offset:43008
ds_read_b128 a[220:223], v5 offset:44032
v_rcp_f32 v147, v147
v_mul_f32 v208, v208, v144
v_mul_f32 v209, v209, v145
v_mul_f32 v210, v210, v146
v_mfma_f32_32x32x16_bf16 v[32:47], a[236:239], a[140:143], v[32:47]
buffer_load_dwordx4 v5, s[4:7], s38 offen offset:2048  sc1 lds
s_waitcnt lgkmcnt(4)
v_mul_f32 v211, v211, v147
v_cvt_pk_bf16_f32 v130, v208, v209
v_cvt_pk_bf16_f32 v131, v210, v211
v_mul_f32 v196, v132, v196
v_mfma_f32_32x32x16_bf16 v[48:63], a[240:243], a[140:143], v[48:63]
ds_read_b128 a[224:227], v5 offset:45056
ds_read_b128 a[228:231], v5 offset:46080
s_add_u32 s41, s43, 0
v_mul_f32 v197, v133, v197
v_mul_f32 v198, v134, v198
v_mul_f32 v199, v135, v199
v_mul_f32 v132, s49, v132
v_mfma_f32_32x32x16_bf16 v[64:79], a[244:247], a[140:143], v[64:79]
buffer_store_dwordx4 v[128:131], v5, s[4:7], s41 offen offset:0 sc1
v_mul_f32 v133, s49, v133
v_mul_f32 v134, s49, v134
v_mul_f32 v135, s49, v135
v_exp_f32 v132, v132
v_mfma_f32_32x32x16_bf16 v[80:95], a[248:251], a[140:143], v[80:95]
ds_read_b128 a[232:235], v5 offset:47104
ds_read_b128 a[236:239], v5 offset:48128
v_mul_f32 v212, v148, v212
v_exp_f32 v133, v133
v_mul_f32 v213, v149, v213
v_mfma_f32_32x32x16_bf16 v[96:111], a[252:255], a[140:143], v[96:111]
buffer_load_dwordx4 v5, s[4:7], s38 offen offset:3072  sc1 lds
s_add_u32 m0, s54, 24576
v_exp_f32 v134, v134
v_mul_f32 v214, v150, v214
s_waitcnt vmcnt(22) lgkmcnt(4)
v_mfma_f32_32x32x16_bf16 v[32:47], a[208:211], a[144:147], v[32:47]
ds_read_b128 a[240:243], v5 offset:49152
ds_read_b128 a[244:247], v5 offset:50176
s_add_u32 s40, s66, 20480
v_exp_f32 v135, v135
v_mul_f32 v215, v151, v215
v_add_f32 v132, 1.0, v132
v_mfma_f32_32x32x16_bf16 v[48:63], a[212:215], a[144:147], v[48:63]
buffer_load_dwordx4 a[128:131], v5, s[4:7], s40 offen offset:0  sc1
v_add_f32 v133, 1.0, v133
v_mul_f32 v148, s49, v148
v_add_f32 v134, 1.0, v134
v_add_f32 v135, 1.0, v135
v_mul_f32 v149, s49, v149
v_mfma_f32_32x32x16_bf16 v[64:79], a[216:219], a[144:147], v[64:79]
ds_read_b128 a[248:251], v5 offset:51200
ds_read_b128 a[252:255], v5 offset:52224
v_rcp_f32 v132, v132
v_mul_f32 v150, s49, v150
v_rcp_f32 v133, v133
v_mfma_f32_32x32x16_bf16 v[80:95], a[220:223], a[144:147], v[80:95]
buffer_load_dwordx4 a[132:135], v5, s[4:7], s40 offen offset:1024  sc1
s_waitcnt lgkmcnt(4)
v_mul_f32 v151, s49, v151
v_rcp_f32 v134, v134
v_mfma_f32_32x32x16_bf16 v[96:111], a[224:227], a[144:147], v[96:111]
ds_read_b128 a[208:211], v5 offset:53248
ds_read_b128 a[212:215], v5 offset:54272
v_rcp_f32 v135, v135
v_exp_f32 v148, v148
v_mul_f32 v196, v196, v132
v_mfma_f32_32x32x16_bf16 v[32:47], a[228:231], a[148:151], v[32:47]
buffer_load_dwordx4 a[136:139], v5, s[4:7], s40 offen offset:2048  sc1
v_exp_f32 v149, v149
v_mul_f32 v197, v197, v133
v_exp_f32 v150, v150
v_mfma_f32_32x32x16_bf16 v[48:63], a[232:235], a[148:151], v[48:63]
ds_read_b128 a[216:219], v5 offset:55296
ds_read_b128 a[220:223], v5 offset:56320
v_mul_f32 v198, v198, v134
v_exp_f32 v151, v151
v_mul_f32 v199, v199, v135
v_add_f32 v148, 1.0, v148
v_mfma_f32_32x32x16_bf16 v[64:79], a[236:239], a[148:151], v[64:79]
buffer_load_dwordx4 a[140:143], v5, s[4:7], s40 offen offset:3072  sc1
s_waitcnt lgkmcnt(4)
v_cvt_pk_bf16_f32 v132, v196, v197
v_add_f32 v149, 1.0, v149
v_cvt_pk_bf16_f32 v133, v198, v199
v_add_f32 v150, 1.0, v150
v_mfma_f32_32x32x16_bf16 v[80:95], a[240:243], a[148:151], v[80:95]
ds_read_b128 a[224:227], v5 offset:57344
ds_read_b128 a[228:231], v5 offset:58368
v_add_f32 v151, 1.0, v151
v_rcp_f32 v148, v148
v_rcp_f32 v149, v149
v_mfma_f32_32x32x16_bf16 v[96:111], a[244:247], a[148:151], v[96:111]
buffer_load_dwordx4 v16, s[4:7], s38 offen  sc1 lds
v_rcp_f32 v150, v150
v_rcp_f32 v151, v151
v_mul_f32 v212, v212, v148
v_mfma_f32_32x32x16_bf16 v[32:47], a[248:251], a[152:155], v[32:47]
ds_read_b128 a[232:235], v5 offset:59392
ds_read_b128 a[236:239], v5 offset:60416
v_mul_f32 v213, v213, v149
v_mul_f32 v214, v214, v150
v_mul_f32 v215, v215, v151
v_cvt_pk_bf16_f32 v134, v212, v213
v_cvt_pk_bf16_f32 v135, v214, v215
v_mfma_f32_32x32x16_bf16 v[48:63], a[252:255], a[152:155], v[48:63]
s_add_u32 s41, s43, 0
v_mul_f32 v200, v136, v200
v_mul_f32 v201, v137, v201
v_mul_f32 v202, v138, v202
v_mul_f32 v203, v139, v203
v_mul_f32 v136, s49, v136
v_mul_f32 v137, s49, v137
s_barrier
s_waitcnt lgkmcnt(4)
v_mfma_f32_32x32x16_bf16 v[64:79], a[208:211], a[152:155], v[64:79]
buffer_store_dwordx4 v[132:135], v5, s[4:7], s41 offen offset:1024 sc1
ds_read_b128 a[240:243], v14 offset:0
s_add_u32 m0, s54, 143360
s_add_u32 s39, s67, 655360
v_mul_f32 v138, s49, v138
v_mul_f32 v139, s49, v139
v_mfma_f32_32x32x16_bf16 v[80:95], a[212:215], a[152:155], v[80:95]
buffer_load_dwordx4 v5, s[4:7], s39 offen offset:0  sc1 lds
ds_read_b128 a[244:247], v14 offset:1024
v_exp_f32 v136, v136
v_mul_f32 v216, v152, v216
v_mfma_f32_32x32x16_bf16 v[96:111], a[216:219], a[152:155], v[96:111]
ds_read_b128 a[248:251], v14 offset:2048
ds_read_b128 a[252:255], v14 offset:3072
v_exp_f32 v137, v137
v_mul_f32 v217, v153, v217
v_exp_f32 v138, v138
v_mfma_f32_32x32x16_bf16 v[32:47], a[220:223], a[156:159], v[32:47]
buffer_load_dwordx4 v5, s[4:7], s39 offen offset:1024  sc1 lds
s_waitcnt lgkmcnt(4)
v_mul_f32 v218, v154, v218
v_exp_f32 v139, v139
v_mul_f32 v219, v155, v219
v_mfma_f32_32x32x16_bf16 v[48:63], a[224:227], a[156:159], v[48:63]
ds_read_b128 a[208:211], v14 offset:4096
ds_read_b128 a[212:215], v14 offset:5120
v_add_f32 v136, 1.0, v136
v_add_f32 v137, 1.0, v137
v_mul_f32 v152, s49, v152
v_add_f32 v138, 1.0, v138
v_add_f32 v139, 1.0, v139
v_mfma_f32_32x32x16_bf16 v[64:79], a[228:231], a[156:159], v[64:79]
buffer_load_dwordx4 v5, s[4:7], s39 offen offset:2048  sc1 lds
v_mul_f32 v153, s49, v153
v_rcp_f32 v136, v136
v_mul_f32 v154, s49, v154
v_mfma_f32_32x32x16_bf16 v[80:95], a[232:235], a[156:159], v[80:95]
ds_read_b128 a[216:219], v14 offset:6144
ds_read_b128 a[220:223], v14 offset:7168
v_rcp_f32 v137, v137
v_mul_f32 v155, s49, v155
v_rcp_f32 v138, v138
v_mfma_f32_32x32x16_bf16 v[96:111], a[236:239], a[156:159], v[96:111]
buffer_load_dwordx4 v5, s[4:7], s39 offen offset:3072  sc1 lds
s_add_u32 m0, s54, 147456
v_rcp_f32 v139, v139
s_waitcnt vmcnt(28) lgkmcnt(4)
v_mfma_f32_32x32x16_bf16 v[32:47], a[240:243], a[160:163], v[32:47]
ds_read_b128 a[224:227], v14 offset:8192
ds_read_b128 a[228:231], v14 offset:9216
s_add_u32 s40, s66, 24576
v_exp_f32 v152, v152
v_mul_f32 v200, v200, v136
v_mfma_f32_32x32x16_bf16 v[48:63], a[244:247], a[160:163], v[48:63]
buffer_load_dwordx4 a[144:147], v5, s[4:7], s40 offen offset:0  sc1
v_exp_f32 v153, v153
v_mul_f32 v201, v201, v137
v_exp_f32 v154, v154
v_mfma_f32_32x32x16_bf16 v[64:79], a[248:251], a[160:163], v[64:79]
ds_read_b128 a[232:235], v14 offset:10240
ds_read_b128 a[236:239], v14 offset:11264
v_mul_f32 v202, v202, v138
v_exp_f32 v155, v155
v_mul_f32 v203, v203, v139
v_add_f32 v152, 1.0, v152
v_mfma_f32_32x32x16_bf16 v[80:95], a[252:255], a[160:163], v[80:95]
buffer_load_dwordx4 a[148:151], v5, s[4:7], s40 offen offset:1024  sc1
s_waitcnt lgkmcnt(4)
v_cvt_pk_bf16_f32 v136, v200, v201
v_add_f32 v153, 1.0, v153
v_cvt_pk_bf16_f32 v137, v202, v203
v_add_f32 v154, 1.0, v154
v_mfma_f32_32x32x16_bf16 v[96:111], a[208:211], a[160:163], v[96:111]
ds_read_b128 a[240:243], v14 offset:12288
ds_read_b128 a[244:247], v14 offset:13312
v_add_f32 v155, 1.0, v155
v_rcp_f32 v152, v152
v_rcp_f32 v153, v153
v_mfma_f32_32x32x16_bf16 v[32:47], a[212:215], a[164:167], v[32:47]
buffer_load_dwordx4 a[152:155], v5, s[4:7], s40 offen offset:2048  sc1
v_rcp_f32 v154, v154
v_rcp_f32 v155, v155
v_mul_f32 v216, v216, v152
v_mfma_f32_32x32x16_bf16 v[48:63], a[216:219], a[164:167], v[48:63]
ds_read_b128 a[248:251], v14 offset:14336
ds_read_b128 a[252:255], v14 offset:15360
v_mul_f32 v217, v217, v153
v_mul_f32 v218, v218, v154
v_mul_f32 v219, v219, v155
v_cvt_pk_bf16_f32 v138, v216, v217
v_cvt_pk_bf16_f32 v139, v218, v219
v_mfma_f32_32x32x16_bf16 v[64:79], a[220:223], a[164:167], v[64:79]
buffer_load_dwordx4 a[156:159], v5, s[4:7], s40 offen offset:3072  sc1
s_add_u32 s41, s43, 110592
v_mul_f32 v204, v140, v204
v_mul_f32 v205, v141, v205
v_mul_f32 v206, v142, v206
s_waitcnt lgkmcnt(4)
v_mfma_f32_32x32x16_bf16 v[80:95], a[224:227], a[164:167], v[80:95]
ds_read_b128 a[208:211], v14 offset:16384
ds_read_b128 a[212:215], v14 offset:17408
v_mul_f32 v207, v143, v207
v_mul_f32 v140, s49, v140
v_mul_f32 v141, s49, v141
v_mul_f32 v142, s49, v142
v_mul_f32 v143, s49, v143
v_mfma_f32_32x32x16_bf16 v[96:111], a[228:231], a[164:167], v[96:111]
buffer_store_dwordx4 v[136:139], v5, s[4:7], s41 offen offset:0 sc1
v_exp_f32 v140, v140
v_mul_f32 v220, v156, v220
v_exp_f32 v141, v141
v_mfma_f32_32x32x16_bf16 v[32:47], a[232:235], a[168:171], v[32:47]
ds_read_b128 a[216:219], v14 offset:18432
ds_read_b128 a[220:223], v14 offset:19456
v_mul_f32 v221, v157, v221
v_exp_f32 v142, v142
v_mul_f32 v222, v158, v222
v_mfma_f32_32x32x16_bf16 v[48:63], a[236:239], a[168:171], v[48:63]
buffer_load_dwordx4 v16, s[4:7], s39 offen  sc1 lds
v_exp_f32 v143, v143
v_mul_f32 v223, v159, v223
v_add_f32 v140, 1.0, v140
s_waitcnt vmcnt(36)
s_barrier
s_waitcnt lgkmcnt(4)
v_mfma_f32_32x32x16_bf16 v[64:79], a[240:243], a[168:171], v[64:79]
ds_read_b128 a[224:227], v14 offset:20480
ds_read_b128 a[228:231], v14 offset:21504
s_add_u32 m0, s54, 40960
s_add_u32 s38, s67, 737280
v_add_f32 v141, 1.0, v141
v_mul_f32 v156, s49, v156
v_add_f32 v142, 1.0, v142
v_mfma_f32_32x32x16_bf16 v[80:95], a[244:247], a[168:171], v[80:95]
buffer_load_dwordx4 v5, s[4:7], s38 offen offset:0  sc1 lds
v_add_f32 v143, 1.0, v143
v_mul_f32 v157, s49, v157
v_rcp_f32 v140, v140
v_mul_f32 v158, s49, v158
v_mfma_f32_32x32x16_bf16 v[96:111], a[248:251], a[168:171], v[96:111]
ds_read_b128 a[232:235], v14 offset:22528
ds_read_b128 a[236:239], v14 offset:23552
v_rcp_f32 v141, v141
v_mul_f32 v159, s49, v159
v_rcp_f32 v142, v142
v_mfma_f32_32x32x16_bf16 v[32:47], a[252:255], a[172:175], v[32:47]
buffer_load_dwordx4 v5, s[4:7], s38 offen offset:1024  sc1 lds
s_waitcnt lgkmcnt(4)
v_rcp_f32 v143, v143
v_exp_f32 v156, v156
v_mfma_f32_32x32x16_bf16 v[48:63], a[208:211], a[172:175], v[48:63]
ds_read_b128 a[240:243], v14 offset:24576
ds_read_b128 a[244:247], v14 offset:25600
v_mul_f32 v204, v204, v140
v_exp_f32 v157, v157
v_mul_f32 v205, v205, v141
v_mfma_f32_32x32x16_bf16 v[64:79], a[212:215], a[172:175], v[64:79]
buffer_load_dwordx4 v5, s[4:7], s38 offen offset:2048  sc1 lds
v_exp_f32 v158, v158
v_mul_f32 v206, v206, v142
v_exp_f32 v159, v159
v_mfma_f32_32x32x16_bf16 v[80:95], a[216:219], a[172:175], v[80:95]
ds_read_b128 a[248:251], v14 offset:26624
ds_read_b128 a[252:255], v14 offset:27648
v_mul_f32 v207, v207, v143
v_add_f32 v156, 1.0, v156
v_cvt_pk_bf16_f32 v140, v204, v205
v_add_f32 v157, 1.0, v157
v_cvt_pk_bf16_f32 v141, v206, v207
v_mfma_f32_32x32x16_bf16 v[96:111], a[220:223], a[172:175], v[96:111]
buffer_load_dwordx4 v5, s[4:7], s38 offen offset:3072  sc1 lds
s_add_u32 m0, s54, 45056
v_add_f32 v158, 1.0, v158
v_add_f32 v159, 1.0, v159
s_waitcnt vmcnt(34) lgkmcnt(4)
v_mfma_f32_32x32x16_bf16 v[32:47], a[224:227], a[176:179], v[32:47]
ds_read_b128 a[208:211], v14 offset:28672
ds_read_b128 a[212:215], v14 offset:29696
s_add_u32 s40, s66, 28672
v_rcp_f32 v156, v156
v_rcp_f32 v157, v157
v_mfma_f32_32x32x16_bf16 v[48:63], a[228:231], a[176:179], v[48:63]
buffer_load_dwordx4 a[160:163], v5, s[4:7], s40 offen offset:0  sc1
v_rcp_f32 v158, v158
v_rcp_f32 v159, v159
v_mul_f32 v220, v220, v156
v_mfma_f32_32x32x16_bf16 v[64:79], a[232:235], a[176:179], v[64:79]
ds_read_b128 a[216:219], v14 offset:30720
ds_read_b128 a[220:223], v14 offset:31744
v_mul_f32 v221, v221, v157
v_mul_f32 v222, v222, v158
v_mul_f32 v223, v223, v159
v_cvt_pk_bf16_f32 v142, v220, v221
v_cvt_pk_bf16_f32 v143, v222, v223
v_mfma_f32_32x32x16_bf16 v[80:95], a[236:239], a[176:179], v[80:95]
buffer_load_dwordx4 a[164:167], v5, s[4:7], s40 offen offset:1024  sc1
s_add_u32 s41, s43, 110592
v_mul_f32 v224, v160, v224
v_mul_f32 v225, v161, v225
v_mul_f32 v226, v162, v226
s_waitcnt lgkmcnt(4)
v_mfma_f32_32x32x16_bf16 v[96:111], a[240:243], a[176:179], v[96:111]
ds_read_b128 a[224:227], v14 offset:32768
ds_read_b128 a[228:231], v14 offset:33792
v_mul_f32 v227, v163, v227
v_mul_f32 v160, s49, v160
v_mul_f32 v161, s49, v161
v_mul_f32 v162, s49, v162
v_mul_f32 v163, s49, v163
v_mfma_f32_32x32x16_bf16 v[32:47], a[244:247], a[180:183], v[32:47]
buffer_store_dwordx4 v[140:143], v5, s[4:7], s41 offen offset:1024 sc1
v_exp_f32 v160, v160
v_mul_f32 v240, v176, v240
v_exp_f32 v161, v161
v_mfma_f32_32x32x16_bf16 v[48:63], a[248:251], a[180:183], v[48:63]
ds_read_b128 a[232:235], v14 offset:34816
ds_read_b128 a[236:239], v14 offset:35840
v_mul_f32 v241, v177, v241
v_exp_f32 v162, v162
v_mul_f32 v242, v178, v242
v_mfma_f32_32x32x16_bf16 v[64:79], a[252:255], a[180:183], v[64:79]
buffer_load_dwordx4 a[168:171], v5, s[4:7], s40 offen offset:2048  sc1
s_waitcnt lgkmcnt(4)
v_exp_f32 v163, v163
v_mul_f32 v243, v179, v243
v_add_f32 v160, 1.0, v160
v_mfma_f32_32x32x16_bf16 v[80:95], a[208:211], a[180:183], v[80:95]
ds_read_b128 a[240:243], v14 offset:36864
ds_read_b128 a[244:247], v14 offset:37888
v_add_f32 v161, 1.0, v161
v_mul_f32 v176, s49, v176
v_add_f32 v162, 1.0, v162
v_add_f32 v163, 1.0, v163
v_mul_f32 v177, s49, v177
v_mfma_f32_32x32x16_bf16 v[96:111], a[212:215], a[180:183], v[96:111]
buffer_load_dwordx4 a[172:175], v5, s[4:7], s40 offen offset:3072  sc1
v_rcp_f32 v160, v160
v_mul_f32 v178, s49, v178
v_rcp_f32 v161, v161
v_mfma_f32_32x32x16_bf16 v[32:47], a[216:219], a[184:187], v[32:47]
ds_read_b128 a[248:251], v14 offset:38912
ds_read_b128 a[252:255], v14 offset:39936
v_mul_f32 v179, s49, v179
v_rcp_f32 v162, v162
v_rcp_f32 v163, v163
v_mfma_f32_32x32x16_bf16 v[48:63], a[220:223], a[184:187], v[48:63]
buffer_load_dwordx4 v16, s[4:7], s38 offen  sc1 lds
v_exp_f32 v176, v176
v_mul_f32 v224, v224, v160
s_waitcnt vmcnt(41)
s_barrier
s_waitcnt lgkmcnt(4)
v_mfma_f32_32x32x16_bf16 v[64:79], a[224:227], a[184:187], v[64:79]
ds_read_b128 a[208:211], v14 offset:40960
ds_read_b128 a[212:215], v14 offset:41984
s_add_u32 m0, s54, 61440
s_add_u32 s39, s67, 819200
v_exp_f32 v177, v177
v_mul_f32 v225, v225, v161
v_mfma_f32_32x32x16_bf16 v[80:95], a[228:231], a[184:187], v[80:95]
buffer_load_dwordx4 v5, s[4:7], s39 offen offset:0  sc1 lds
v_exp_f32 v178, v178
v_mul_f32 v226, v226, v162
v_exp_f32 v179, v179
v_mfma_f32_32x32x16_bf16 v[96:111], a[232:235], a[184:187], v[96:111]
ds_read_b128 a[216:219], v14 offset:43008
ds_read_b128 a[220:223], v14 offset:44032
v_mul_f32 v227, v227, v163
v_add_f32 v176, 1.0, v176
v_cvt_pk_bf16_f32 v160, v224, v225
v_add_f32 v177, 1.0, v177
v_cvt_pk_bf16_f32 v161, v226, v227
v_mfma_f32_32x32x16_bf16 v[32:47], a[236:239], a[188:191], v[32:47]
buffer_load_dwordx4 v5, s[4:7], s39 offen offset:1024  sc1 lds
s_waitcnt lgkmcnt(4)
v_add_f32 v178, 1.0, v178
v_add_f32 v179, 1.0, v179
v_rcp_f32 v176, v176
v_mfma_f32_32x32x16_bf16 v[48:63], a[240:243], a[188:191], v[48:63]
ds_read_b128 a[224:227], v14 offset:45056
ds_read_b128 a[228:231], v14 offset:46080
v_rcp_f32 v177, v177
v_rcp_f32 v178, v178
v_mfma_f32_32x32x16_bf16 v[64:79], a[244:247], a[188:191], v[64:79]
buffer_load_dwordx4 v5, s[4:7], s39 offen offset:2048  sc1 lds
v_rcp_f32 v179, v179
v_mul_f32 v240, v240, v176
v_mul_f32 v241, v241, v177
v_mul_f32 v242, v242, v178
v_mfma_f32_32x32x16_bf16 v[80:95], a[248:251], a[188:191], v[80:95]
ds_read_b128 a[232:235], v14 offset:47104
ds_read_b128 a[236:239], v14 offset:48128
v_mul_f32 v243, v243, v179
v_cvt_pk_bf16_f32 v162, v240, v241
v_cvt_pk_bf16_f32 v163, v242, v243
v_mul_f32 v228, v164, v228
v_mul_f32 v229, v165, v229
v_mfma_f32_32x32x16_bf16 v[96:111], a[252:255], a[188:191], v[96:111]
buffer_load_dwordx4 v5, s[4:7], s39 offen offset:3072  sc1 lds
s_add_u32 m0, s54, 65536
s_add_u32 s41, s43, 0
v_mul_f32 v230, v166, v230
v_mul_f32 v231, v167, v231
s_waitcnt vmcnt(40) lgkmcnt(4)
v_mfma_f32_32x32x16_bf16 v[32:47], a[208:211], v[112:115], v[32:47]
ds_read_b128 a[240:243], v14 offset:49152
ds_read_b128 a[244:247], v14 offset:50176
s_add_u32 s40, s66, 32768
v_mul_f32 v164, s49, v164
v_mul_f32 v165, s49, v165
v_mul_f32 v166, s49, v166
v_mul_f32 v167, s49, v167
v_mfma_f32_32x32x16_bf16 v[48:63], a[212:215], v[112:115], v[48:63]
buffer_store_dwordx4 v[160:163], v5, s[4:7], s41 offen offset:2048 sc1
v_exp_f32 v164, v164
v_mul_f32 v244, v180, v244
v_exp_f32 v165, v165
v_mfma_f32_32x32x16_bf16 v[64:79], a[216:219], v[112:115], v[64:79]
ds_read_b128 a[248:251], v14 offset:51200
ds_read_b128 a[252:255], v14 offset:52224
v_mul_f32 v245, v181, v245
v_exp_f32 v166, v166
v_mul_f32 v246, v182, v246
v_mfma_f32_32x32x16_bf16 v[80:95], a[220:223], v[112:115], v[80:95]
buffer_load_dwordx4 a[176:179], v5, s[4:7], s40 offen offset:0  sc1
s_waitcnt lgkmcnt(4)
v_exp_f32 v167, v167
v_mul_f32 v247, v183, v247
v_add_f32 v164, 1.0, v164
v_mfma_f32_32x32x16_bf16 v[96:111], a[224:227], v[112:115], v[96:111]
ds_read_b128 a[208:211], v14 offset:53248
ds_read_b128 a[212:215], v14 offset:54272
v_add_f32 v165, 1.0, v165
v_mul_f32 v180, s49, v180
v_add_f32 v166, 1.0, v166
v_add_f32 v167, 1.0, v167
v_mul_f32 v181, s49, v181
v_mfma_f32_32x32x16_bf16 v[32:47], a[228:231], v[116:119], v[32:47]
buffer_load_dwordx4 a[180:183], v5, s[4:7], s40 offen offset:1024  sc1
v_rcp_f32 v164, v164
v_mul_f32 v182, s49, v182
v_rcp_f32 v165, v165
v_mfma_f32_32x32x16_bf16 v[48:63], a[232:235], v[116:119], v[48:63]
ds_read_b128 a[216:219], v14 offset:55296
ds_read_b128 a[220:223], v14 offset:56320
v_mul_f32 v183, s49, v183
v_rcp_f32 v166, v166
v_rcp_f32 v167, v167
v_mfma_f32_32x32x16_bf16 v[64:79], a[236:239], v[116:119], v[64:79]
buffer_load_dwordx4 a[184:187], v5, s[4:7], s40 offen offset:2048  sc1
s_waitcnt lgkmcnt(4)
v_exp_f32 v180, v180
v_mul_f32 v228, v228, v164
v_mfma_f32_32x32x16_bf16 v[80:95], a[240:243], v[116:119], v[80:95]
ds_read_b128 a[224:227], v14 offset:57344
ds_read_b128 a[228:231], v14 offset:58368
v_exp_f32 v181, v181
v_mul_f32 v229, v229, v165
v_exp_f32 v182, v182
v_mfma_f32_32x32x16_bf16 v[96:111], a[244:247], v[116:119], v[96:111]
buffer_load_dwordx4 a[188:191], v5, s[4:7], s40 offen offset:3072  sc1
v_mul_f32 v230, v230, v166
v_exp_f32 v183, v183
v_mul_f32 v231, v231, v167
v_add_f32 v180, 1.0, v180
v_mfma_f32_32x32x16_bf16 v[32:47], a[248:251], v[120:123], v[32:47]
ds_read_b128 a[232:235], v14 offset:59392
ds_read_b128 a[236:239], v14 offset:60416
v_cvt_pk_bf16_f32 v164, v228, v229
v_add_f32 v181, 1.0, v181
v_cvt_pk_bf16_f32 v165, v230, v231
v_add_f32 v182, 1.0, v182
v_add_f32 v183, 1.0, v183
v_mfma_f32_32x32x16_bf16 v[48:63], a[252:255], v[120:123], v[48:63]
buffer_load_dwordx4 v16, s[4:7], s39 offen  sc1 lds
v_rcp_f32 v180, v180
v_rcp_f32 v181, v181
s_waitcnt vmcnt(46)
s_barrier
s_waitcnt lgkmcnt(4)
v_mfma_f32_32x32x16_bf16 v[64:79], a[208:211], v[120:123], v[64:79]
ds_read_b128 a[240:243], v15 offset:0
ds_read_b128 a[244:247], v15 offset:1024
s_add_u32 m0, s54, 81920
s_add_u32 s38, s67, 901120
v_rcp_f32 v182, v182
v_mfma_f32_32x32x16_bf16 v[80:95], a[212:215], v[120:123], v[80:95]
buffer_load_dwordx4 v5, s[4:7], s38 offen offset:0  sc1 lds
v_rcp_f32 v183, v183
v_mul_f32 v244, v244, v180
v_mul_f32 v245, v245, v181
v_mul_f32 v246, v246, v182
v_mfma_f32_32x32x16_bf16 v[96:111], a[216:219], v[120:123], v[96:111]
ds_read_b128 a[248:251], v15 offset:2048
ds_read_b128 a[252:255], v15 offset:3072
v_mul_f32 v247, v247, v183
v_cvt_pk_bf16_f32 v166, v244, v245
v_cvt_pk_bf16_f32 v167, v246, v247
v_mul_f32 v232, v168, v232
v_mul_f32 v233, v169, v233
v_mfma_f32_32x32x16_bf16 v[32:47], a[220:223], v[124:127], v[32:47]
buffer_load_dwordx4 v5, s[4:7], s38 offen offset:1024  sc1 lds
s_add_u32 s41, s43, 0
v_mul_f32 v234, v170, v234
v_mul_f32 v235, v171, v235
v_mul_f32 v168, s49, v168
s_waitcnt lgkmcnt(4)
v_mfma_f32_32x32x16_bf16 v[48:63], a[224:227], v[124:127], v[48:63]
ds_read_b128 a[208:211], v15 offset:4096
ds_read_b128 a[212:215], v15 offset:5120
v_mul_f32 v169, s49, v169
v_mul_f32 v170, s49, v170
v_mul_f32 v171, s49, v171
v_exp_f32 v168, v168
v_mfma_f32_32x32x16_bf16 v[64:79], a[228:231], v[124:127], v[64:79]
buffer_store_dwordx4 v[164:167], v5, s[4:7], s41 offen offset:3072 sc1
v_mul_f32 v248, v184, v248
v_exp_f32 v169, v169
v_mul_f32 v249, v185, v249
v_mfma_f32_32x32x16_bf16 v[80:95], a[232:235], v[124:127], v[80:95]
ds_read_b128 a[216:219], v15 offset:6144
ds_read_b128 a[220:223], v15 offset:7168
v_exp_f32 v170, v170
v_mul_f32 v250, v186, v250
v_exp_f32 v171, v171
v_mfma_f32_32x32x16_bf16 v[96:111], a[236:239], v[124:127], v[96:111]
buffer_load_dwordx4 v5, s[4:7], s38 offen offset:2048  sc1 lds
s_waitcnt vmcnt(36) lgkmcnt(4)
v_mul_f32 v251, v187, v251
v_add_f32 v168, 1.0, v168
v_add_f32 v169, 1.0, v169
v_mul_f32 v184, s49, v184
v_mfma_f32_32x32x16_bf16 v[32:47], a[240:243], a[128:131], v[32:47]
ds_read_b128 a[224:227], v15 offset:8192
ds_read_b128 a[228:231], v15 offset:9216
s_add_u32 s40, s66, 36864
v_add_f32 v170, 1.0, v170
v_add_f32 v171, 1.0, v171
v_mul_f32 v185, s49, v185
v_mfma_f32_32x32x16_bf16 v[48:63], a[244:247], a[128:131], v[48:63]
buffer_load_dwordx4 v[112:115], v5, s[4:7], s40 offen offset:0  sc1
v_rcp_f32 v168, v168
v_mul_f32 v186, s49, v186
v_rcp_f32 v169, v169
v_mfma_f32_32x32x16_bf16 v[64:79], a[248:251], a[128:131], v[64:79]
ds_read_b128 a[232:235], v15 offset:10240
ds_read_b128 a[236:239], v15 offset:11264
v_mul_f32 v187, s49, v187
v_rcp_f32 v170, v170
v_rcp_f32 v171, v171
v_mfma_f32_32x32x16_bf16 v[80:95], a[252:255], a[128:131], v[80:95]
buffer_load_dwordx4 v[116:119], v5, s[4:7], s40 offen offset:1024  sc1
s_waitcnt lgkmcnt(4)
v_exp_f32 v184, v184
v_mul_f32 v232, v232, v168
v_mfma_f32_32x32x16_bf16 v[96:111], a[208:211], a[128:131], v[96:111]
ds_read_b128 a[240:243], v15 offset:12288
ds_read_b128 a[244:247], v15 offset:13312
v_exp_f32 v185, v185
v_mul_f32 v233, v233, v169
v_exp_f32 v186, v186
v_mfma_f32_32x32x16_bf16 v[32:47], a[212:215], a[132:135], v[32:47]
buffer_load_dwordx4 v[120:123], v5, s[4:7], s40 offen offset:2048  sc1
v_mul_f32 v234, v234, v170
v_exp_f32 v187, v187
v_mul_f32 v235, v235, v171
v_add_f32 v184, 1.0, v184
v_mfma_f32_32x32x16_bf16 v[48:63], a[216:219], a[132:135], v[48:63]
ds_read_b128 a[248:251], v15 offset:14336
ds_read_b128 a[252:255], v15 offset:15360
v_cvt_pk_bf16_f32 v168, v232, v233
v_add_f32 v185, 1.0, v185
v_cvt_pk_bf16_f32 v169, v234, v235
v_add_f32 v186, 1.0, v186
v_add_f32 v187, 1.0, v187
v_mfma_f32_32x32x16_bf16 v[64:79], a[220:223], a[132:135], v[64:79]
buffer_load_dwordx4 v[124:127], v5, s[4:7], s40 offen offset:3072  sc1
s_waitcnt lgkmcnt(4)
v_rcp_f32 v184, v184
v_rcp_f32 v185, v185
v_mfma_f32_32x32x16_bf16 v[80:95], a[224:227], a[132:135], v[80:95]
ds_read_b128 a[208:211], v15 offset:16384
ds_read_b128 a[212:215], v15 offset:17408
v_rcp_f32 v186, v186
v_rcp_f32 v187, v187
v_mul_f32 v248, v248, v184
v_mfma_f32_32x32x16_bf16 v[96:111], a[228:231], a[132:135], v[96:111]
buffer_load_dwordx4 v5, s[4:7], s38 offen offset:3072  sc1 lds
s_add_u32 m0, s54, 86016
v_mul_f32 v249, v249, v185
v_mul_f32 v250, v250, v186
v_mul_f32 v251, v251, v187
v_cvt_pk_bf16_f32 v170, v248, v249
v_mfma_f32_32x32x16_bf16 v[32:47], a[232:235], a[136:139], v[32:47]
ds_read_b128 a[216:219], v15 offset:18432
ds_read_b128 a[220:223], v15 offset:19456
v_cvt_pk_bf16_f32 v171, v250, v251
v_mul_f32 v236, v172, v236
v_mul_f32 v237, v173, v237
v_mul_f32 v238, v174, v238
v_mul_f32 v239, v175, v239
v_mfma_f32_32x32x16_bf16 v[48:63], a[236:239], a[136:139], v[48:63]
buffer_load_dwordx4 v16, s[4:7], s38 offen  sc1 lds
s_add_u32 s41, s43, 110592
v_mul_f32 v172, s49, v172
v_mul_f32 v173, s49, v173
v_mul_f32 v174, s49, v174
s_barrier
s_waitcnt lgkmcnt(4)
v_mfma_f32_32x32x16_bf16 v[64:79], a[240:243], a[136:139], v[64:79]
ds_read_b128 a[224:227], v5 offset:0
ds_read_b128 a[228:231], v5 offset:1024
s_add_u32 m0, s54, 102400
s_add_u32 s39, s67, 983040
v_mul_f32 v175, s49, v175
v_exp_f32 v172, v172
v_mfma_f32_32x32x16_bf16 v[80:95], a[244:247], a[136:139], v[80:95]
buffer_store_dwordx4 v[168:171], v5, s[4:7], s41 offen offset:2048 sc1
v_mul_f32 v252, v188, v252
v_exp_f32 v173, v173
v_mul_f32 v253, v189, v253
v_mfma_f32_32x32x16_bf16 v[96:111], a[248:251], a[136:139], v[96:111]
ds_read_b128 a[232:235], v5 offset:2048
ds_read_b128 a[236:239], v5 offset:3072
v_exp_f32 v174, v174
v_mul_f32 v254, v190, v254
v_exp_f32 v175, v175
v_mfma_f32_32x32x16_bf16 v[32:47], a[252:255], a[140:143], v[32:47]
buffer_load_dwordx4 v5, s[4:7], s39 offen offset:0  sc1 lds
s_waitcnt lgkmcnt(4)
v_mul_f32 v255, v191, v255
v_add_f32 v172, 1.0, v172
v_add_f32 v173, 1.0, v173
v_mul_f32 v188, s49, v188
v_mfma_f32_32x32x16_bf16 v[48:63], a[208:211], a[140:143], v[48:63]
ds_read_b128 a[240:243], v5 offset:4096
ds_read_b128 a[244:247], v5 offset:5120
v_add_f32 v174, 1.0, v174
v_add_f32 v175, 1.0, v175
v_mul_f32 v189, s49, v189
v_rcp_f32 v172, v172
v_mfma_f32_32x32x16_bf16 v[64:79], a[212:215], a[140:143], v[64:79]
buffer_load_dwordx4 v5, s[4:7], s39 offen offset:1024  sc1 lds
v_mul_f32 v190, s49, v190
v_rcp_f32 v173, v173
v_mul_f32 v191, s49, v191
v_mfma_f32_32x32x16_bf16 v[80:95], a[216:219], a[140:143], v[80:95]
ds_read_b128 a[248:251], v5 offset:6144
ds_read_b128 a[252:255], v5 offset:7168
v_rcp_f32 v174, v174
v_rcp_f32 v175, v175
v_mfma_f32_32x32x16_bf16 v[96:111], a[220:223], a[140:143], v[96:111]
buffer_load_dwordx4 v5, s[4:7], s39 offen offset:2048  sc1 lds
s_waitcnt vmcnt(36) lgkmcnt(4)
v_exp_f32 v188, v188
v_mul_f32 v236, v236, v172
v_mfma_f32_32x32x16_bf16 v[32:47], a[224:227], a[144:147], v[32:47]
ds_read_b128 a[208:211], v5 offset:8192
ds_read_b128 a[212:215], v5 offset:9216
s_add_u32 s40, s66, 40960
v_exp_f32 v189, v189
v_mul_f32 v237, v237, v173
v_mfma_f32_32x32x16_bf16 v[48:63], a[228:231], a[144:147], v[48:63]
buffer_load_dwordx4 a[128:131], v5, s[4:7], s40 offen offset:0  sc1
v_exp_f32 v190, v190
v_mul_f32 v238, v238, v174
v_exp_f32 v191, v191
v_mfma_f32_32x32x16_bf16 v[64:79], a[232:235], a[144:147], v[64:79]
ds_read_b128 a[216:219], v5 offset:10240
ds_read_b128 a[220:223], v5 offset:11264
v_mul_f32 v239, v239, v175
v_add_f32 v188, 1.0, v188
v_cvt_pk_bf16_f32 v172, v236, v237
v_add_f32 v189, 1.0, v189
v_cvt_pk_bf16_f32 v173, v238, v239
v_mfma_f32_32x32x16_bf16 v[80:95], a[236:239], a[144:147], v[80:95]
buffer_load_dwordx4 a[132:135], v5, s[4:7], s40 offen offset:1024  sc1
s_waitcnt lgkmcnt(4)
v_add_f32 v190, 1.0, v190
v_add_f32 v191, 1.0, v191
v_rcp_f32 v188, v188
v_mfma_f32_32x32x16_bf16 v[96:111], a[240:243], a[144:147], v[96:111]
ds_read_b128 a[224:227], v5 offset:12288
ds_read_b128 a[228:231], v5 offset:13312
v_rcp_f32 v189, v189
v_rcp_f32 v190, v190
v_mfma_f32_32x32x16_bf16 v[32:47], a[244:247], a[148:151], v[32:47]
buffer_load_dwordx4 a[136:139], v5, s[4:7], s40 offen offset:2048  sc1
v_rcp_f32 v191, v191
v_mul_f32 v252, v252, v188
v_mul_f32 v253, v253, v189
v_mul_f32 v254, v254, v190
v_mfma_f32_32x32x16_bf16 v[48:63], a[248:251], a[148:151], v[48:63]
ds_read_b128 a[232:235], v5 offset:14336
ds_read_b128 a[236:239], v5 offset:15360
v_mul_f32 v255, v255, v191
v_cvt_pk_bf16_f32 v174, v252, v253
v_cvt_pk_bf16_f32 v175, v254, v255
v_mfma_f32_32x32x16_bf16 v[64:79], a[252:255], a[148:151], v[64:79]
buffer_load_dwordx4 a[140:143], v5, s[4:7], s40 offen offset:3072  sc1
s_add_u32 s41, s43, 110592
s_waitcnt lgkmcnt(4)
v_mfma_f32_32x32x16_bf16 v[80:95], a[208:211], a[148:151], v[80:95]
ds_read_b128 a[240:243], v5 offset:16384
ds_read_b128 a[244:247], v5 offset:17408
v_mfma_f32_32x32x16_bf16 v[96:111], a[212:215], a[148:151], v[96:111]
buffer_store_dwordx4 v[172:175], v5, s[4:7], s41 offen offset:3072 sc1
v_mfma_f32_32x32x16_bf16 v[32:47], a[216:219], a[152:155], v[32:47]
ds_read_b128 a[248:251], v5 offset:18432
ds_read_b128 a[252:255], v5 offset:19456
v_mfma_f32_32x32x16_bf16 v[48:63], a[220:223], a[152:155], v[48:63]
buffer_load_dwordx4 v5, s[4:7], s39 offen offset:3072  sc1 lds
s_add_u32 m0, s54, 106496
s_barrier
s_waitcnt lgkmcnt(4)
v_mfma_f32_32x32x16_bf16 v[64:79], a[224:227], a[152:155], v[64:79]
ds_read_b128 a[208:211], v5 offset:20480
ds_read_b128 a[212:215], v5 offset:21504
v_mfma_f32_32x32x16_bf16 v[80:95], a[228:231], a[152:155], v[80:95]
buffer_load_dwordx4 v16, s[4:7], s39 offen  sc1 lds
s_add_u32 m0, s54, 122880
s_add_u32 s38, s67, 1064960
v_mfma_f32_32x32x16_bf16 v[96:111], a[232:235], a[152:155], v[96:111]
ds_read_b128 a[216:219], v5 offset:22528
ds_read_b128 a[220:223], v5 offset:23552
v_mfma_f32_32x32x16_bf16 v[32:47], a[236:239], a[156:159], v[32:47]
buffer_load_dwordx4 v5, s[4:7], s38 offen offset:0  sc1 lds
s_waitcnt lgkmcnt(4)
v_mfma_f32_32x32x16_bf16 v[48:63], a[240:243], a[156:159], v[48:63]
ds_read_b128 a[224:227], v5 offset:24576
ds_read_b128 a[228:231], v5 offset:25600
v_mfma_f32_32x32x16_bf16 v[64:79], a[244:247], a[156:159], v[64:79]
buffer_load_dwordx4 v5, s[4:7], s38 offen offset:1024  sc1 lds
v_mfma_f32_32x32x16_bf16 v[80:95], a[248:251], a[156:159], v[80:95]
ds_read_b128 a[232:235], v5 offset:26624
ds_read_b128 a[236:239], v5 offset:27648
v_mfma_f32_32x32x16_bf16 v[96:111], a[252:255], a[156:159], v[96:111]
buffer_load_dwordx4 v5, s[4:7], s38 offen offset:2048  sc1 lds
s_waitcnt vmcnt(35) lgkmcnt(4)
v_mfma_f32_32x32x16_bf16 v[32:47], a[208:211], a[160:163], v[32:47]
ds_read_b128 a[240:243], v5 offset:28672
ds_read_b128 a[244:247], v5 offset:29696
s_add_u32 s40, s66, 45056
v_mfma_f32_32x32x16_bf16 v[48:63], a[212:215], a[160:163], v[48:63]
buffer_load_dwordx4 a[144:147], v5, s[4:7], s40 offen offset:0  sc1
v_mfma_f32_32x32x16_bf16 v[64:79], a[216:219], a[160:163], v[64:79]
ds_read_b128 a[248:251], v5 offset:30720
ds_read_b128 a[252:255], v5 offset:31744
v_mfma_f32_32x32x16_bf16 v[80:95], a[220:223], a[160:163], v[80:95]
buffer_load_dwordx4 a[148:151], v5, s[4:7], s40 offen offset:1024  sc1
s_waitcnt lgkmcnt(4)
v_mfma_f32_32x32x16_bf16 v[96:111], a[224:227], a[160:163], v[96:111]
ds_read_b128 a[208:211], v5 offset:32768
ds_read_b128 a[212:215], v5 offset:33792
v_mfma_f32_32x32x16_bf16 v[32:47], a[228:231], a[164:167], v[32:47]
buffer_load_dwordx4 a[152:155], v5, s[4:7], s40 offen offset:2048  sc1
v_mfma_f32_32x32x16_bf16 v[48:63], a[232:235], a[164:167], v[48:63]
ds_read_b128 a[216:219], v5 offset:34816
ds_read_b128 a[220:223], v5 offset:35840
v_mfma_f32_32x32x16_bf16 v[64:79], a[236:239], a[164:167], v[64:79]
buffer_load_dwordx4 a[156:159], v5, s[4:7], s40 offen offset:3072  sc1
s_waitcnt lgkmcnt(4)
v_mfma_f32_32x32x16_bf16 v[80:95], a[240:243], a[164:167], v[80:95]
ds_read_b128 a[224:227], v5 offset:36864
ds_read_b128 a[228:231], v5 offset:37888
v_mfma_f32_32x32x16_bf16 v[96:111], a[244:247], a[164:167], v[96:111]
buffer_load_dwordx4 v5, s[4:7], s38 offen offset:3072  sc1 lds
s_add_u32 m0, s54, 126976
v_mfma_f32_32x32x16_bf16 v[32:47], a[248:251], a[168:171], v[32:47]
ds_read_b128 a[232:235], v5 offset:38912
ds_read_b128 a[236:239], v5 offset:39936
v_mfma_f32_32x32x16_bf16 v[48:63], a[252:255], a[168:171], v[48:63]
buffer_load_dwordx4 v16, s[4:7], s38 offen  sc1 lds
s_waitcnt vmcnt(11)
s_barrier
s_waitcnt lgkmcnt(4)
v_mfma_f32_32x32x16_bf16 v[64:79], a[208:211], a[168:171], v[64:79]
ds_read_b128 a[240:243], v15 offset:20480
ds_read_b128 a[244:247], v15 offset:21504
s_sub_u32 s41, s84, 60817408
s_lshr_b32 s41, s41, 3
s_add_u32 s41, s41, 60948480
s_max_u32 s41, s41, s62
v_mfma_f32_32x32x16_bf16 v[80:95], a[212:215], a[168:171], v[80:95]
buffer_store_dwordx2 v[10:11], v9, s[4:7], s41 offen sc1
s_add_u32 m0, s54, 0
s_add_u32 s39, s67, 1146880
v_mfma_f32_32x32x16_bf16 v[96:111], a[216:219], a[168:171], v[96:111]
buffer_load_dwordx4 v5, s[4:7], s39 offen offset:0  sc1 lds
ds_read_b128 a[248:251], v15 offset:22528
v_mfma_f32_32x32x16_bf16 v[32:47], a[220:223], a[172:175], v[32:47]
ds_read_b128 a[252:255], v15 offset:23552
s_waitcnt lgkmcnt(4)
v_mfma_f32_32x32x16_bf16 v[48:63], a[224:227], a[172:175], v[48:63]
buffer_load_dwordx4 v5, s[4:7], s39 offen offset:1024  sc1 lds
ds_read_b128 a[208:211], v15 offset:24576
v_mfma_f32_32x32x16_bf16 v[64:79], a[228:231], a[172:175], v[64:79]
ds_read_b128 a[212:215], v15 offset:25600
v_mfma_f32_32x32x16_bf16 v[80:95], a[232:235], a[172:175], v[80:95]
buffer_load_dwordx4 v5, s[4:7], s39 offen offset:2048  sc1 lds
ds_read_b128 a[216:219], v15 offset:26624
v_mfma_f32_32x32x16_bf16 v[96:111], a[236:239], a[172:175], v[96:111]
ds_read_b128 a[220:223], v15 offset:27648
s_waitcnt lgkmcnt(4)
v_mfma_f32_32x32x16_bf16 v[32:47], a[240:243], a[176:179], v[32:47]
ds_read_b128 a[224:227], v15 offset:28672
ds_read_b128 a[228:231], v15 offset:29696
s_add_u32 s40, s66, 49152
v_mfma_f32_32x32x16_bf16 v[48:63], a[244:247], a[176:179], v[48:63]
buffer_load_dwordx4 a[160:163], v5, s[4:7], s40 offen offset:0  sc1
v_mfma_f32_32x32x16_bf16 v[64:79], a[248:251], a[176:179], v[64:79]
buffer_load_dwordx4 a[164:167], v5, s[4:7], s40 offen offset:1024  sc1
ds_read_b128 a[232:235], v15 offset:30720
v_mfma_f32_32x32x16_bf16 v[80:95], a[252:255], a[176:179], v[80:95]
ds_read_b128 a[236:239], v15 offset:31744
s_waitcnt lgkmcnt(4)
v_mfma_f32_32x32x16_bf16 v[96:111], a[208:211], a[176:179], v[96:111]
buffer_load_dwordx4 a[168:171], v5, s[4:7], s40 offen offset:2048  sc1
ds_read_b128 a[240:243], v15 offset:32768
v_mfma_f32_32x32x16_bf16 v[32:47], a[212:215], a[180:183], v[32:47]
ds_read_b128 a[244:247], v15 offset:33792
v_mfma_f32_32x32x16_bf16 v[48:63], a[216:219], a[180:183], v[48:63]
buffer_load_dwordx4 a[172:175], v5, s[4:7], s40 offen offset:3072  sc1
ds_read_b128 a[248:251], v15 offset:34816
v_mfma_f32_32x32x16_bf16 v[64:79], a[220:223], a[180:183], v[64:79]
ds_read_b128 a[252:255], v15 offset:35840
s_waitcnt lgkmcnt(4)
v_mfma_f32_32x32x16_bf16 v[80:95], a[224:227], a[180:183], v[80:95]
buffer_load_dwordx4 v5, s[4:7], s39 offen offset:3072  sc1 lds
ds_read_b128 a[208:211], v15 offset:36864
s_add_u32 m0, s54, 4096
v_mfma_f32_32x32x16_bf16 v[96:111], a[228:231], a[180:183], v[96:111]
ds_read_b128 a[212:215], v15 offset:37888
v_mfma_f32_32x32x16_bf16 v[32:47], a[232:235], a[184:187], v[32:47]
buffer_load_dwordx4 v16, s[4:7], s39 offen  sc1 lds
ds_read_b128 a[216:219], v15 offset:38912
v_mfma_f32_32x32x16_bf16 v[48:63], a[236:239], a[184:187], v[48:63]
ds_read_b128 a[220:223], v15 offset:39936
s_barrier
s_waitcnt lgkmcnt(4)
v_mfma_f32_32x32x16_bf16 v[64:79], a[240:243], a[184:187], v[64:79]
ds_read_b128 a[224:227], v5 offset:40960
ds_read_b128 a[228:231], v5 offset:41984
s_add_u32 m0, s54, 20480
s_add_u32 s38, s67, 1228800
v_mfma_f32_32x32x16_bf16 v[80:95], a[244:247], a[184:187], v[80:95]
buffer_load_dwordx4 v5, s[4:7], s38 offen offset:0  sc1 lds
v_mfma_f32_32x32x16_bf16 v[96:111], a[248:251], a[184:187], v[96:111]
buffer_load_dwordx4 v5, s[4:7], s38 offen offset:1024  sc1 lds
ds_read_b128 a[232:235], v5 offset:43008
v_mfma_f32_32x32x16_bf16 v[32:47], a[252:255], a[188:191], v[32:47]
ds_read_b128 a[236:239], v5 offset:44032
s_waitcnt lgkmcnt(4)
v_mfma_f32_32x32x16_bf16 v[48:63], a[208:211], a[188:191], v[48:63]
buffer_load_dwordx4 v5, s[4:7], s38 offen offset:2048  sc1 lds
ds_read_b128 a[240:243], v5 offset:45056
v_mfma_f32_32x32x16_bf16 v[64:79], a[212:215], a[188:191], v[64:79]
ds_read_b128 a[244:247], v5 offset:46080
v_mfma_f32_32x32x16_bf16 v[80:95], a[216:219], a[188:191], v[80:95]
buffer_load_dwordx4 v5, s[4:7], s38 offen offset:3072  sc1 lds
ds_read_b128 a[248:251], v5 offset:47104
s_add_u32 m0, s54, 24576
v_mfma_f32_32x32x16_bf16 v[96:111], a[220:223], a[188:191], v[96:111]
ds_read_b128 a[252:255], v5 offset:48128
s_waitcnt lgkmcnt(4)
v_mfma_f32_32x32x16_bf16 v[32:47], a[224:227], v[112:115], v[32:47]
ds_read_b128 a[208:211], v5 offset:49152
ds_read_b128 a[212:215], v5 offset:50176
s_add_u32 s40, s66, 53248
v_mfma_f32_32x32x16_bf16 v[48:63], a[228:231], v[112:115], v[48:63]
buffer_load_dwordx4 a[176:179], v5, s[4:7], s40 offen offset:0  sc1
v_mfma_f32_32x32x16_bf16 v[64:79], a[232:235], v[112:115], v[64:79]
buffer_load_dwordx4 a[180:183], v5, s[4:7], s40 offen offset:1024  sc1
ds_read_b128 a[216:219], v5 offset:51200
v_mfma_f32_32x32x16_bf16 v[80:95], a[236:239], v[112:115], v[80:95]
ds_read_b128 a[220:223], v5 offset:52224
s_waitcnt lgkmcnt(4)
v_mfma_f32_32x32x16_bf16 v[96:111], a[240:243], v[112:115], v[96:111]
buffer_load_dwordx4 a[184:187], v5, s[4:7], s40 offen offset:2048  sc1
ds_read_b128 a[224:227], v5 offset:53248
v_mfma_f32_32x32x16_bf16 v[32:47], a[244:247], v[116:119], v[32:47]
ds_read_b128 a[228:231], v5 offset:54272
v_mfma_f32_32x32x16_bf16 v[48:63], a[248:251], v[116:119], v[48:63]
buffer_load_dwordx4 a[188:191], v5, s[4:7], s40 offen offset:3072  sc1
ds_read_b128 a[232:235], v5 offset:55296
v_mfma_f32_32x32x16_bf16 v[64:79], a[252:255], v[116:119], v[64:79]
ds_read_b128 a[236:239], v5 offset:56320
s_waitcnt lgkmcnt(4)
v_mfma_f32_32x32x16_bf16 v[80:95], a[208:211], v[116:119], v[80:95]
buffer_load_dwordx4 v16, s[4:7], s38 offen  sc1 lds
ds_read_b128 a[240:243], v5 offset:57344
s_add_u32 s63, s81, 0
v_mfma_f32_32x32x16_bf16 v[96:111], a[212:215], v[116:119], v[96:111]
ds_read_b128 a[244:247], v5 offset:58368
v_mfma_f32_32x32x16_bf16 v[32:47], a[216:219], v[120:123], v[32:47]
buffer_load_dwordx4 a[0:3], v6, s[4:7], s63 offen offset:0 sc1
ds_read_b128 a[248:251], v5 offset:59392
v_mfma_f32_32x32x16_bf16 v[48:63], a[220:223], v[120:123], v[48:63]
ds_read_b128 a[252:255], v5 offset:60416
s_barrier
s_waitcnt lgkmcnt(4)
v_mfma_f32_32x32x16_bf16 v[64:79], a[224:227], v[120:123], v[64:79]
buffer_load_dwordx4 a[4:7], v6, s[4:7], s63 offen offset:1024 sc1
ds_read_b128 a[208:211], v14 offset:0
v_mfma_f32_32x32x16_bf16 v[80:95], a[228:231], v[120:123], v[80:95]
ds_read_b128 a[212:215], v14 offset:1024
v_mfma_f32_32x32x16_bf16 v[96:111], a[232:235], v[120:123], v[96:111]
buffer_load_dwordx4 a[8:11], v6, s[4:7], s63 offen offset:2048 sc1
ds_read_b128 a[216:219], v14 offset:2048
v_mfma_f32_32x32x16_bf16 v[32:47], a[236:239], v[124:127], v[32:47]
ds_read_b128 a[220:223], v14 offset:3072
s_waitcnt lgkmcnt(4)
v_mfma_f32_32x32x16_bf16 v[48:63], a[240:243], v[124:127], v[48:63]
buffer_load_dwordx4 a[12:15], v6, s[4:7], s63 offen offset:3072 sc1
ds_read_b128 a[224:227], v14 offset:4096
v_mfma_f32_32x32x16_bf16 v[64:79], a[244:247], v[124:127], v[64:79]
ds_read_b128 a[228:231], v14 offset:5120
v_mfma_f32_32x32x16_bf16 v[80:95], a[248:251], v[124:127], v[80:95]
buffer_load_dwordx4 a[16:19], v8, s[4:7], s63 offen sc1
ds_read_b128 a[232:235], v14 offset:6144
s_add_u32 s63, s81, 40960
v_mfma_f32_32x32x16_bf16 v[96:111], a[252:255], v[124:127], v[96:111]
ds_read_b128 a[236:239], v14 offset:7168
s_waitcnt lgkmcnt(4)
v_mfma_f32_32x32x16_bf16 v[32:47], a[208:211], a[128:131], v[32:47]
ds_read_b128 a[240:243], v14 offset:8192
ds_read_b128 a[244:247], v14 offset:9216
s_add_u32 s40, s66, 57344
v_mfma_f32_32x32x16_bf16 v[48:63], a[212:215], a[128:131], v[48:63]
buffer_load_dwordx4 v[112:115], v5, s[4:7], s40 offen offset:0  sc1
v_mfma_f32_32x32x16_bf16 v[64:79], a[216:219], a[128:131], v[64:79]
buffer_load_dwordx4 v[116:119], v5, s[4:7], s40 offen offset:1024  sc1
ds_read_b128 a[248:251], v14 offset:10240
v_mfma_f32_32x32x16_bf16 v[80:95], a[220:223], a[128:131], v[80:95]
ds_read_b128 a[252:255], v14 offset:11264
s_waitcnt lgkmcnt(4)
v_mfma_f32_32x32x16_bf16 v[96:111], a[224:227], a[128:131], v[96:111]
buffer_load_dwordx4 v[120:123], v5, s[4:7], s40 offen offset:2048  sc1
ds_read_b128 a[208:211], v14 offset:12288
v_mfma_f32_32x32x16_bf16 v[32:47], a[228:231], a[132:135], v[32:47]
ds_read_b128 a[212:215], v14 offset:13312
v_mfma_f32_32x32x16_bf16 v[48:63], a[232:235], a[132:135], v[48:63]
buffer_load_dwordx4 v[124:127], v5, s[4:7], s40 offen offset:3072  sc1
ds_read_b128 a[216:219], v14 offset:14336
v_mfma_f32_32x32x16_bf16 v[64:79], a[236:239], a[132:135], v[64:79]
ds_read_b128 a[220:223], v14 offset:15360
s_waitcnt lgkmcnt(4)
v_mfma_f32_32x32x16_bf16 v[80:95], a[240:243], a[132:135], v[80:95]
buffer_load_dwordx4 a[36:39], v6, s[4:7], s63 offen offset:0 sc1
ds_read_b128 a[224:227], v14 offset:16384
v_mfma_f32_32x32x16_bf16 v[96:111], a[244:247], a[132:135], v[96:111]
ds_read_b128 a[228:231], v14 offset:17408
v_mfma_f32_32x32x16_bf16 v[32:47], a[248:251], a[136:139], v[32:47]
buffer_load_dwordx4 a[40:43], v6, s[4:7], s63 offen offset:1024 sc1
ds_read_b128 a[232:235], v14 offset:18432
v_mfma_f32_32x32x16_bf16 v[48:63], a[252:255], a[136:139], v[48:63]
ds_read_b128 a[236:239], v14 offset:19456
s_barrier
s_waitcnt lgkmcnt(4)
v_mfma_f32_32x32x16_bf16 v[64:79], a[208:211], a[136:139], v[64:79]
buffer_load_dwordx4 a[44:47], v6, s[4:7], s63 offen offset:2048 sc1
ds_read_b128 a[240:243], v14 offset:20480
v_mfma_f32_32x32x16_bf16 v[80:95], a[212:215], a[136:139], v[80:95]
ds_read_b128 a[244:247], v14 offset:21504
v_mfma_f32_32x32x16_bf16 v[96:111], a[216:219], a[136:139], v[96:111]
buffer_load_dwordx4 a[48:51], v6, s[4:7], s63 offen offset:3072 sc1
ds_read_b128 a[248:251], v14 offset:22528
v_mfma_f32_32x32x16_bf16 v[32:47], a[220:223], a[140:143], v[32:47]
ds_read_b128 a[252:255], v14 offset:23552
s_waitcnt lgkmcnt(4)
v_mfma_f32_32x32x16_bf16 v[48:63], a[224:227], a[140:143], v[48:63]
buffer_load_dwordx4 a[52:55], v8, s[4:7], s63 offen sc1
ds_read_b128 a[208:211], v14 offset:24576
s_add_u32 s63, s71, 81920
v_mfma_f32_32x32x16_bf16 v[64:79], a[228:231], a[140:143], v[64:79]
ds_read_b128 a[212:215], v14 offset:25600
v_mfma_f32_32x32x16_bf16 v[80:95], a[232:235], a[140:143], v[80:95]
buffer_load_dwordx4 a[72:75], v6, s[4:7], s63 offen offset:0 sc1
ds_read_b128 a[216:219], v14 offset:26624
v_mfma_f32_32x32x16_bf16 v[96:111], a[236:239], a[140:143], v[96:111]
ds_read_b128 a[220:223], v14 offset:27648
s_waitcnt vmcnt(36) lgkmcnt(4)
v_mfma_f32_32x32x16_bf16 v[32:47], a[240:243], a[144:147], v[32:47]
buffer_load_dwordx2 v[24:25], v23, s[4:7], s86 offen sc1
ds_read_b128 a[224:227], v14 offset:28672
s_add_u32 s40, s66, 61440
v_mfma_f32_32x32x16_bf16 v[48:63], a[244:247], a[144:147], v[48:63]
buffer_load_dwordx4 a[128:131], v5, s[4:7], s40 offen offset:0  sc1
ds_read_b128 a[228:231], v14 offset:29696
v_mfma_f32_32x32x16_bf16 v[64:79], a[248:251], a[144:147], v[64:79]
ds_read_b128 a[232:235], v14 offset:30720
ds_read_b128 a[236:239], v14 offset:31744
v_mfma_f32_32x32x16_bf16 v[80:95], a[252:255], a[144:147], v[80:95]
buffer_load_dwordx4 a[132:135], v5, s[4:7], s40 offen offset:1024  sc1
s_waitcnt lgkmcnt(4)
v_mfma_f32_32x32x16_bf16 v[96:111], a[208:211], a[144:147], v[96:111]
ds_read_b128 a[240:243], v14 offset:32768
ds_read_b128 a[244:247], v14 offset:33792
v_mfma_f32_32x32x16_bf16 v[32:47], a[212:215], a[148:151], v[32:47]
buffer_load_dwordx4 a[136:139], v5, s[4:7], s40 offen offset:2048  sc1
v_mfma_f32_32x32x16_bf16 v[48:63], a[216:219], a[148:151], v[48:63]
ds_read_b128 a[248:251], v14 offset:34816
ds_read_b128 a[252:255], v14 offset:35840
v_mfma_f32_32x32x16_bf16 v[64:79], a[220:223], a[148:151], v[64:79]
buffer_load_dwordx4 a[140:143], v5, s[4:7], s40 offen offset:3072  sc1
s_waitcnt lgkmcnt(4)
v_mfma_f32_32x32x16_bf16 v[80:95], a[224:227], a[148:151], v[80:95]
ds_read_b128 a[208:211], v14 offset:36864
ds_read_b128 a[212:215], v14 offset:37888
v_mfma_f32_32x32x16_bf16 v[96:111], a[228:231], a[148:151], v[96:111]
buffer_load_dwordx4 a[76:79], v6, s[4:7], s63 offen offset:1024 sc1
v_mfma_f32_32x32x16_bf16 v[32:47], a[232:235], a[152:155], v[32:47]
ds_read_b128 a[216:219], v14 offset:38912
ds_read_b128 a[220:223], v14 offset:39936
v_mfma_f32_32x32x16_bf16 v[48:63], a[236:239], a[152:155], v[48:63]
buffer_load_dwordx4 a[80:83], v6, s[4:7], s63 offen offset:2048 sc1
s_barrier
s_waitcnt lgkmcnt(4)
v_mfma_f32_32x32x16_bf16 v[64:79], a[240:243], a[152:155], v[64:79]
ds_read_b128 a[224:227], v14 offset:40960
ds_read_b128 a[228:231], v14 offset:41984
v_mfma_f32_32x32x16_bf16 v[80:95], a[244:247], a[152:155], v[80:95]
buffer_load_dwordx4 a[84:87], v6, s[4:7], s63 offen offset:3072 sc1
v_mfma_f32_32x32x16_bf16 v[96:111], a[248:251], a[152:155], v[96:111]
ds_read_b128 a[232:235], v14 offset:43008
ds_read_b128 a[236:239], v14 offset:44032
v_mfma_f32_32x32x16_bf16 v[32:47], a[252:255], a[156:159], v[32:47]
buffer_load_dwordx4 a[88:91], v8, s[4:7], s63 offen sc1
s_add_u32 s63, s71, 122880
s_waitcnt lgkmcnt(4)
v_mfma_f32_32x32x16_bf16 v[48:63], a[208:211], a[156:159], v[48:63]
ds_read_b128 a[240:243], v14 offset:45056
ds_read_b128 a[244:247], v14 offset:46080
v_mfma_f32_32x32x16_bf16 v[64:79], a[212:215], a[156:159], v[64:79]
buffer_load_dwordx4 a[108:111], v6, s[4:7], s63 offen offset:0 sc1
v_mfma_f32_32x32x16_bf16 v[80:95], a[216:219], a[156:159], v[80:95]
ds_read_b128 a[248:251], v14 offset:47104
ds_read_b128 a[252:255], v14 offset:48128
v_mfma_f32_32x32x16_bf16 v[96:111], a[220:223], a[156:159], v[96:111]
buffer_load_dwordx4 a[112:115], v6, s[4:7], s63 offen offset:1024 sc1
s_waitcnt vmcnt(10)
v_cmp_ne_u64 vcc, s[68:69], v[24:25]
s_nop 3
s_cbranch_vccnz Lp_h
Lr_h:
s_waitcnt lgkmcnt(4)
v_mfma_f32_32x32x16_bf16 v[32:47], a[224:227], a[160:163], v[32:47]
ds_read_b128 a[208:211], v14 offset:49152
ds_read_b128 a[212:215], v14 offset:50176
v_mfma_f32_32x32x16_bf16 v[48:63], a[228:231], a[160:163], v[48:63]
buffer_load_dwordx4 a[116:119], v6, s[4:7], s63 offen offset:2048 sc1
v_mfma_f32_32x32x16_bf16 v[64:79], a[232:235], a[160:163], v[64:79]
ds_read_b128 a[216:219], v14 offset:51200
ds_read_b128 a[220:223], v14 offset:52224
v_mfma_f32_32x32x16_bf16 v[80:95], a[236:239], a[160:163], v[80:95]
buffer_load_dwordx4 a[120:123], v6, s[4:7], s63 offen offset:3072 sc1
s_waitcnt lgkmcnt(4)
v_mfma_f32_32x32x16_bf16 v[96:111], a[240:243], a[160:163], v[96:111]
ds_read_b128 a[224:227], v14 offset:53248
ds_read_b128 a[228:231], v14 offset:54272
v_mfma_f32_32x32x16_bf16 v[32:47], a[244:247], a[164:167], v[32:47]
buffer_load_dwordx4 a[124:127], v8, s[4:7], s63 offen sc1
s_add_u32 s63, s80, 0
v_mfma_f32_32x32x16_bf16 v[48:63], a[248:251], a[164:167], v[48:63]
ds_read_b128 a[232:235], v14 offset:55296
ds_read_b128 a[236:239], v14 offset:56320
v_mfma_f32_32x32x16_bf16 v[64:79], a[252:255], a[164:167], v[64:79]
buffer_load_dwordx4 a[20:23], v17, s[4:7], s63 offen sc1
s_waitcnt lgkmcnt(4)
v_mfma_f32_32x32x16_bf16 v[80:95], a[208:211], a[164:167], v[80:95]
ds_read_b128 a[240:243], v14 offset:57344
ds_read_b128 a[244:247], v14 offset:58368
v_mfma_f32_32x32x16_bf16 v[96:111], a[212:215], a[164:167], v[96:111]
buffer_load_dwordx4 a[24:27], v18, s[4:7], s63 offen sc1
v_mfma_f32_32x32x16_bf16 v[32:47], a[216:219], a[168:171], v[32:47]
ds_read_b128 a[248:251], v14 offset:59392
ds_read_b128 a[252:255], v14 offset:60416
v_mfma_f32_32x32x16_bf16 v[48:63], a[220:223], a[168:171], v[48:63]
buffer_load_dwordx4 a[28:31], v19, s[4:7], s63 offen sc1
s_barrier
s_waitcnt lgkmcnt(4)
v_mfma_f32_32x32x16_bf16 v[64:79], a[224:227], a[168:171], v[64:79]
ds_read_b128 a[208:211], v15 offset:0
ds_read_b128 a[212:215], v15 offset:1024
v_mfma_f32_32x32x16_bf16 v[80:95], a[228:231], a[168:171], v[80:95]
buffer_load_dwordx4 a[32:35], v20, s[4:7], s63 offen sc1
s_add_u32 s63, s80, 2048
v_mfma_f32_32x32x16_bf16 v[96:111], a[232:235], a[168:171], v[96:111]
ds_read_b128 a[216:219], v15 offset:2048
ds_read_b128 a[220:223], v15 offset:3072
v_mfma_f32_32x32x16_bf16 v[32:47], a[236:239], a[172:175], v[32:47]
buffer_load_dwordx4 a[56:59], v17, s[4:7], s63 offen sc1
s_waitcnt lgkmcnt(4)
v_mfma_f32_32x32x16_bf16 v[48:63], a[240:243], a[172:175], v[48:63]
ds_read_b128 a[224:227], v15 offset:4096
ds_read_b128 a[228:231], v15 offset:5120
v_mfma_f32_32x32x16_bf16 v[64:79], a[244:247], a[172:175], v[64:79]
buffer_load_dwordx4 a[60:63], v18, s[4:7], s63 offen sc1
v_mfma_f32_32x32x16_bf16 v[80:95], a[248:251], a[172:175], v[80:95]
ds_read_b128 a[232:235], v15 offset:6144
ds_read_b128 a[236:239], v15 offset:7168
v_mfma_f32_32x32x16_bf16 v[96:111], a[252:255], a[172:175], v[96:111]
buffer_load_dwordx4 a[64:67], v19, s[4:7], s63 offen sc1
s_waitcnt lgkmcnt(4)
v_mfma_f32_32x32x16_bf16 v[32:47], a[208:211], a[176:179], v[32:47]
ds_read_b128 a[240:243], v15 offset:8192
ds_read_b128 a[244:247], v15 offset:9216
s_mul_i32 s56, s36, 10240
s_add_u32 s56, s56, 61440
s_lshr_b32 s57, s65, 1
v_add_u32 v218, s56, v12
v_add_u32 v219, s56, v13
v_mfma_f32_32x32x16_bf16 v[48:63], a[212:215], a[176:179], v[48:63]
buffer_load_dwordx4 a[68:71], v20, s[4:7], s63 offen sc1
s_add_u32 s63, s70, 4096
s_lshl_b32 s57, s57, 2
s_add_u32 s57, s57, s36
s_mul_i32 s57, s57, 5120
s_and_b32 s58, s65, 1
v_mfma_f32_32x32x16_bf16 v[64:79], a[216:219], a[176:179], v[64:79]
ds_read_b128 a[248:251], v15 offset:10240
ds_read_b128 a[252:255], v15 offset:11264
s_mul_i32 s58, s58, 2560
s_add_u32 s57, s57, s58
s_add_u32 s57, s57, 61440
v_add_u32 v220, s57, v5
v_add_u32 v221, s57, v1
v_mfma_f32_32x32x16_bf16 v[80:95], a[220:223], a[176:179], v[80:95]
buffer_load_dwordx4 a[92:95], v17, s[4:7], s63 offen sc1
s_add_u32 s56, s36, 1
s_and_b32 s56, s56, 3
s_mul_i32 s56, s56, 15360
s_add_u32 s56, s56, 102400
s_waitcnt lgkmcnt(4)
v_mfma_f32_32x32x16_bf16 v[96:111], a[224:227], a[176:179], v[96:111]
ds_read_b128 a[208:211], v15 offset:12288
ds_read_b128 a[212:215], v15 offset:13312
v_add_u32 v222, s56, v5
s_add_u32 s56, s36, 2
s_and_b32 s56, s56, 3
s_mul_i32 s56, s56, 15360
s_add_u32 s56, s56, 107520
v_mfma_f32_32x32x16_bf16 v[32:47], a[228:231], a[180:183], v[32:47]
buffer_load_dwordx4 a[96:99], v18, s[4:7], s63 offen sc1
v_add_u32 v223, s56, v5
s_add_u32 s56, s36, 3
s_and_b32 s56, s56, 3
s_mul_i32 s56, s56, 15360
s_add_u32 s56, s56, 112640
v_mfma_f32_32x32x16_bf16 v[48:63], a[232:235], a[180:183], v[48:63]
ds_read_b128 a[216:219], v15 offset:14336
ds_read_b128 a[220:223], v15 offset:15360
s_mov_b32 s50, s49
v_add_u32 v224, s56, v5
s_mul_i32 s56, s36, 15360
s_add_u32 s56, s56, 102400
v_add_u32 v4, s56, v5
v_mfma_f32_32x32x16_bf16 v[64:79], a[236:239], a[180:183], v[64:79]
buffer_load_dwordx4 a[100:103], v19, s[4:7], s63 offen sc1
s_waitcnt lgkmcnt(4)
v_mfma_f32_32x32x16_bf16 v[80:95], a[240:243], a[180:183], v[80:95]
ds_read_b128 a[224:227], v15 offset:16384
ds_read_b128 a[228:231], v15 offset:17408
v_mfma_f32_32x32x16_bf16 v[96:111], a[244:247], a[180:183], v[96:111]
buffer_load_dwordx4 a[104:107], v20, s[4:7], s63 offen sc1
s_add_u32 s63, s70, 6144
v_mfma_f32_32x32x16_bf16 v[32:47], a[248:251], a[184:187], v[32:47]
ds_read_b128 a[232:235], v15 offset:18432
ds_read_b128 a[236:239], v15 offset:19456
v_mfma_f32_32x32x16_bf16 v[48:63], a[252:255], a[184:187], v[48:63]
buffer_load_dwordx4 a[192:195], v17, s[4:7], s63 offen sc1
s_barrier
s_waitcnt lgkmcnt(4)
v_mfma_f32_32x32x16_bf16 v[64:79], a[208:211], a[184:187], v[64:79]
ds_read_b128 a[240:243], v5 offset:0
ds_read_b128 a[244:247], v5 offset:1024
v_mfma_f32_32x32x16_bf16 v[80:95], a[212:215], a[184:187], v[80:95]
buffer_load_dwordx4 a[196:199], v18, s[4:7], s63 offen sc1
v_mfma_f32_32x32x16_bf16 v[96:111], a[216:219], a[184:187], v[96:111]
ds_read_b128 a[248:251], v5 offset:2048
ds_read_b128 a[252:255], v5 offset:3072
v_mfma_f32_32x32x16_bf16 v[32:47], a[220:223], a[188:191], v[32:47]
buffer_load_dwordx4 a[200:203], v19, s[4:7], s63 offen sc1
s_waitcnt lgkmcnt(4)
v_mfma_f32_32x32x16_bf16 v[48:63], a[224:227], a[188:191], v[48:63]
ds_read_b128 a[208:211], v5 offset:4096
ds_read_b128 a[212:215], v5 offset:5120
v_mfma_f32_32x32x16_bf16 v[64:79], a[228:231], a[188:191], v[64:79]
buffer_load_dwordx4 a[204:207], v20, s[4:7], s63 offen sc1
v_mfma_f32_32x32x16_bf16 v[80:95], a[232:235], a[188:191], v[80:95]
ds_read_b128 a[216:219], v5 offset:6144
ds_read_b128 a[220:223], v5 offset:7168
v_mfma_f32_32x32x16_bf16 v[96:111], a[236:239], a[188:191], v[96:111]
buffer_load_dwordx2 v[208:209], v21, s[72:75], s64 offen offset:0
s_waitcnt lgkmcnt(4)
v_mfma_f32_32x32x16_bf16 v[32:47], a[240:243], v[112:115], v[32:47]
ds_read_b128 a[224:227], v5 offset:8192
ds_read_b128 a[228:231], v5 offset:9216
v_mfma_f32_32x32x16_bf16 v[48:63], a[244:247], v[112:115], v[48:63]
v_mfma_f32_32x32x16_bf16 v[64:79], a[248:251], v[112:115], v[64:79]
ds_read_b128 a[232:235], v5 offset:10240
ds_read_b128 a[236:239], v5 offset:11264
v_mfma_f32_32x32x16_bf16 v[80:95], a[252:255], v[112:115], v[80:95]
buffer_load_dwordx2 v[210:211], v21, s[72:75], s64 offen offset:32
s_waitcnt lgkmcnt(4)
v_mfma_f32_32x32x16_bf16 v[96:111], a[208:211], v[112:115], v[96:111]
ds_read_b128 a[240:243], v5 offset:12288
ds_read_b128 a[244:247], v5 offset:13312
v_mfma_f32_32x32x16_bf16 v[32:47], a[212:215], v[116:119], v[32:47]
v_mfma_f32_32x32x16_bf16 v[48:63], a[216:219], v[116:119], v[48:63]
buffer_load_dwordx2 v[212:213], v21, s[72:75], s64 offen offset:64
ds_read_b128 a[248:251], v5 offset:14336
v_mfma_f32_32x32x16_bf16 v[64:79], a[220:223], v[116:119], v[64:79]
ds_read_b128 a[252:255], v5 offset:15360
s_waitcnt lgkmcnt(4)
v_mfma_f32_32x32x16_bf16 v[80:95], a[224:227], v[116:119], v[80:95]
ds_read_b128 a[208:211], v5 offset:16384
ds_read_b128 a[212:215], v5 offset:17408
v_mfma_f32_32x32x16_bf16 v[96:111], a[228:231], v[116:119], v[96:111]
buffer_load_dwordx2 v[214:215], v21, s[72:75], s64 offen offset:96
v_mfma_f32_32x32x16_bf16 v[32:47], a[232:235], v[120:123], v[32:47]
ds_read_b128 a[216:219], v5 offset:18432
ds_read_b128 a[220:223], v5 offset:19456
v_mfma_f32_32x32x16_bf16 v[48:63], a[236:239], v[120:123], v[48:63]
s_barrier
s_waitcnt lgkmcnt(4)
v_mfma_f32_32x32x16_bf16 v[64:79], a[240:243], v[120:123], v[64:79]
buffer_load_dwordx2 v[216:217], v27, s[72:75], s64 offen
ds_read_b128 a[224:227], v5 offset:20480
v_mfma_f32_32x32x16_bf16 v[80:95], a[244:247], v[120:123], v[80:95]
ds_read_b128 a[228:231], v5 offset:25600
v_mfma_f32_32x32x16_bf16 v[96:111], a[248:251], v[120:123], v[96:111]
ds_read_b128 a[232:235], v5 offset:30720
ds_read_b128 a[236:239], v5 offset:35840
v_mfma_f32_32x32x16_bf16 v[32:47], a[252:255], v[124:127], v[32:47]
s_waitcnt lgkmcnt(4)
v_mfma_f32_32x32x16_bf16 v[48:63], a[208:211], v[124:127], v[48:63]
ds_read_b128 a[240:243], v5 offset:21504
ds_read_b128 a[244:247], v5 offset:26624
v_mfma_f32_32x32x16_bf16 v[64:79], a[212:215], v[124:127], v[64:79]
v_mfma_f32_32x32x16_bf16 v[80:95], a[216:219], v[124:127], v[80:95]
ds_read_b128 a[248:251], v5 offset:31744
ds_read_b128 a[252:255], v5 offset:36864
v_mfma_f32_32x32x16_bf16 v[96:111], a[220:223], v[124:127], v[96:111]
s_waitcnt vmcnt(30) lgkmcnt(4)
v_mfma_f32_32x32x16_bf16 v[32:47], a[224:227], a[128:131], v[32:47]
ds_read_b128 a[208:211], v5 offset:22528
ds_read_b128 a[212:215], v5 offset:27648
v_mfma_f32_32x32x16_bf16 v[32:47], a[228:231], a[132:135], v[32:47]
v_mfma_f32_32x32x16_bf16 v[32:47], a[232:235], a[136:139], v[32:47]
ds_read_b128 a[216:219], v5 offset:32768
ds_read_b128 a[220:223], v5 offset:37888
v_mfma_f32_32x32x16_bf16 v[32:47], a[236:239], a[140:143], v[32:47]
s_waitcnt lgkmcnt(4)
v_mfma_f32_32x32x16_bf16 v[48:63], a[240:243], a[128:131], v[48:63]
ds_read_b128 a[224:227], v5 offset:23552
ds_read_b128 a[228:231], v5 offset:28672
v_mfma_f32_32x32x16_bf16 v[48:63], a[244:247], a[132:135], v[48:63]
v_mfma_f32_32x32x16_bf16 v[48:63], a[248:251], a[136:139], v[48:63]
ds_read_b128 a[232:235], v5 offset:33792
ds_read_b128 a[236:239], v5 offset:38912
s_nop 3
v_cvt_pk_bf16_f32 v32, v32, v33
v_cvt_pk_bf16_f32 v33, v34, v35
v_cvt_pk_bf16_f32 v34, v40, v41
v_cvt_pk_bf16_f32 v35, v42, v43
v_mfma_f32_32x32x16_bf16 v[48:63], a[252:255], a[140:143], v[48:63]
buffer_store_dwordx4 v[32:35], v12, s[4:7], s82 offen offset:0 sc1
s_waitcnt lgkmcnt(4)
v_cvt_pk_bf16_f32 v36, v36, v37
v_cvt_pk_bf16_f32 v37, v38, v39
v_cvt_pk_bf16_f32 v38, v44, v45
v_mfma_f32_32x32x16_bf16 v[64:79], a[208:211], a[128:131], v[64:79]
ds_read_b128 a[240:243], v5 offset:24576
ds_read_b128 a[244:247], v5 offset:29696
v_mfma_f32_32x32x16_bf16 v[64:79], a[212:215], a[132:135], v[64:79]
v_mfma_f32_32x32x16_bf16 v[64:79], a[216:219], a[136:139], v[64:79]
ds_read_b128 a[248:251], v5 offset:34816
ds_read_b128 a[252:255], v5 offset:39936
v_cvt_pk_bf16_f32 v39, v46, v47
v_cvt_pk_bf16_f32 v48, v48, v49
v_cvt_pk_bf16_f32 v49, v50, v51
v_cvt_pk_bf16_f32 v50, v56, v57
v_mfma_f32_32x32x16_bf16 v[64:79], a[220:223], a[140:143], v[64:79]
buffer_store_dwordx4 v[36:39], v12, s[4:7], s82 offen offset:512 sc1
s_waitcnt lgkmcnt(4)
v_cvt_pk_bf16_f32 v51, v58, v59
v_cvt_pk_bf16_f32 v52, v52, v53
v_cvt_pk_bf16_f32 v53, v54, v55
v_mfma_f32_32x32x16_bf16 v[80:95], a[224:227], a[128:131], v[80:95]
buffer_store_dwordx4 v[48:51], v12, s[4:7], s82 offen offset:1024 sc1
v_mfma_f32_32x32x16_bf16 v[80:95], a[228:231], a[132:135], v[80:95]
v_mfma_f32_32x32x16_bf16 v[80:95], a[232:235], a[136:139], v[80:95]
v_cvt_pk_bf16_f32 v54, v60, v61
v_cvt_pk_bf16_f32 v55, v62, v63
s_nop 0
v_cvt_pk_bf16_f32 v64, v64, v65
v_cvt_pk_bf16_f32 v65, v66, v67
v_cvt_pk_bf16_f32 v68, v68, v69
v_cvt_pk_bf16_f32 v69, v70, v71
v_mfma_f32_32x32x16_bf16 v[80:95], a[236:239], a[140:143], v[80:95]
buffer_store_dwordx4 v[52:55], v12, s[4:7], s82 offen offset:1536 sc1
s_waitcnt lgkmcnt(0)
v_cvt_pk_bf16_f32 v72, v72, v73
v_cvt_pk_bf16_f32 v73, v74, v75
v_cvt_pk_bf16_f32 v76, v76, v77
v_mfma_f32_32x32x16_bf16 v[96:111], a[240:243], a[128:131], v[96:111]
buffer_store_dwordx2 v[64:65], v13, s[4:7], s82 offen offset:2048 sc1
v_mfma_f32_32x32x16_bf16 v[96:111], a[244:247], a[132:135], v[96:111]
v_mfma_f32_32x32x16_bf16 v[96:111], a[248:251], a[136:139], v[96:111]
buffer_store_dwordx2 v[68:69], v13, s[4:7], s82 offen offset:2304 sc1
v_cvt_pk_bf16_f32 v77, v78, v79
s_nop 0
v_cvt_pk_bf16_f32 v80, v80, v81
v_cvt_pk_bf16_f32 v81, v82, v83
v_cvt_pk_bf16_f32 v82, v88, v89
v_mfma_f32_32x32x16_bf16 v[96:111], a[252:255], a[140:143], v[96:111]
s_waitcnt vmcnt(23)
v_cvt_pk_bf16_f32 v83, v90, v91
v_cvt_pk_bf16_f32 v84, v84, v85
v_cvt_pk_bf16_f32 v85, v86, v87
v_cvt_pk_bf16_f32 v86, v92, v93
v_cvt_pk_bf16_f32 v87, v94, v95
v_mfma_f32_16x16x32_bf16 v[128:131], a[0:3], a[20:23], 0
buffer_store_dwordx2 v[72:73], v13, s[4:7], s100 offen offset:2048 sc1
v_mfma_f32_16x16x32_bf16 v[132:135], a[0:3], a[24:27], 0
buffer_store_dwordx2 v[76:77], v13, s[4:7], s100 offen offset:2304 sc1
v_mfma_f32_16x16x32_bf16 v[136:139], a[0:3], a[28:31], 0
buffer_store_dwordx4 v[80:83], v12, s[4:7], s100 offen offset:0 sc1
v_mfma_f32_16x16x32_bf16 v[140:143], a[0:3], a[32:35], 0
buffer_store_dwordx4 v[84:87], v12, s[4:7], s100 offen offset:512 sc1
v_mfma_f32_16x16x32_bf16 v[144:147], a[4:7], a[20:23], 0
v_cvt_pk_bf16_f32 v96, v96, v97
v_cvt_pk_bf16_f32 v97, v98, v99
v_mfma_f32_16x16x32_bf16 v[148:151], a[4:7], a[24:27], 0
v_cvt_pk_bf16_f32 v98, v104, v105
v_cvt_pk_bf16_f32 v99, v106, v107
v_mfma_f32_16x16x32_bf16 v[152:155], a[4:7], a[28:31], 0
buffer_store_dwordx4 v[96:99], v12, s[4:7], s100 offen offset:1024 sc1
v_mfma_f32_16x16x32_bf16 v[156:159], a[4:7], a[32:35], 0
v_cvt_pk_bf16_f32 v100, v100, v101
v_cvt_pk_bf16_f32 v101, v102, v103
v_mfma_f32_16x16x32_bf16 v[160:163], a[8:11], a[20:23], 0
v_cvt_pk_bf16_f32 v102, v108, v109
v_cvt_pk_bf16_f32 v103, v110, v111
v_mfma_f32_16x16x32_bf16 v[164:167], a[8:11], a[24:27], 0
buffer_store_dwordx4 v[100:103], v12, s[4:7], s100 offen offset:1536 sc1
v_mfma_f32_16x16x32_bf16 v[168:171], a[8:11], a[28:31], 0
v_mfma_f32_16x16x32_bf16 v[172:175], a[8:11], a[32:35], 0
v_mfma_f32_16x16x32_bf16 v[176:179], a[12:15], a[20:23], 0
v_mfma_f32_16x16x32_bf16 v[180:183], a[12:15], a[24:27], 0
v_mfma_f32_16x16x32_bf16 v[184:187], a[12:15], a[28:31], 0
v_mfma_f32_16x16x32_bf16 v[188:191], a[12:15], a[32:35], 0
v_mfma_f32_16x16x32_bf16 v[192:195], a[16:19], a[20:23], 0
v_mfma_f32_16x16x32_bf16 v[196:199], a[16:19], a[24:27], 0
v_mfma_f32_16x16x32_bf16 v[200:203], a[16:19], a[28:31], 0
v_mfma_f32_16x16x32_bf16 v[204:207], a[16:19], a[32:35], 0
ds_write_b128 v218, v[32:35] offset:0
ds_write_b128 v218, v[36:39] offset:512
ds_write_b128 v218, v[48:51] offset:1024
ds_write_b128 v218, v[52:55] offset:1536
ds_write_b64 v219, v[64:65] offset:2048
ds_write_b64 v219, v[68:69] offset:2304
ds_write_b64 v219, v[72:73] offset:4608
ds_write_b64 v219, v[76:77] offset:4864
ds_write_b128 v218, v[80:83] offset:2560
ds_write_b128 v218, v[84:87] offset:3072
ds_write_b128 v218, v[96:99] offset:3584
ds_write_b128 v218, v[100:103] offset:4096
s_cmp_ge_u32 s36, 2
s_cbranch_scc1 L1_skip
s_waitcnt vmcnt(25)
v_mfma_f32_16x16x32_bf16 v[128:131], a[36:39], a[56:59], v[128:131]
v_mfma_f32_16x16x32_bf16 v[132:135], a[36:39], a[60:63], v[132:135]
v_mfma_f32_16x16x32_bf16 v[136:139], a[36:39], a[64:67], v[136:139]
v_mfma_f32_16x16x32_bf16 v[140:143], a[36:39], a[68:71], v[140:143]
v_mfma_f32_16x16x32_bf16 v[144:147], a[40:43], a[56:59], v[144:147]
v_mfma_f32_16x16x32_bf16 v[148:151], a[40:43], a[60:63], v[148:151]
v_mfma_f32_16x16x32_bf16 v[152:155], a[40:43], a[64:67], v[152:155]
v_mfma_f32_16x16x32_bf16 v[156:159], a[40:43], a[68:71], v[156:159]
v_mfma_f32_16x16x32_bf16 v[160:163], a[44:47], a[56:59], v[160:163]
v_mfma_f32_16x16x32_bf16 v[164:167], a[44:47], a[60:63], v[164:167]
v_mfma_f32_16x16x32_bf16 v[168:171], a[44:47], a[64:67], v[168:171]
v_mfma_f32_16x16x32_bf16 v[172:175], a[44:47], a[68:71], v[172:175]
v_mfma_f32_16x16x32_bf16 v[176:179], a[48:51], a[56:59], v[176:179]
v_mfma_f32_16x16x32_bf16 v[180:183], a[48:51], a[60:63], v[180:183]
v_mfma_f32_16x16x32_bf16 v[184:187], a[48:51], a[64:67], v[184:187]
v_mfma_f32_16x16x32_bf16 v[188:191], a[48:51], a[68:71], v[188:191]
v_mfma_f32_16x16x32_bf16 v[192:195], a[52:55], a[56:59], v[192:195]
v_mfma_f32_16x16x32_bf16 v[196:199], a[52:55], a[60:63], v[196:199]
v_mfma_f32_16x16x32_bf16 v[200:203], a[52:55], a[64:67], v[200:203]
v_mfma_f32_16x16x32_bf16 v[204:207], a[52:55], a[68:71], v[204:207]
L1_skip:
s_waitcnt vmcnt(21)
v_mfma_f32_16x16x32_bf16 v[128:131], a[72:75], a[92:95], v[128:131]
s_add_u32 s63, s71, 163840
v_mfma_f32_16x16x32_bf16 v[132:135], a[72:75], a[96:99], v[132:135]
buffer_load_dwordx4 a[0:3], v6, s[4:7], s63 offen offset:0 sc1
v_mfma_f32_16x16x32_bf16 v[136:139], a[72:75], a[100:103], v[136:139]
buffer_load_dwordx4 a[4:7], v6, s[4:7], s63 offen offset:1024 sc1
v_mfma_f32_16x16x32_bf16 v[140:143], a[72:75], a[104:107], v[140:143]
buffer_load_dwordx4 a[8:11], v6, s[4:7], s63 offen offset:2048 sc1
v_mfma_f32_16x16x32_bf16 v[144:147], a[76:79], a[92:95], v[144:147]
buffer_load_dwordx4 a[12:15], v6, s[4:7], s63 offen offset:3072 sc1
v_mfma_f32_16x16x32_bf16 v[148:151], a[76:79], a[96:99], v[148:151]
buffer_load_dwordx4 a[16:19], v8, s[4:7], s63 offen sc1
v_mfma_f32_16x16x32_bf16 v[152:155], a[76:79], a[100:103], v[152:155]
s_add_u32 s63, s70, 8192
v_mfma_f32_16x16x32_bf16 v[156:159], a[76:79], a[104:107], v[156:159]
buffer_load_dwordx4 a[20:23], v17, s[4:7], s63 offen sc1
v_mfma_f32_16x16x32_bf16 v[160:163], a[80:83], a[92:95], v[160:163]
buffer_load_dwordx4 a[24:27], v18, s[4:7], s63 offen sc1
v_mfma_f32_16x16x32_bf16 v[164:167], a[80:83], a[96:99], v[164:167]
buffer_load_dwordx4 a[28:31], v19, s[4:7], s63 offen sc1
v_mfma_f32_16x16x32_bf16 v[168:171], a[80:83], a[100:103], v[168:171]
buffer_load_dwordx4 a[32:35], v20, s[4:7], s63 offen sc1
v_mfma_f32_16x16x32_bf16 v[172:175], a[80:83], a[104:107], v[172:175]
s_add_u32 s63, s71, 204800
v_mfma_f32_16x16x32_bf16 v[176:179], a[84:87], a[92:95], v[176:179]
buffer_load_dwordx4 a[36:39], v6, s[4:7], s63 offen offset:0 sc1
v_mfma_f32_16x16x32_bf16 v[180:183], a[84:87], a[96:99], v[180:183]
buffer_load_dwordx4 a[40:43], v6, s[4:7], s63 offen offset:1024 sc1
v_mfma_f32_16x16x32_bf16 v[184:187], a[84:87], a[100:103], v[184:187]
buffer_load_dwordx4 a[44:47], v6, s[4:7], s63 offen offset:2048 sc1
v_mfma_f32_16x16x32_bf16 v[188:191], a[84:87], a[104:107], v[188:191]
buffer_load_dwordx4 a[48:51], v6, s[4:7], s63 offen offset:3072 sc1
v_mfma_f32_16x16x32_bf16 v[192:195], a[88:91], a[92:95], v[192:195]
buffer_load_dwordx4 a[52:55], v8, s[4:7], s63 offen sc1
v_mfma_f32_16x16x32_bf16 v[196:199], a[88:91], a[96:99], v[196:199]
s_add_u32 s63, s70, 10240
v_mfma_f32_16x16x32_bf16 v[200:203], a[88:91], a[100:103], v[200:203]
buffer_load_dwordx4 a[56:59], v17, s[4:7], s63 offen sc1
v_mfma_f32_16x16x32_bf16 v[204:207], a[88:91], a[104:107], v[204:207]
buffer_load_dwordx4 a[60:63], v18, s[4:7], s63 offen sc1
buffer_load_dwordx4 a[64:67], v19, s[4:7], s63 offen sc1
buffer_load_dwordx4 a[68:71], v20, s[4:7], s63 offen sc1
s_waitcnt vmcnt(18) lgkmcnt(0)
s_barrier
s_add_u32 s41, s84, 32768
buffer_store_dwordx2 v[10:11], v9, s[4:7], s41 offen sc1
v_mfma_f32_16x16x32_bf16 v[128:131], a[108:111], a[192:195], v[128:131]
s_add_u32 s63, s71, 245760
v_mfma_f32_16x16x32_bf16 v[132:135], a[108:111], a[196:199], v[132:135]
buffer_load_dwordx4 a[72:75], v6, s[4:7], s63 offen offset:0 sc1
v_mfma_f32_16x16x32_bf16 v[136:139], a[108:111], a[200:203], v[136:139]
buffer_load_dwordx4 a[76:79], v6, s[4:7], s63 offen offset:1024 sc1
v_mfma_f32_16x16x32_bf16 v[140:143], a[108:111], a[204:207], v[140:143]
buffer_load_dwordx4 a[80:83], v6, s[4:7], s63 offen offset:2048 sc1
v_mfma_f32_16x16x32_bf16 v[144:147], a[112:115], a[192:195], v[144:147]
buffer_load_dwordx4 a[84:87], v6, s[4:7], s63 offen offset:3072 sc1
v_mfma_f32_16x16x32_bf16 v[148:151], a[112:115], a[196:199], v[148:151]
buffer_load_dwordx4 a[88:91], v8, s[4:7], s63 offen sc1
v_mfma_f32_16x16x32_bf16 v[152:155], a[112:115], a[200:203], v[152:155]
s_add_u32 s63, s70, 12288
v_mfma_f32_16x16x32_bf16 v[156:159], a[112:115], a[204:207], v[156:159]
buffer_load_dwordx4 a[92:95], v17, s[4:7], s63 offen sc1
v_mfma_f32_16x16x32_bf16 v[160:163], a[116:119], a[192:195], v[160:163]
buffer_load_dwordx4 a[96:99], v18, s[4:7], s63 offen sc1
v_mfma_f32_16x16x32_bf16 v[164:167], a[116:119], a[196:199], v[164:167]
buffer_load_dwordx4 a[100:103], v19, s[4:7], s63 offen sc1
v_mfma_f32_16x16x32_bf16 v[168:171], a[116:119], a[200:203], v[168:171]
buffer_load_dwordx4 a[104:107], v20, s[4:7], s63 offen sc1
v_mfma_f32_16x16x32_bf16 v[172:175], a[116:119], a[204:207], v[172:175]
v_mfma_f32_16x16x32_bf16 v[176:179], a[120:123], a[192:195], v[176:179]
v_mfma_f32_16x16x32_bf16 v[180:183], a[120:123], a[196:199], v[180:183]
v_mfma_f32_16x16x32_bf16 v[184:187], a[120:123], a[200:203], v[184:187]
ds_read_b128 v[32:35], v220
v_mfma_f32_16x16x32_bf16 v[188:191], a[120:123], a[204:207], v[188:191]
ds_read_b128 v[36:39], v220 offset:1024
v_mfma_f32_16x16x32_bf16 v[192:195], a[124:127], a[192:195], v[192:195]
ds_read_b64 v[40:41], v221
v_mfma_f32_16x16x32_bf16 v[196:199], a[124:127], a[196:199], v[196:199]
v_mfma_f32_16x16x32_bf16 v[200:203], a[124:127], a[200:203], v[200:203]
v_mfma_f32_16x16x32_bf16 v[204:207], a[124:127], a[204:207], v[204:207]
s_waitcnt vmcnt(19)
v_mfma_f32_16x16x32_bf16 v[128:131], a[0:3], a[20:23], v[128:131]
s_add_u32 s63, s71, 286720
v_lshlrev_b32 v226, 16, v208
v_and_b32 v227, 0xffff0000, v208
v_mfma_f32_16x16x32_bf16 v[132:135], a[0:3], a[24:27], v[132:135]
buffer_load_dwordx4 a[108:111], v6, s[4:7], s63 offen offset:0 sc1
v_mfma_f32_16x16x32_bf16 v[136:139], a[0:3], a[28:31], v[136:139]
buffer_load_dwordx4 a[112:115], v6, s[4:7], s63 offen offset:1024 sc1
v_mfma_f32_16x16x32_bf16 v[140:143], a[0:3], a[32:35], v[140:143]
buffer_load_dwordx4 a[116:119], v6, s[4:7], s63 offen offset:2048 sc1
v_mfma_f32_16x16x32_bf16 v[144:147], a[4:7], a[20:23], v[144:147]
buffer_load_dwordx4 a[120:123], v6, s[4:7], s63 offen offset:3072 sc1
v_mfma_f32_16x16x32_bf16 v[148:151], a[4:7], a[24:27], v[148:151]
buffer_load_dwordx4 a[124:127], v8, s[4:7], s63 offen sc1
v_mfma_f32_16x16x32_bf16 v[152:155], a[4:7], a[28:31], v[152:155]
s_add_u32 s63, s70, 14336
v_lshlrev_b32 v228, 16, v209
v_and_b32 v229, 0xffff0000, v209
v_mfma_f32_16x16x32_bf16 v[156:159], a[4:7], a[32:35], v[156:159]
buffer_load_dwordx4 a[192:195], v17, s[4:7], s63 offen sc1
v_mfma_f32_16x16x32_bf16 v[160:163], a[8:11], a[20:23], v[160:163]
buffer_load_dwordx4 a[196:199], v18, s[4:7], s63 offen sc1
v_mfma_f32_16x16x32_bf16 v[164:167], a[8:11], a[24:27], v[164:167]
buffer_load_dwordx4 a[200:203], v19, s[4:7], s63 offen sc1
v_mfma_f32_16x16x32_bf16 v[168:171], a[8:11], a[28:31], v[168:171]
buffer_load_dwordx4 a[204:207], v20, s[4:7], s63 offen sc1
v_mfma_f32_16x16x32_bf16 v[172:175], a[8:11], a[32:35], v[172:175]
v_lshlrev_b32 v230, 16, v210
v_and_b32 v231, 0xffff0000, v210
v_mfma_f32_16x16x32_bf16 v[176:179], a[12:15], a[20:23], v[176:179]
v_lshlrev_b32 v232, 16, v211
v_and_b32 v233, 0xffff0000, v211
v_mfma_f32_16x16x32_bf16 v[180:183], a[12:15], a[24:27], v[180:183]
v_lshlrev_b32 v234, 16, v212
v_and_b32 v235, 0xffff0000, v212
v_mfma_f32_16x16x32_bf16 v[184:187], a[12:15], a[28:31], v[184:187]
v_lshlrev_b32 v236, 16, v213
v_and_b32 v237, 0xffff0000, v213
v_mfma_f32_16x16x32_bf16 v[188:191], a[12:15], a[32:35], v[188:191]
v_lshlrev_b32 v238, 16, v214
v_and_b32 v239, 0xffff0000, v214
v_mfma_f32_16x16x32_bf16 v[192:195], a[16:19], a[20:23], v[192:195]
v_lshlrev_b32 v240, 16, v215
v_and_b32 v241, 0xffff0000, v215
v_mfma_f32_16x16x32_bf16 v[196:199], a[16:19], a[24:27], v[196:199]
v_lshlrev_b32 v242, 16, v216
v_and_b32 v243, 0xffff0000, v216
v_mfma_f32_16x16x32_bf16 v[200:203], a[16:19], a[28:31], v[200:203]
v_lshlrev_b32 v244, 16, v217
v_and_b32 v245, 0xffff0000, v217
v_mfma_f32_16x16x32_bf16 v[204:207], a[16:19], a[32:35], v[204:207]
s_waitcnt vmcnt(19) lgkmcnt(2)
v_lshlrev_b32 v72, 16, v32
v_and_b32 v73, 0xffff0000, v32
v_mfma_f32_16x16x32_bf16 v[128:131], a[36:39], a[56:59], v[128:131]
s_add_u32 s63, s71, 327680
v_lshlrev_b32 v74, 16, v33
v_and_b32 v75, 0xffff0000, v33
v_mfma_f32_16x16x32_bf16 v[132:135], a[36:39], a[60:63], v[132:135]
buffer_load_dwordx4 a[0:3], v6, s[4:7], s63 offen offset:0 sc1
v_mfma_f32_16x16x32_bf16 v[136:139], a[36:39], a[64:67], v[136:139]
buffer_load_dwordx4 a[4:7], v6, s[4:7], s63 offen offset:1024 sc1
v_mfma_f32_16x16x32_bf16 v[140:143], a[36:39], a[68:71], v[140:143]
buffer_load_dwordx4 a[8:11], v6, s[4:7], s63 offen offset:2048 sc1
v_mfma_f32_16x16x32_bf16 v[144:147], a[40:43], a[56:59], v[144:147]
buffer_load_dwordx4 a[12:15], v6, s[4:7], s63 offen offset:3072 sc1
v_mfma_f32_16x16x32_bf16 v[148:151], a[40:43], a[60:63], v[148:151]
buffer_load_dwordx4 a[16:19], v8, s[4:7], s63 offen sc1
v_mfma_f32_16x16x32_bf16 v[152:155], a[40:43], a[64:67], v[152:155]
s_add_u32 s63, s70, 16384
v_lshlrev_b32 v76, 16, v34
v_and_b32 v77, 0xffff0000, v34
v_mfma_f32_16x16x32_bf16 v[156:159], a[40:43], a[68:71], v[156:159]
buffer_load_dwordx4 a[20:23], v17, s[4:7], s63 offen sc1
v_mfma_f32_16x16x32_bf16 v[160:163], a[44:47], a[56:59], v[160:163]
buffer_load_dwordx4 a[24:27], v18, s[4:7], s63 offen sc1
v_mfma_f32_16x16x32_bf16 v[164:167], a[44:47], a[60:63], v[164:167]
buffer_load_dwordx4 a[28:31], v19, s[4:7], s63 offen sc1
v_mfma_f32_16x16x32_bf16 v[168:171], a[44:47], a[64:67], v[168:171]
buffer_load_dwordx4 a[32:35], v20, s[4:7], s63 offen sc1
v_mfma_f32_16x16x32_bf16 v[172:175], a[44:47], a[68:71], v[172:175]
v_lshlrev_b32 v78, 16, v35
v_and_b32 v79, 0xffff0000, v35
v_mfma_f32_16x16x32_bf16 v[176:179], a[48:51], a[56:59], v[176:179]
s_waitcnt lgkmcnt(1)
v_lshlrev_b32 v80, 16, v36
v_and_b32 v81, 0xffff0000, v36
v_mfma_f32_16x16x32_bf16 v[180:183], a[48:51], a[60:63], v[180:183]
v_lshlrev_b32 v82, 16, v37
v_and_b32 v83, 0xffff0000, v37
v_mfma_f32_16x16x32_bf16 v[184:187], a[48:51], a[64:67], v[184:187]
v_lshlrev_b32 v84, 16, v38
v_and_b32 v85, 0xffff0000, v38
v_mfma_f32_16x16x32_bf16 v[188:191], a[48:51], a[68:71], v[188:191]
v_lshlrev_b32 v86, 16, v39
v_and_b32 v87, 0xffff0000, v39
v_mfma_f32_16x16x32_bf16 v[192:195], a[52:55], a[56:59], v[192:195]
s_waitcnt lgkmcnt(0)
v_lshlrev_b32 v88, 16, v40
v_and_b32 v89, 0xffff0000, v40
v_mfma_f32_16x16x32_bf16 v[196:199], a[52:55], a[60:63], v[196:199]
v_lshlrev_b32 v90, 16, v41
v_and_b32 v91, 0xffff0000, v41
v_mfma_f32_16x16x32_bf16 v[200:203], a[52:55], a[64:67], v[200:203]
v_mfma_f32_16x16x32_bf16 v[204:207], a[52:55], a[68:71], v[204:207]
s_waitcnt vmcnt(18)
v_mfma_f32_16x16x32_bf16 v[128:131], a[72:75], a[92:95], v[128:131]
s_add_u32 s63, s71, 368640
v_mfma_f32_16x16x32_bf16 v[132:135], a[72:75], a[96:99], v[132:135]
buffer_load_dwordx4 a[36:39], v6, s[4:7], s63 offen offset:0 sc1
v_mfma_f32_16x16x32_bf16 v[136:139], a[72:75], a[100:103], v[136:139]
buffer_load_dwordx4 a[40:43], v6, s[4:7], s63 offen offset:1024 sc1
v_mfma_f32_16x16x32_bf16 v[140:143], a[72:75], a[104:107], v[140:143]
buffer_load_dwordx4 a[44:47], v6, s[4:7], s63 offen offset:2048 sc1
v_mfma_f32_16x16x32_bf16 v[144:147], a[76:79], a[92:95], v[144:147]
buffer_load_dwordx4 a[48:51], v6, s[4:7], s63 offen offset:3072 sc1
v_mfma_f32_16x16x32_bf16 v[148:151], a[76:79], a[96:99], v[148:151]
buffer_load_dwordx4 a[52:55], v8, s[4:7], s63 offen sc1
v_mfma_f32_16x16x32_bf16 v[152:155], a[76:79], a[100:103], v[152:155]
s_add_u32 s63, s70, 18432
v_mfma_f32_16x16x32_bf16 v[156:159], a[76:79], a[104:107], v[156:159]
buffer_load_dwordx4 a[56:59], v17, s[4:7], s63 offen sc1
v_mfma_f32_16x16x32_bf16 v[160:163], a[80:83], a[92:95], v[160:163]
buffer_load_dwordx4 a[60:63], v18, s[4:7], s63 offen sc1
v_mfma_f32_16x16x32_bf16 v[164:167], a[80:83], a[96:99], v[164:167]
buffer_load_dwordx4 a[64:67], v19, s[4:7], s63 offen sc1
v_mfma_f32_16x16x32_bf16 v[168:171], a[80:83], a[100:103], v[168:171]
buffer_load_dwordx4 a[68:71], v20, s[4:7], s63 offen sc1
v_mfma_f32_16x16x32_bf16 v[172:175], a[80:83], a[104:107], v[172:175]
v_mfma_f32_16x16x32_bf16 v[176:179], a[84:87], a[92:95], v[176:179]
v_mfma_f32_16x16x32_bf16 v[180:183], a[84:87], a[96:99], v[180:183]
v_mfma_f32_16x16x32_bf16 v[184:187], a[84:87], a[100:103], v[184:187]
v_mfma_f32_16x16x32_bf16 v[188:191], a[84:87], a[104:107], v[188:191]
v_mfma_f32_16x16x32_bf16 v[192:195], a[88:91], a[92:95], v[192:195]
v_mfma_f32_16x16x32_bf16 v[196:199], a[88:91], a[96:99], v[196:199]
v_mfma_f32_16x16x32_bf16 v[200:203], a[88:91], a[100:103], v[200:203]
v_mfma_f32_16x16x32_bf16 v[204:207], a[88:91], a[104:107], v[204:207]
s_waitcnt vmcnt(18)
v_mfma_f32_16x16x32_bf16 v[128:131], a[108:111], a[192:195], v[128:131]
s_add_u32 s63, s71, 409600
v_mfma_f32_16x16x32_bf16 v[132:135], a[108:111], a[196:199], v[132:135]
buffer_load_dwordx4 a[72:75], v6, s[4:7], s63 offen offset:0 sc1
v_mfma_f32_16x16x32_bf16 v[136:139], a[108:111], a[200:203], v[136:139]
buffer_load_dwordx4 a[76:79], v6, s[4:7], s63 offen offset:1024 sc1
v_mfma_f32_16x16x32_bf16 v[140:143], a[108:111], a[204:207], v[140:143]
buffer_load_dwordx4 a[80:83], v6, s[4:7], s63 offen offset:2048 sc1
v_mfma_f32_16x16x32_bf16 v[144:147], a[112:115], a[192:195], v[144:147]
buffer_load_dwordx4 a[84:87], v6, s[4:7], s63 offen offset:3072 sc1
v_mfma_f32_16x16x32_bf16 v[148:151], a[112:115], a[196:199], v[148:151]
buffer_load_dwordx4 a[88:91], v8, s[4:7], s63 offen sc1
v_mfma_f32_16x16x32_bf16 v[152:155], a[112:115], a[200:203], v[152:155]
s_add_u32 s63, s70, 20480
v_mfma_f32_16x16x32_bf16 v[156:159], a[112:115], a[204:207], v[156:159]
buffer_load_dwordx4 a[92:95], v17, s[4:7], s63 offen sc1
v_mfma_f32_16x16x32_bf16 v[160:163], a[116:119], a[192:195], v[160:163]
buffer_load_dwordx4 a[96:99], v18, s[4:7], s63 offen sc1
v_mfma_f32_16x16x32_bf16 v[164:167], a[116:119], a[196:199], v[164:167]
buffer_load_dwordx4 a[100:103], v19, s[4:7], s63 offen sc1
v_mfma_f32_16x16x32_bf16 v[168:171], a[116:119], a[200:203], v[168:171]
buffer_load_dwordx4 a[104:107], v20, s[4:7], s63 offen sc1
v_mfma_f32_16x16x32_bf16 v[172:175], a[116:119], a[204:207], v[172:175]
buffer_load_dwordx2 v[24:25], v3, s[4:7], s87 offen sc1
v_mfma_f32_16x16x32_bf16 v[176:179], a[120:123], a[192:195], v[176:179]
v_mfma_f32_16x16x32_bf16 v[180:183], a[120:123], a[196:199], v[180:183]
v_mfma_f32_16x16x32_bf16 v[184:187], a[120:123], a[200:203], v[184:187]
v_mfma_f32_16x16x32_bf16 v[188:191], a[120:123], a[204:207], v[188:191]
v_mfma_f32_16x16x32_bf16 v[192:195], a[124:127], a[192:195], v[192:195]
v_mfma_f32_16x16x32_bf16 v[196:199], a[124:127], a[196:199], v[196:199]
v_mfma_f32_16x16x32_bf16 v[200:203], a[124:127], a[200:203], v[200:203]
v_mfma_f32_16x16x32_bf16 v[204:207], a[124:127], a[204:207], v[204:207]
s_waitcnt vmcnt(19)
v_mfma_f32_16x16x32_bf16 v[128:131], a[0:3], a[20:23], v[128:131]
s_add_u32 s63, s71, 450560
v_mfma_f32_16x16x32_bf16 v[132:135], a[0:3], a[24:27], v[132:135]
buffer_load_dwordx4 a[108:111], v6, s[4:7], s63 offen offset:0 sc1
v_mfma_f32_16x16x32_bf16 v[136:139], a[0:3], a[28:31], v[136:139]
buffer_load_dwordx4 a[112:115], v6, s[4:7], s63 offen offset:1024 sc1
v_mfma_f32_16x16x32_bf16 v[140:143], a[0:3], a[32:35], v[140:143]
buffer_load_dwordx4 a[116:119], v6, s[4:7], s63 offen offset:2048 sc1
v_mfma_f32_16x16x32_bf16 v[144:147], a[4:7], a[20:23], v[144:147]
buffer_load_dwordx4 a[120:123], v6, s[4:7], s63 offen offset:3072 sc1
v_mfma_f32_16x16x32_bf16 v[148:151], a[4:7], a[24:27], v[148:151]
buffer_load_dwordx4 a[124:127], v8, s[4:7], s63 offen sc1
v_mfma_f32_16x16x32_bf16 v[152:155], a[4:7], a[28:31], v[152:155]
s_add_u32 s63, s70, 22528
v_mfma_f32_16x16x32_bf16 v[156:159], a[4:7], a[32:35], v[156:159]
buffer_load_dwordx4 a[192:195], v17, s[4:7], s63 offen sc1
v_mfma_f32_16x16x32_bf16 v[160:163], a[8:11], a[20:23], v[160:163]
buffer_load_dwordx4 a[196:199], v18, s[4:7], s63 offen sc1
v_mfma_f32_16x16x32_bf16 v[164:167], a[8:11], a[24:27], v[164:167]
buffer_load_dwordx4 a[200:203], v19, s[4:7], s63 offen sc1
v_mfma_f32_16x16x32_bf16 v[168:171], a[8:11], a[28:31], v[168:171]
buffer_load_dwordx4 a[204:207], v20, s[4:7], s63 offen sc1
v_mfma_f32_16x16x32_bf16 v[172:175], a[8:11], a[32:35], v[172:175]
v_mfma_f32_16x16x32_bf16 v[176:179], a[12:15], a[20:23], v[176:179]
v_mfma_f32_16x16x32_bf16 v[180:183], a[12:15], a[24:27], v[180:183]
v_mfma_f32_16x16x32_bf16 v[184:187], a[12:15], a[28:31], v[184:187]
v_mfma_f32_16x16x32_bf16 v[188:191], a[12:15], a[32:35], v[188:191]
v_mfma_f32_16x16x32_bf16 v[192:195], a[16:19], a[20:23], v[192:195]
v_mfma_f32_16x16x32_bf16 v[196:199], a[16:19], a[24:27], v[196:199]
v_mfma_f32_16x16x32_bf16 v[200:203], a[16:19], a[28:31], v[200:203]
v_mfma_f32_16x16x32_bf16 v[204:207], a[16:19], a[32:35], v[204:207]
s_waitcnt vmcnt(9)
v_cmp_ne_u64 vcc, s[68:69], v[24:25]
s_nop 3
s_cbranch_vccnz Lp_p
Lr_p:
v_mfma_f32_16x16x32_bf16 v[128:131], a[36:39], a[56:59], v[128:131]
s_add_u32 s40, s65, 1
s_and_b32 s40, s40, 3
s_mul_i32 s40, s40, 40960
v_mfma_f32_16x16x32_bf16 v[132:135], a[36:39], a[60:63], v[132:135]
s_add_u32 s40, s40, s83
v_mfma_f32_16x16x32_bf16 v[136:139], a[36:39], a[64:67], v[136:139]
buffer_load_dwordx4 v[42:45], v5, s[4:7], s40 offen offset:0 sc1
v_mfma_f32_16x16x32_bf16 v[140:143], a[36:39], a[68:71], v[140:143]
buffer_load_dwordx4 v[46:49], v5, s[4:7], s40 offen offset:1024 sc1
v_mfma_f32_16x16x32_bf16 v[144:147], a[40:43], a[56:59], v[144:147]
buffer_load_dwordx2 v[50:51], v1, s[4:7], s40 offen sc1
v_mfma_f32_16x16x32_bf16 v[148:151], a[40:43], a[60:63], v[148:151]
s_add_u32 s40, s65, 2
s_and_b32 s40, s40, 3
s_mul_i32 s40, s40, 40960
v_mfma_f32_16x16x32_bf16 v[152:155], a[40:43], a[64:67], v[152:155]
s_add_u32 s40, s40, s83
v_mfma_f32_16x16x32_bf16 v[156:159], a[40:43], a[68:71], v[156:159]
buffer_load_dwordx4 v[52:55], v5, s[4:7], s40 offen offset:0 sc1
v_mfma_f32_16x16x32_bf16 v[160:163], a[44:47], a[56:59], v[160:163]
buffer_load_dwordx4 v[56:59], v5, s[4:7], s40 offen offset:1024 sc1
v_mfma_f32_16x16x32_bf16 v[164:167], a[44:47], a[60:63], v[164:167]
buffer_load_dwordx2 v[60:61], v1, s[4:7], s40 offen sc1
v_mfma_f32_16x16x32_bf16 v[168:171], a[44:47], a[64:67], v[168:171]
s_add_u32 s40, s65, 3
s_and_b32 s40, s40, 3
s_mul_i32 s40, s40, 40960
v_mfma_f32_16x16x32_bf16 v[172:175], a[44:47], a[68:71], v[172:175]
s_add_u32 s40, s40, s83
v_mfma_f32_16x16x32_bf16 v[176:179], a[48:51], a[56:59], v[176:179]
buffer_load_dwordx4 v[62:65], v5, s[4:7], s40 offen offset:0 sc1
v_mfma_f32_16x16x32_bf16 v[180:183], a[48:51], a[60:63], v[180:183]
buffer_load_dwordx4 v[66:69], v5, s[4:7], s40 offen offset:1024 sc1
v_mfma_f32_16x16x32_bf16 v[184:187], a[48:51], a[64:67], v[184:187]
buffer_load_dwordx2 v[70:71], v1, s[4:7], s40 offen sc1
v_mfma_f32_16x16x32_bf16 v[188:191], a[48:51], a[68:71], v[188:191]
s_add_u32 s63, s71, 491520
v_mfma_f32_16x16x32_bf16 v[192:195], a[52:55], a[56:59], v[192:195]
buffer_load_dwordx4 a[0:3], v6, s[4:7], s63 offen offset:0 sc1
v_mfma_f32_16x16x32_bf16 v[196:199], a[52:55], a[60:63], v[196:199]
buffer_load_dwordx4 a[4:7], v6, s[4:7], s63 offen offset:1024 sc1
v_mfma_f32_16x16x32_bf16 v[200:203], a[52:55], a[64:67], v[200:203]
buffer_load_dwordx4 a[8:11], v6, s[4:7], s63 offen offset:2048 sc1
v_mfma_f32_16x16x32_bf16 v[204:207], a[52:55], a[68:71], v[204:207]
buffer_load_dwordx4 a[12:15], v6, s[4:7], s63 offen offset:3072 sc1
buffer_load_dwordx4 a[16:19], v8, s[4:7], s63 offen sc1
s_add_u32 s63, s70, 24576
buffer_load_dwordx4 a[20:23], v17, s[4:7], s63 offen sc1
buffer_load_dwordx4 a[24:27], v18, s[4:7], s63 offen sc1
buffer_load_dwordx4 a[28:31], v19, s[4:7], s63 offen sc1
buffer_load_dwordx4 a[32:35], v20, s[4:7], s63 offen sc1
v_mfma_f32_16x16x32_bf16 v[128:131], a[72:75], a[92:95], v[128:131]
s_add_u32 s63, s71, 532480
v_mfma_f32_16x16x32_bf16 v[132:135], a[72:75], a[96:99], v[132:135]
buffer_load_dwordx4 a[36:39], v6, s[4:7], s63 offen offset:0 sc1
v_mfma_f32_16x16x32_bf16 v[136:139], a[72:75], a[100:103], v[136:139]
buffer_load_dwordx4 a[40:43], v6, s[4:7], s63 offen offset:1024 sc1
v_mfma_f32_16x16x32_bf16 v[140:143], a[72:75], a[104:107], v[140:143]
buffer_load_dwordx4 a[44:47], v6, s[4:7], s63 offen offset:2048 sc1
v_mfma_f32_16x16x32_bf16 v[144:147], a[76:79], a[92:95], v[144:147]
buffer_load_dwordx4 a[48:51], v6, s[4:7], s63 offen offset:3072 sc1
v_mfma_f32_16x16x32_bf16 v[148:151], a[76:79], a[96:99], v[148:151]
buffer_load_dwordx4 a[52:55], v8, s[4:7], s63 offen sc1
v_mfma_f32_16x16x32_bf16 v[152:155], a[76:79], a[100:103], v[152:155]
s_add_u32 s63, s70, 26624
v_mfma_f32_16x16x32_bf16 v[156:159], a[76:79], a[104:107], v[156:159]
buffer_load_dwordx4 a[56:59], v17, s[4:7], s63 offen sc1
v_mfma_f32_16x16x32_bf16 v[160:163], a[80:83], a[92:95], v[160:163]
buffer_load_dwordx4 a[60:63], v18, s[4:7], s63 offen sc1
v_mfma_f32_16x16x32_bf16 v[164:167], a[80:83], a[96:99], v[164:167]
buffer_load_dwordx4 a[64:67], v19, s[4:7], s63 offen sc1
v_mfma_f32_16x16x32_bf16 v[168:171], a[80:83], a[100:103], v[168:171]
buffer_load_dwordx4 a[68:71], v20, s[4:7], s63 offen sc1
v_mfma_f32_16x16x32_bf16 v[172:175], a[80:83], a[104:107], v[172:175]
v_mfma_f32_16x16x32_bf16 v[176:179], a[84:87], a[92:95], v[176:179]
v_mfma_f32_16x16x32_bf16 v[180:183], a[84:87], a[96:99], v[180:183]
v_mfma_f32_16x16x32_bf16 v[184:187], a[84:87], a[100:103], v[184:187]
v_mfma_f32_16x16x32_bf16 v[188:191], a[84:87], a[104:107], v[188:191]
v_mfma_f32_16x16x32_bf16 v[192:195], a[88:91], a[92:95], v[192:195]
v_mfma_f32_16x16x32_bf16 v[196:199], a[88:91], a[96:99], v[196:199]
v_mfma_f32_16x16x32_bf16 v[200:203], a[88:91], a[100:103], v[200:203]
v_mfma_f32_16x16x32_bf16 v[204:207], a[88:91], a[104:107], v[204:207]
s_waitcnt vmcnt(27)
v_mfma_f32_16x16x32_bf16 v[128:131], a[108:111], a[192:195], v[128:131]
s_waitcnt vmcnt(26)
v_lshlrev_b32 v92, 16, v42
v_and_b32 v93, 0xffff0000, v42
v_mfma_f32_16x16x32_bf16 v[132:135], a[108:111], a[196:199], v[132:135]
v_add_f32 v72, v72, v92
v_add_f32 v73, v73, v93
v_mfma_f32_16x16x32_bf16 v[136:139], a[108:111], a[200:203], v[136:139]
v_lshlrev_b32 v94, 16, v43
v_and_b32 v95, 0xffff0000, v43
v_mfma_f32_16x16x32_bf16 v[140:143], a[108:111], a[204:207], v[140:143]
v_add_f32 v74, v74, v94
v_add_f32 v75, v75, v95
v_mfma_f32_16x16x32_bf16 v[144:147], a[112:115], a[192:195], v[144:147]
v_lshlrev_b32 v96, 16, v44
v_and_b32 v97, 0xffff0000, v44
v_mfma_f32_16x16x32_bf16 v[148:151], a[112:115], a[196:199], v[148:151]
v_add_f32 v76, v76, v96
v_add_f32 v77, v77, v97
v_mfma_f32_16x16x32_bf16 v[152:155], a[112:115], a[200:203], v[152:155]
v_lshlrev_b32 v98, 16, v45
v_and_b32 v99, 0xffff0000, v45
v_mfma_f32_16x16x32_bf16 v[156:159], a[112:115], a[204:207], v[156:159]
v_add_f32 v78, v78, v98
v_add_f32 v79, v79, v99
v_mfma_f32_16x16x32_bf16 v[160:163], a[116:119], a[192:195], v[160:163]
s_waitcnt vmcnt(25)
v_lshlrev_b32 v100, 16, v46
v_and_b32 v101, 0xffff0000, v46
v_mfma_f32_16x16x32_bf16 v[164:167], a[116:119], a[196:199], v[164:167]
v_add_f32 v80, v80, v100
v_add_f32 v81, v81, v101
v_mfma_f32_16x16x32_bf16 v[168:171], a[116:119], a[200:203], v[168:171]
v_lshlrev_b32 v102, 16, v47
v_and_b32 v103, 0xffff0000, v47
v_mfma_f32_16x16x32_bf16 v[172:175], a[116:119], a[204:207], v[172:175]
v_add_f32 v82, v82, v102
v_add_f32 v83, v83, v103
v_mfma_f32_16x16x32_bf16 v[176:179], a[120:123], a[192:195], v[176:179]
v_lshlrev_b32 v104, 16, v48
v_and_b32 v105, 0xffff0000, v48
v_mfma_f32_16x16x32_bf16 v[180:183], a[120:123], a[196:199], v[180:183]
v_add_f32 v84, v84, v104
v_add_f32 v85, v85, v105
v_mfma_f32_16x16x32_bf16 v[184:187], a[120:123], a[200:203], v[184:187]
v_lshlrev_b32 v106, 16, v49
v_and_b32 v107, 0xffff0000, v49
v_mfma_f32_16x16x32_bf16 v[188:191], a[120:123], a[204:207], v[188:191]
v_add_f32 v86, v86, v106
v_add_f32 v87, v87, v107
v_mfma_f32_16x16x32_bf16 v[192:195], a[124:127], a[192:195], v[192:195]
s_waitcnt vmcnt(24)
v_lshlrev_b32 v108, 16, v50
v_and_b32 v109, 0xffff0000, v50
v_mfma_f32_16x16x32_bf16 v[196:199], a[124:127], a[196:199], v[196:199]
v_add_f32 v88, v88, v108
v_add_f32 v89, v89, v109
v_mfma_f32_16x16x32_bf16 v[200:203], a[124:127], a[200:203], v[200:203]
v_lshlrev_b32 v110, 16, v51
v_and_b32 v111, 0xffff0000, v51
v_mfma_f32_16x16x32_bf16 v[204:207], a[124:127], a[204:207], v[204:207]
s_waitcnt vmcnt(9)
v_add_f32 v90, v90, v110
v_add_f32 v91, v91, v111
v_mfma_f32_16x16x32_bf16 v[128:131], a[0:3], a[20:23], v[128:131]
v_lshlrev_b32 v92, 16, v52
v_and_b32 v93, 0xffff0000, v52
v_mfma_f32_16x16x32_bf16 v[132:135], a[0:3], a[24:27], v[132:135]
v_add_f32 v72, v72, v92
v_add_f32 v73, v73, v93
v_mfma_f32_16x16x32_bf16 v[136:139], a[0:3], a[28:31], v[136:139]
v_lshlrev_b32 v94, 16, v53
v_and_b32 v95, 0xffff0000, v53
v_mfma_f32_16x16x32_bf16 v[140:143], a[0:3], a[32:35], v[140:143]
v_add_f32 v74, v74, v94
v_add_f32 v75, v75, v95
v_mfma_f32_16x16x32_bf16 v[144:147], a[4:7], a[20:23], v[144:147]
v_lshlrev_b32 v96, 16, v54
v_and_b32 v97, 0xffff0000, v54
v_mfma_f32_16x16x32_bf16 v[148:151], a[4:7], a[24:27], v[148:151]
v_add_f32 v76, v76, v96
v_add_f32 v77, v77, v97
v_mfma_f32_16x16x32_bf16 v[152:155], a[4:7], a[28:31], v[152:155]
v_lshlrev_b32 v98, 16, v55
v_and_b32 v99, 0xffff0000, v55
v_mfma_f32_16x16x32_bf16 v[156:159], a[4:7], a[32:35], v[156:159]
v_add_f32 v78, v78, v98
v_add_f32 v79, v79, v99
v_mfma_f32_16x16x32_bf16 v[160:163], a[8:11], a[20:23], v[160:163]
v_lshlrev_b32 v100, 16, v56
v_and_b32 v101, 0xffff0000, v56
v_mfma_f32_16x16x32_bf16 v[164:167], a[8:11], a[24:27], v[164:167]
v_add_f32 v80, v80, v100
v_add_f32 v81, v81, v101
v_mfma_f32_16x16x32_bf16 v[168:171], a[8:11], a[28:31], v[168:171]
v_lshlrev_b32 v102, 16, v57
v_and_b32 v103, 0xffff0000, v57
v_mfma_f32_16x16x32_bf16 v[172:175], a[8:11], a[32:35], v[172:175]
v_add_f32 v82, v82, v102
v_add_f32 v83, v83, v103
v_mfma_f32_16x16x32_bf16 v[176:179], a[12:15], a[20:23], v[176:179]
v_lshlrev_b32 v104, 16, v58
v_and_b32 v105, 0xffff0000, v58
v_mfma_f32_16x16x32_bf16 v[180:183], a[12:15], a[24:27], v[180:183]
v_add_f32 v84, v84, v104
v_add_f32 v85, v85, v105
v_mfma_f32_16x16x32_bf16 v[184:187], a[12:15], a[28:31], v[184:187]
v_lshlrev_b32 v106, 16, v59
v_and_b32 v107, 0xffff0000, v59
v_mfma_f32_16x16x32_bf16 v[188:191], a[12:15], a[32:35], v[188:191]
v_add_f32 v86, v86, v106
v_add_f32 v87, v87, v107
v_mfma_f32_16x16x32_bf16 v[192:195], a[16:19], a[20:23], v[192:195]
v_lshlrev_b32 v108, 16, v60
v_and_b32 v109, 0xffff0000, v60
v_mfma_f32_16x16x32_bf16 v[196:199], a[16:19], a[24:27], v[196:199]
v_add_f32 v88, v88, v108
v_add_f32 v89, v89, v109
v_mfma_f32_16x16x32_bf16 v[200:203], a[16:19], a[28:31], v[200:203]
v_lshlrev_b32 v110, 16, v61
v_and_b32 v111, 0xffff0000, v61
v_mfma_f32_16x16x32_bf16 v[204:207], a[16:19], a[32:35], v[204:207]
s_waitcnt vmcnt(0)
v_add_f32 v90, v90, v110
v_add_f32 v91, v91, v111
v_mfma_f32_16x16x32_bf16 v[132:135], a[36:39], a[60:63], v[132:135]
v_lshlrev_b32 v92, 16, v62
v_and_b32 v93, 0xffff0000, v62
v_mfma_f32_16x16x32_bf16 v[148:151], a[40:43], a[60:63], v[148:151]
v_add_f32 v72, v72, v92
v_add_f32 v73, v73, v93
v_mfma_f32_16x16x32_bf16 v[164:167], a[44:47], a[60:63], v[164:167]
v_lshlrev_b32 v94, 16, v63
v_and_b32 v95, 0xffff0000, v63
v_mfma_f32_16x16x32_bf16 v[180:183], a[48:51], a[60:63], v[180:183]
v_add_f32 v74, v74, v94
v_add_f32 v75, v75, v95
v_mfma_f32_16x16x32_bf16 v[196:199], a[52:55], a[60:63], v[196:199]
v_lshlrev_b32 v96, 16, v64
v_and_b32 v97, 0xffff0000, v64
v_mfma_f32_16x16x32_bf16 v[136:139], a[36:39], a[64:67], v[136:139]
v_add_f32 v76, v76, v96
v_add_f32 v77, v77, v97
v_mfma_f32_16x16x32_bf16 v[152:155], a[40:43], a[64:67], v[152:155]
v_lshlrev_b32 v98, 16, v65
v_and_b32 v99, 0xffff0000, v65
v_mfma_f32_16x16x32_bf16 v[168:171], a[44:47], a[64:67], v[168:171]
ds_write_b128 v222, v[132:135] offset:0
v_add_f32 v78, v78, v98
v_mfma_f32_16x16x32_bf16 v[184:187], a[48:51], a[64:67], v[184:187]
ds_write_b128 v222, v[148:151] offset:1024
v_add_f32 v79, v79, v99
v_mfma_f32_16x16x32_bf16 v[200:203], a[52:55], a[64:67], v[200:203]
ds_write_b128 v222, v[164:167] offset:2048
v_lshlrev_b32 v100, 16, v66
v_mfma_f32_16x16x32_bf16 v[140:143], a[36:39], a[68:71], v[140:143]
ds_write_b128 v222, v[180:183] offset:3072
v_and_b32 v101, 0xffff0000, v66
v_mfma_f32_16x16x32_bf16 v[156:159], a[40:43], a[68:71], v[156:159]
ds_write_b128 v222, v[196:199] offset:4096
v_add_f32 v80, v80, v100
v_mfma_f32_16x16x32_bf16 v[172:175], a[44:47], a[68:71], v[172:175]
ds_write_b128 v223, v[136:139] offset:0
v_add_f32 v81, v81, v101
v_mfma_f32_16x16x32_bf16 v[188:191], a[48:51], a[68:71], v[188:191]
ds_write_b128 v223, v[152:155] offset:1024
v_lshlrev_b32 v102, 16, v67
v_mfma_f32_16x16x32_bf16 v[204:207], a[52:55], a[68:71], v[204:207]
ds_write_b128 v223, v[168:171] offset:2048
v_and_b32 v103, 0xffff0000, v67
v_mfma_f32_16x16x32_bf16 v[128:131], a[36:39], a[56:59], v[128:131]
ds_write_b128 v223, v[184:187] offset:3072
v_add_f32 v82, v82, v102
v_mfma_f32_16x16x32_bf16 v[144:147], a[40:43], a[56:59], v[144:147]
ds_write_b128 v223, v[200:203] offset:4096
v_add_f32 v83, v83, v103
v_mfma_f32_16x16x32_bf16 v[160:163], a[44:47], a[56:59], v[160:163]
ds_write_b128 v224, v[140:143] offset:0
v_lshlrev_b32 v104, 16, v68
v_mfma_f32_16x16x32_bf16 v[176:179], a[48:51], a[56:59], v[176:179]
ds_write_b128 v224, v[156:159] offset:1024
v_and_b32 v105, 0xffff0000, v68
v_mfma_f32_16x16x32_bf16 v[192:195], a[52:55], a[56:59], v[192:195]
ds_write_b128 v224, v[172:175] offset:2048
v_add_f32 v84, v84, v104
ds_write_b128 v224, v[188:191] offset:3072
ds_write_b128 v224, v[204:207] offset:4096
s_waitcnt lgkmcnt(0)
s_barrier
ds_read_b128 v[132:135], v4 offset:0
ds_read_b128 v[136:139], v4 offset:5120
ds_read_b128 v[140:143], v4 offset:10240
ds_read_b128 v[148:151], v4 offset:1024
ds_read_b128 v[152:155], v4 offset:6144
ds_read_b128 v[156:159], v4 offset:11264
ds_read_b128 v[164:167], v4 offset:2048
ds_read_b128 v[168:171], v4 offset:7168
ds_read_b128 v[172:175], v4 offset:12288
ds_read_b128 v[180:183], v4 offset:3072
ds_read_b128 v[184:187], v4 offset:8192
ds_read_b128 v[188:191], v4 offset:13312
ds_read_b128 v[196:199], v4 offset:4096
ds_read_b128 v[200:203], v4 offset:9216
ds_read_b128 v[204:207], v4 offset:14336
v_add_f32 v85, v85, v105
v_lshlrev_b32 v106, 16, v69
v_and_b32 v107, 0xffff0000, v69
v_add_f32 v86, v86, v106
v_add_f32 v87, v87, v107
v_lshlrev_b32 v108, 16, v70
v_and_b32 v109, 0xffff0000, v70
v_add_f32 v88, v88, v108
v_add_f32 v89, v89, v109
v_lshlrev_b32 v110, 16, v71
v_and_b32 v111, 0xffff0000, v71
v_add_f32 v90, v90, v110
v_add_f32 v91, v91, v111
s_waitcnt lgkmcnt(14)
v_pk_add_f32 v[128:129], v[128:129], v[132:133]
s_waitcnt lgkmcnt(12)
v_pk_add_f32 v[136:137], v[136:137], v[140:141]
v_pk_add_f32 v[130:131], v[130:131], v[134:135]
v_pk_add_f32 v[138:139], v[138:139], v[142:143]
v_pk_add_f32 v[128:129], v[128:129], v[136:137]
v_pk_add_f32 v[130:131], v[130:131], v[138:139]
v_pk_mul_f32 v[132:133], v[128:129], s[50:51] op_sel_hi:[1,0]
v_pk_mul_f32 v[134:135], v[130:131], s[50:51] op_sel_hi:[1,0]
v_exp_f32 v132, v132
v_exp_f32 v133, v133
v_exp_f32 v134, v134
v_exp_f32 v135, v135
v_pk_mul_f32 v[128:129], v[128:129], v[72:73]
v_pk_mul_f32 v[130:131], v[130:131], v[74:75]
v_pk_add_f32 v[132:133], v[132:133], 1.0 op_sel_hi:[1,0]
v_pk_add_f32 v[134:135], v[134:135], 1.0 op_sel_hi:[1,0]
v_rcp_f32 v132, v132
v_rcp_f32 v133, v133
v_rcp_f32 v134, v134
v_rcp_f32 v135, v135
v_pk_fma_f32 v[226:227], v[128:129], v[132:133], v[226:227]
v_pk_fma_f32 v[228:229], v[130:131], v[134:135], v[228:229]
v_cvt_pk_bf16_f32 v208, v226, v227
v_cvt_pk_bf16_f32 v209, v228, v229
buffer_store_dwordx2 v[208:209], v21, s[76:79], s64 offen offset:0 nt
s_waitcnt lgkmcnt(11)
v_pk_add_f32 v[144:145], v[144:145], v[148:149]
s_waitcnt lgkmcnt(9)
v_pk_add_f32 v[152:153], v[152:153], v[156:157]
v_pk_add_f32 v[146:147], v[146:147], v[150:151]
v_pk_add_f32 v[154:155], v[154:155], v[158:159]
v_pk_add_f32 v[144:145], v[144:145], v[152:153]
v_pk_add_f32 v[146:147], v[146:147], v[154:155]
v_pk_mul_f32 v[148:149], v[144:145], s[50:51] op_sel_hi:[1,0]
v_pk_mul_f32 v[150:151], v[146:147], s[50:51] op_sel_hi:[1,0]
v_exp_f32 v148, v148
v_exp_f32 v149, v149
v_exp_f32 v150, v150
v_exp_f32 v151, v151
v_pk_mul_f32 v[144:145], v[144:145], v[76:77]
v_pk_mul_f32 v[146:147], v[146:147], v[78:79]
v_pk_add_f32 v[148:149], v[148:149], 1.0 op_sel_hi:[1,0]
v_pk_add_f32 v[150:151], v[150:151], 1.0 op_sel_hi:[1,0]
v_rcp_f32 v148, v148
v_rcp_f32 v149, v149
v_rcp_f32 v150, v150
v_rcp_f32 v151, v151
v_pk_fma_f32 v[230:231], v[144:145], v[148:149], v[230:231]
v_pk_fma_f32 v[232:233], v[146:147], v[150:151], v[232:233]
v_cvt_pk_bf16_f32 v210, v230, v231
v_cvt_pk_bf16_f32 v211, v232, v233
buffer_store_dwordx2 v[210:211], v21, s[76:79], s64 offen offset:32 nt
s_waitcnt lgkmcnt(8)
v_pk_add_f32 v[160:161], v[160:161], v[164:165]
s_waitcnt lgkmcnt(6)
v_pk_add_f32 v[168:169], v[168:169], v[172:173]
v_pk_add_f32 v[162:163], v[162:163], v[166:167]
v_pk_add_f32 v[170:171], v[170:171], v[174:175]
v_pk_add_f32 v[160:161], v[160:161], v[168:169]
v_pk_add_f32 v[162:163], v[162:163], v[170:171]
v_pk_mul_f32 v[164:165], v[160:161], s[50:51] op_sel_hi:[1,0]
v_pk_mul_f32 v[166:167], v[162:163], s[50:51] op_sel_hi:[1,0]
v_exp_f32 v164, v164
v_exp_f32 v165, v165
v_exp_f32 v166, v166
v_exp_f32 v167, v167
v_pk_mul_f32 v[160:161], v[160:161], v[80:81]
v_pk_mul_f32 v[162:163], v[162:163], v[82:83]
v_pk_add_f32 v[164:165], v[164:165], 1.0 op_sel_hi:[1,0]
v_pk_add_f32 v[166:167], v[166:167], 1.0 op_sel_hi:[1,0]
v_rcp_f32 v164, v164
v_rcp_f32 v165, v165
v_rcp_f32 v166, v166
v_rcp_f32 v167, v167
v_pk_fma_f32 v[234:235], v[160:161], v[164:165], v[234:235]
v_pk_fma_f32 v[236:237], v[162:163], v[166:167], v[236:237]
v_cvt_pk_bf16_f32 v212, v234, v235
v_cvt_pk_bf16_f32 v213, v236, v237
buffer_store_dwordx2 v[212:213], v21, s[76:79], s64 offen offset:64 nt
s_waitcnt lgkmcnt(5)
v_pk_add_f32 v[176:177], v[176:177], v[180:181]
s_waitcnt lgkmcnt(3)
v_pk_add_f32 v[184:185], v[184:185], v[188:189]
v_pk_add_f32 v[178:179], v[178:179], v[182:183]
v_pk_add_f32 v[186:187], v[186:187], v[190:191]
v_pk_add_f32 v[176:177], v[176:177], v[184:185]
v_pk_add_f32 v[178:179], v[178:179], v[186:187]
v_pk_mul_f32 v[180:181], v[176:177], s[50:51] op_sel_hi:[1,0]
v_pk_mul_f32 v[182:183], v[178:179], s[50:51] op_sel_hi:[1,0]
v_exp_f32 v180, v180
v_exp_f32 v181, v181
v_exp_f32 v182, v182
v_exp_f32 v183, v183
v_pk_mul_f32 v[176:177], v[176:177], v[84:85]
v_pk_mul_f32 v[178:179], v[178:179], v[86:87]
v_pk_add_f32 v[180:181], v[180:181], 1.0 op_sel_hi:[1,0]
v_pk_add_f32 v[182:183], v[182:183], 1.0 op_sel_hi:[1,0]
v_rcp_f32 v180, v180
v_rcp_f32 v181, v181
v_rcp_f32 v182, v182
v_rcp_f32 v183, v183
v_pk_fma_f32 v[238:239], v[176:177], v[180:181], v[238:239]
v_pk_fma_f32 v[240:241], v[178:179], v[182:183], v[240:241]
v_cvt_pk_bf16_f32 v214, v238, v239
v_cvt_pk_bf16_f32 v215, v240, v241
buffer_store_dwordx2 v[214:215], v21, s[76:79], s64 offen offset:96 nt
s_waitcnt lgkmcnt(2)
v_pk_add_f32 v[192:193], v[192:193], v[196:197]
s_waitcnt lgkmcnt(0)
v_pk_add_f32 v[200:201], v[200:201], v[204:205]
v_pk_add_f32 v[194:195], v[194:195], v[198:199]
v_pk_add_f32 v[202:203], v[202:203], v[206:207]
v_pk_add_f32 v[192:193], v[192:193], v[200:201]
v_pk_add_f32 v[194:195], v[194:195], v[202:203]
v_pk_mul_f32 v[196:197], v[192:193], s[50:51] op_sel_hi:[1,0]
v_pk_mul_f32 v[198:199], v[194:195], s[50:51] op_sel_hi:[1,0]
v_exp_f32 v196, v196
v_exp_f32 v197, v197
v_exp_f32 v198, v198
v_exp_f32 v199, v199
v_pk_mul_f32 v[192:193], v[192:193], v[88:89]
v_pk_mul_f32 v[194:195], v[194:195], v[90:91]
v_pk_add_f32 v[196:197], v[196:197], 1.0 op_sel_hi:[1,0]
v_pk_add_f32 v[198:199], v[198:199], 1.0 op_sel_hi:[1,0]
v_rcp_f32 v196, v196
v_rcp_f32 v197, v197
v_rcp_f32 v198, v198
v_rcp_f32 v199, v199
v_pk_fma_f32 v[242:243], v[192:193], v[196:197], v[242:243]
v_pk_fma_f32 v[244:245], v[194:195], v[198:199], v[244:245]
v_cvt_pk_bf16_f32 v216, v242, v243
v_cvt_pk_bf16_f32 v217, v244, v245
buffer_store_dwordx2 v[216:217], v27, s[76:79], s64 offen nt
L1_end:
s_endpgm
L1_noffn:
s_mov_b32 s59, 60919808
v_lshlrev_b32 v30, 3, v0
buffer_load_dwordx2 v[24:25], v30, s[4:7], s59 offen sc1
v_pk_mul_f32 v[128:129], v[128:129], v[26:27] op_sel_hi:[1,0]
v_pk_mul_f32 v[130:131], v[130:131], v[26:27] op_sel_hi:[1,0]
v_pk_mul_f32 v[132:133], v[132:133], v[26:27] op_sel_hi:[1,0]
v_pk_mul_f32 v[134:135], v[134:135], v[26:27] op_sel_hi:[1,0]
v_pk_mul_f32 v[136:137], v[136:137], v[26:27] op_sel_hi:[1,0]
v_pk_mul_f32 v[138:139], v[138:139], v[26:27] op_sel_hi:[1,0]
v_pk_mul_f32 v[140:141], v[140:141], v[26:27] op_sel_hi:[1,0]
v_pk_mul_f32 v[142:143], v[142:143], v[26:27] op_sel_hi:[1,0]
v_cvt_pk_bf16_f32 v32, v128, v129
v_cvt_pk_bf16_f32 v33, v130, v131
v_cvt_pk_bf16_f32 v34, v132, v133
v_cvt_pk_bf16_f32 v35, v134, v135
v_cvt_pk_bf16_f32 v36, v136, v137
v_cvt_pk_bf16_f32 v37, v138, v139
v_cvt_pk_bf16_f32 v38, v140, v141
v_cvt_pk_bf16_f32 v39, v142, v143
s_add_u32 s41, s44, 0
buffer_store_dwordx4 v[32:35], v5, s[4:7], s41 offen offset:0 sc1
buffer_store_dwordx4 v[36:39], v5, s[4:7], s41 offen offset:1024 sc1
v_pk_mul_f32 v[144:145], v[144:145], v[26:27] op_sel_hi:[1,0]
v_pk_mul_f32 v[146:147], v[146:147], v[26:27] op_sel_hi:[1,0]
v_pk_mul_f32 v[148:149], v[148:149], v[26:27] op_sel_hi:[1,0]
v_pk_mul_f32 v[150:151], v[150:151], v[26:27] op_sel_hi:[1,0]
v_pk_mul_f32 v[152:153], v[152:153], v[26:27] op_sel_hi:[1,0]
v_pk_mul_f32 v[154:155], v[154:155], v[26:27] op_sel_hi:[1,0]
v_pk_mul_f32 v[156:157], v[156:157], v[26:27] op_sel_hi:[1,0]
v_pk_mul_f32 v[158:159], v[158:159], v[26:27] op_sel_hi:[1,0]
v_cvt_pk_bf16_f32 v40, v144, v145
v_cvt_pk_bf16_f32 v41, v146, v147
v_cvt_pk_bf16_f32 v42, v148, v149
v_cvt_pk_bf16_f32 v43, v150, v151
v_cvt_pk_bf16_f32 v44, v152, v153
v_cvt_pk_bf16_f32 v45, v154, v155
v_cvt_pk_bf16_f32 v46, v156, v157
v_cvt_pk_bf16_f32 v47, v158, v159
buffer_store_dwordx4 v[40:43], v5, s[4:7], s41 offen offset:2048 sc1
buffer_store_dwordx4 v[44:47], v5, s[4:7], s41 offen offset:3072 sc1
v_pk_mul_f32 v[160:161], v[160:161], v[26:27] op_sel_hi:[1,0]
v_pk_mul_f32 v[162:163], v[162:163], v[26:27] op_sel_hi:[1,0]
v_pk_mul_f32 v[164:165], v[164:165], v[26:27] op_sel_hi:[1,0]
v_pk_mul_f32 v[166:167], v[166:167], v[26:27] op_sel_hi:[1,0]
v_pk_mul_f32 v[168:169], v[168:169], v[26:27] op_sel_hi:[1,0]
v_pk_mul_f32 v[170:171], v[170:171], v[26:27] op_sel_hi:[1,0]
v_pk_mul_f32 v[172:173], v[172:173], v[26:27] op_sel_hi:[1,0]
v_pk_mul_f32 v[174:175], v[174:175], v[26:27] op_sel_hi:[1,0]
v_cvt_pk_bf16_f32 v48, v160, v161
v_cvt_pk_bf16_f32 v49, v162, v163
v_cvt_pk_bf16_f32 v50, v164, v165
v_cvt_pk_bf16_f32 v51, v166, v167
v_cvt_pk_bf16_f32 v52, v168, v169
v_cvt_pk_bf16_f32 v53, v170, v171
v_cvt_pk_bf16_f32 v54, v172, v173
v_cvt_pk_bf16_f32 v55, v174, v175
s_add_u32 s41, s44, 4096
buffer_store_dwordx4 v[48:51], v5, s[4:7], s41 offen offset:0 sc1
buffer_store_dwordx4 v[52:55], v5, s[4:7], s41 offen offset:1024 sc1
v_pk_mul_f32 v[176:177], v[176:177], v[26:27] op_sel_hi:[1,0]
v_pk_mul_f32 v[178:179], v[178:179], v[26:27] op_sel_hi:[1,0]
v_pk_mul_f32 v[180:181], v[180:181], v[26:27] op_sel_hi:[1,0]
v_pk_mul_f32 v[182:183], v[182:183], v[26:27] op_sel_hi:[1,0]
v_pk_mul_f32 v[184:185], v[184:185], v[26:27] op_sel_hi:[1,0]
v_pk_mul_f32 v[186:187], v[186:187], v[26:27] op_sel_hi:[1,0]
v_pk_mul_f32 v[188:189], v[188:189], v[26:27] op_sel_hi:[1,0]
v_pk_mul_f32 v[190:191], v[190:191], v[26:27] op_sel_hi:[1,0]
v_cvt_pk_bf16_f32 v56, v176, v177
v_cvt_pk_bf16_f32 v57, v178, v179
v_cvt_pk_bf16_f32 v58, v180, v181
v_cvt_pk_bf16_f32 v59, v182, v183
v_cvt_pk_bf16_f32 v60, v184, v185
v_cvt_pk_bf16_f32 v61, v186, v187
v_cvt_pk_bf16_f32 v62, v188, v189
v_cvt_pk_bf16_f32 v63, v190, v191
buffer_store_dwordx4 v[56:59], v5, s[4:7], s41 offen offset:2048 sc1
buffer_store_dwordx4 v[60:63], v5, s[4:7], s41 offen offset:3072 sc1
v_pk_mul_f32 v[192:193], v[192:193], v[28:29] op_sel_hi:[1,0]
v_pk_mul_f32 v[194:195], v[194:195], v[28:29] op_sel_hi:[1,0]
v_pk_mul_f32 v[196:197], v[196:197], v[28:29] op_sel_hi:[1,0]
v_pk_mul_f32 v[198:199], v[198:199], v[28:29] op_sel_hi:[1,0]
v_pk_mul_f32 v[200:201], v[200:201], v[28:29] op_sel_hi:[1,0]
v_pk_mul_f32 v[202:203], v[202:203], v[28:29] op_sel_hi:[1,0]
v_pk_mul_f32 v[204:205], v[204:205], v[28:29] op_sel_hi:[1,0]
v_pk_mul_f32 v[206:207], v[206:207], v[28:29] op_sel_hi:[1,0]
v_cvt_pk_bf16_f32 v64, v192, v193
v_cvt_pk_bf16_f32 v65, v194, v195
v_cvt_pk_bf16_f32 v66, v196, v197
v_cvt_pk_bf16_f32 v67, v198, v199
v_cvt_pk_bf16_f32 v68, v200, v201
v_cvt_pk_bf16_f32 v69, v202, v203
v_cvt_pk_bf16_f32 v70, v204, v205
v_cvt_pk_bf16_f32 v71, v206, v207
s_add_u32 s41, s44, 266496
buffer_store_dwordx4 v[64:67], v5, s[4:7], s41 offen offset:0 sc1
buffer_store_dwordx4 v[68:71], v5, s[4:7], s41 offen offset:1024 sc1
v_pk_mul_f32 v[208:209], v[208:209], v[28:29] op_sel_hi:[1,0]
v_pk_mul_f32 v[210:211], v[210:211], v[28:29] op_sel_hi:[1,0]
v_pk_mul_f32 v[212:213], v[212:213], v[28:29] op_sel_hi:[1,0]
v_pk_mul_f32 v[214:215], v[214:215], v[28:29] op_sel_hi:[1,0]
v_pk_mul_f32 v[216:217], v[216:217], v[28:29] op_sel_hi:[1,0]
v_pk_mul_f32 v[218:219], v[218:219], v[28:29] op_sel_hi:[1,0]
v_pk_mul_f32 v[220:221], v[220:221], v[28:29] op_sel_hi:[1,0]
v_pk_mul_f32 v[222:223], v[222:223], v[28:29] op_sel_hi:[1,0]
v_cvt_pk_bf16_f32 v72, v208, v209
v_cvt_pk_bf16_f32 v73, v210, v211
v_cvt_pk_bf16_f32 v74, v212, v213
v_cvt_pk_bf16_f32 v75, v214, v215
v_cvt_pk_bf16_f32 v76, v216, v217
v_cvt_pk_bf16_f32 v77, v218, v219
v_cvt_pk_bf16_f32 v78, v220, v221
v_cvt_pk_bf16_f32 v79, v222, v223
buffer_store_dwordx4 v[72:75], v5, s[4:7], s41 offen offset:2048 sc1
buffer_store_dwordx4 v[76:79], v5, s[4:7], s41 offen offset:3072 sc1
v_pk_mul_f32 v[224:225], v[224:225], v[28:29] op_sel_hi:[1,0]
v_pk_mul_f32 v[226:227], v[226:227], v[28:29] op_sel_hi:[1,0]
v_pk_mul_f32 v[228:229], v[228:229], v[28:29] op_sel_hi:[1,0]
v_pk_mul_f32 v[230:231], v[230:231], v[28:29] op_sel_hi:[1,0]
v_pk_mul_f32 v[232:233], v[232:233], v[28:29] op_sel_hi:[1,0]
v_pk_mul_f32 v[234:235], v[234:235], v[28:29] op_sel_hi:[1,0]
v_pk_mul_f32 v[236:237], v[236:237], v[28:29] op_sel_hi:[1,0]
v_pk_mul_f32 v[238:239], v[238:239], v[28:29] op_sel_hi:[1,0]
v_cvt_pk_bf16_f32 v80, v224, v225
v_cvt_pk_bf16_f32 v81, v226, v227
v_cvt_pk_bf16_f32 v82, v228, v229
v_cvt_pk_bf16_f32 v83, v230, v231
v_cvt_pk_bf16_f32 v84, v232, v233
v_cvt_pk_bf16_f32 v85, v234, v235
v_cvt_pk_bf16_f32 v86, v236, v237
v_cvt_pk_bf16_f32 v87, v238, v239
s_add_u32 s41, s44, 270592
buffer_store_dwordx4 v[80:83], v5, s[4:7], s41 offen offset:0 sc1
buffer_store_dwordx4 v[84:87], v5, s[4:7], s41 offen offset:1024 sc1
v_pk_mul_f32 v[240:241], v[240:241], v[28:29] op_sel_hi:[1,0]
v_pk_mul_f32 v[242:243], v[242:243], v[28:29] op_sel_hi:[1,0]
v_pk_mul_f32 v[244:245], v[244:245], v[28:29] op_sel_hi:[1,0]
v_pk_mul_f32 v[246:247], v[246:247], v[28:29] op_sel_hi:[1,0]
v_pk_mul_f32 v[248:249], v[248:249], v[28:29] op_sel_hi:[1,0]
v_pk_mul_f32 v[250:251], v[250:251], v[28:29] op_sel_hi:[1,0]
v_pk_mul_f32 v[252:253], v[252:253], v[28:29] op_sel_hi:[1,0]
v_pk_mul_f32 v[254:255], v[254:255], v[28:29] op_sel_hi:[1,0]
v_cvt_pk_bf16_f32 v88, v240, v241
v_cvt_pk_bf16_f32 v89, v242, v243
v_cvt_pk_bf16_f32 v90, v244, v245
v_cvt_pk_bf16_f32 v91, v246, v247
v_cvt_pk_bf16_f32 v92, v248, v249
v_cvt_pk_bf16_f32 v93, v250, v251
v_cvt_pk_bf16_f32 v94, v252, v253
v_cvt_pk_bf16_f32 v95, v254, v255
buffer_store_dwordx4 v[88:91], v5, s[4:7], s41 offen offset:2048 sc1
buffer_store_dwordx4 v[92:95], v5, s[4:7], s41 offen offset:3072 sc1
s_waitcnt vmcnt(16)
v_cmp_ne_u64 vcc, s[68:69], v[24:25]
s_nop 3
s_cbranch_vccnz Lp_gN
Lr_gN:
s_waitcnt vmcnt(0) lgkmcnt(0)
s_barrier
s_add_u32 s41, s84, 0
buffer_store_dwordx2 v[10:11], v9, s[4:7], s41 offen sc1
s_add_u32 m0, s54, 143360
s_add_u32 s39, s67, 0
buffer_load_dwordx4 v5, s[4:7], s39 offen offset:0  sc1 lds
buffer_load_dwordx4 v5, s[4:7], s39 offen offset:1024  sc1 lds
buffer_load_dwordx4 v5, s[4:7], s39 offen offset:2048  sc1 lds
buffer_load_dwordx4 v5, s[4:7], s39 offen offset:3072  sc1 lds
s_add_u32 m0, s54, 147456
s_nop 0
buffer_load_dwordx4 v16, s[4:7], s39 offen  sc1 lds
s_add_u32 m0, s54, 40960
s_add_u32 s38, s67, 81920
buffer_load_dwordx4 v5, s[4:7], s38 offen offset:0  sc1 lds
buffer_load_dwordx4 v5, s[4:7], s38 offen offset:1024  sc1 lds
buffer_load_dwordx4 v5, s[4:7], s38 offen offset:2048  sc1 lds
buffer_load_dwordx4 v5, s[4:7], s38 offen offset:3072  sc1 lds
s_add_u32 m0, s54, 45056
s_nop 0
buffer_load_dwordx4 v16, s[4:7], s38 offen  sc1 lds
s_add_u32 m0, s54, 61440
s_add_u32 s39, s67, 163840
buffer_load_dwordx4 v5, s[4:7], s39 offen offset:0  sc1 lds
buffer_load_dwordx4 v5, s[4:7], s39 offen offset:1024  sc1 lds
buffer_load_dwordx4 v5, s[4:7], s39 offen offset:2048  sc1 lds
buffer_load_dwordx4 v5, s[4:7], s39 offen offset:3072  sc1 lds
s_add_u32 m0, s54, 65536
s_nop 0
buffer_load_dwordx4 v16, s[4:7], s39 offen  sc1 lds
s_add_u32 m0, s54, 81920
s_add_u32 s38, s67, 245760
buffer_load_dwordx4 v5, s[4:7], s38 offen offset:0  sc1 lds
buffer_load_dwordx4 v5, s[4:7], s38 offen offset:1024  sc1 lds
buffer_load_dwordx4 v5, s[4:7], s38 offen offset:2048  sc1 lds
buffer_load_dwordx4 v5, s[4:7], s38 offen offset:3072  sc1 lds
s_add_u32 m0, s54, 86016
s_nop 0
buffer_load_dwordx4 v16, s[4:7], s38 offen  sc1 lds
s_add_u32 m0, s54, 102400
s_add_u32 s39, s67, 327680
buffer_load_dwordx4 v5, s[4:7], s39 offen offset:0  sc1 lds
buffer_load_dwordx4 v5, s[4:7], s39 offen offset:1024  sc1 lds
buffer_load_dwordx4 v5, s[4:7], s39 offen offset:2048  sc1 lds
buffer_load_dwordx4 v5, s[4:7], s39 offen offset:3072  sc1 lds
s_add_u32 m0, s54, 106496
s_nop 0
buffer_load_dwordx4 v16, s[4:7], s39 offen  sc1 lds
s_add_u32 m0, s54, 122880
s_add_u32 s38, s67, 409600
buffer_load_dwordx4 v5, s[4:7], s38 offen offset:0  sc1 lds
buffer_load_dwordx4 v5, s[4:7], s38 offen offset:1024  sc1 lds
buffer_load_dwordx4 v5, s[4:7], s38 offen offset:2048  sc1 lds
buffer_load_dwordx4 v5, s[4:7], s38 offen offset:3072  sc1 lds
s_add_u32 m0, s54, 126976
s_nop 0
buffer_load_dwordx4 v16, s[4:7], s38 offen  sc1 lds
s_cmp_lg_u32 s36, 0
s_cbranch_scc1 LoN_skip
buffer_load_dwordx2 v[24:25], v22, s[4:7], s85 offen sc1
s_waitcnt vmcnt(0)
v_cmp_ne_u64 vcc, s[68:69], v[24:25]
s_nop 3
s_cbranch_vccnz Lp_oN
Lr_oN:
LoN_skip:
s_barrier
s_add_u32 s40, s66, 0
buffer_load_dwordx4 a[128:131], v5, s[4:7], s40 offen offset:0  sc1
buffer_load_dwordx4 a[132:135], v5, s[4:7], s40 offen offset:1024  sc1
buffer_load_dwordx4 a[136:139], v5, s[4:7], s40 offen offset:2048  sc1
buffer_load_dwordx4 a[140:143], v5, s[4:7], s40 offen offset:3072  sc1
s_add_u32 s40, s66, 4096
buffer_load_dwordx4 a[144:147], v5, s[4:7], s40 offen offset:0  sc1
buffer_load_dwordx4 a[148:151], v5, s[4:7], s40 offen offset:1024  sc1
buffer_load_dwordx4 a[152:155], v5, s[4:7], s40 offen offset:2048  sc1
buffer_load_dwordx4 a[156:159], v5, s[4:7], s40 offen offset:3072  sc1
s_add_u32 s40, s66, 8192
buffer_load_dwordx4 a[160:163], v5, s[4:7], s40 offen offset:0  sc1
buffer_load_dwordx4 a[164:167], v5, s[4:7], s40 offen offset:1024  sc1
buffer_load_dwordx4 a[168:171], v5, s[4:7], s40 offen offset:2048  sc1
buffer_load_dwordx4 a[172:175], v5, s[4:7], s40 offen offset:3072  sc1
s_add_u32 s40, s66, 12288
buffer_load_dwordx4 a[176:179], v5, s[4:7], s40 offen offset:0  sc1
buffer_load_dwordx4 a[180:183], v5, s[4:7], s40 offen offset:1024  sc1
buffer_load_dwordx4 a[184:187], v5, s[4:7], s40 offen offset:2048  sc1
buffer_load_dwordx4 a[188:191], v5, s[4:7], s40 offen offset:3072  sc1
s_add_u32 s40, s66, 16384
buffer_load_dwordx4 v[112:115], v5, s[4:7], s40 offen offset:0  sc1
buffer_load_dwordx4 v[116:119], v5, s[4:7], s40 offen offset:1024  sc1
buffer_load_dwordx4 v[120:123], v5, s[4:7], s40 offen offset:2048  sc1
buffer_load_dwordx4 v[124:127], v5, s[4:7], s40 offen offset:3072  sc1
s_waitcnt vmcnt(45)
s_barrier
ds_read_b128 a[224:227], v15 offset:20480
ds_read_b128 a[228:231], v15 offset:21504
ds_read_b128 a[232:235], v15 offset:22528
ds_read_b128 a[236:239], v15 offset:23552
ds_read_b128 a[240:243], v15 offset:24576
ds_read_b128 a[244:247], v15 offset:25600
ds_read_b128 a[248:251], v15 offset:26624
ds_read_b128 a[252:255], v15 offset:27648
s_branch L1_spart
Lfb:
s_waitcnt vmcnt(0) lgkmcnt(0)
v_and_b32 v29, 31, v0
v_bfe_u32 v30, v0, 5, 1
v_lshlrev_b32 v30, 4, v30
v_lshl_add_u32 v14, v29, 8, v30
v_subrev_u32 v15, s37, v13
v_and_b32 v17, 0xffff, v22
v_add_u32 v17, s52, v17
v_and_b32 v18, 0xffff, v23
v_add_u32 v18, s52, v18
v_and_b32 v19, 0xffff, v24
v_add_u32 v19, s52, v19
v_and_b32 v20, 0xffff, v25
v_add_u32 v20, s52, v20
v_mov_b32 v32, 0xff800000
v_mov_b32 v33, 0xff800000
v_mov_b32 v26, 0
v_mov_b32 v48, 0xff800000
v_mov_b32 v49, 0xff800000
v_mov_b32 v28, 0
v_mov_b32 v128, 0
v_mov_b32 v129, 0
v_mov_b32 v130, 0
v_mov_b32 v131, 0
v_mov_b32 v132, 0
v_mov_b32 v133, 0
v_mov_b32 v134, 0
v_mov_b32 v135, 0
v_mov_b32 v136, 0
v_mov_b32 v137, 0
v_mov_b32 v138, 0
v_mov_b32 v139, 0
v_mov_b32 v140, 0
v_mov_b32 v141, 0
v_mov_b32 v142, 0
v_mov_b32 v143, 0
v_mov_b32 v144, 0
v_mov_b32 v145, 0
v_mov_b32 v146, 0
v_mov_b32 v147, 0
v_mov_b32 v148, 0
v_mov_b32 v149, 0
v_mov_b32 v150, 0
v_mov_b32 v151, 0
v_mov_b32 v152, 0
v_mov_b32 v153, 0
v_mov_b32 v154, 0
v_mov_b32 v155, 0
v_mov_b32 v156, 0
v_mov_b32 v157, 0
v_mov_b32 v158, 0
v_mov_b32 v159, 0
v_mov_b32 v160, 0
v_mov_b32 v161, 0
v_mov_b32 v162, 0
v_mov_b32 v163, 0
v_mov_b32 v164, 0
v_mov_b32 v165, 0
v_mov_b32 v166, 0
v_mov_b32 v167, 0
v_mov_b32 v168, 0
v_mov_b32 v169, 0
v_mov_b32 v170, 0
v_mov_b32 v171, 0
v_mov_b32 v172, 0
v_mov_b32 v173, 0
v_mov_b32 v174, 0
v_mov_b32 v175, 0
v_mov_b32 v176, 0
v_mov_b32 v177, 0
v_mov_b32 v178, 0
v_mov_b32 v179, 0
v_mov_b32 v180, 0
v_mov_b32 v181, 0
v_mov_b32 v182, 0
v_mov_b32 v183, 0
v_mov_b32 v184, 0
v_mov_b32 v185, 0
v_mov_b32 v186, 0
v_mov_b32 v187, 0
v_mov_b32 v188, 0
v_mov_b32 v189, 0
v_mov_b32 v190, 0
v_mov_b32 v191, 0
v_mov_b32 v192, 0
v_mov_b32 v193, 0
v_mov_b32 v194, 0
v_mov_b32 v195, 0
v_mov_b32 v196, 0
v_mov_b32 v197, 0
v_mov_b32 v198, 0
v_mov_b32 v199, 0
v_mov_b32 v200, 0
v_mov_b32 v201, 0
v_mov_b32 v202, 0
v_mov_b32 v203, 0
v_mov_b32 v204, 0
v_mov_b32 v205, 0
v_mov_b32 v206, 0
v_mov_b32 v207, 0
v_mov_b32 v208, 0
v_mov_b32 v209, 0
v_mov_b32 v210, 0
v_mov_b32 v211, 0
v_mov_b32 v212, 0
v_mov_b32 v213, 0
v_mov_b32 v214, 0
v_mov_b32 v215, 0
v_mov_b32 v216, 0
v_mov_b32 v217, 0
v_mov_b32 v218, 0
v_mov_b32 v219, 0
v_mov_b32 v220, 0
v_mov_b32 v221, 0
v_mov_b32 v222, 0
v_mov_b32 v223, 0
v_mov_b32 v224, 0
v_mov_b32 v225, 0
v_mov_b32 v226, 0
v_mov_b32 v227, 0
v_mov_b32 v228, 0
v_mov_b32 v229, 0
v_mov_b32 v230, 0
v_mov_b32 v231, 0
v_mov_b32 v232, 0
v_mov_b32 v233, 0
v_mov_b32 v234, 0
v_mov_b32 v235, 0
v_mov_b32 v236, 0
v_mov_b32 v237, 0
v_mov_b32 v238, 0
v_mov_b32 v239, 0
v_mov_b32 v240, 0
v_mov_b32 v241, 0
v_mov_b32 v242, 0
v_mov_b32 v243, 0
v_mov_b32 v244, 0
v_mov_b32 v245, 0
v_mov_b32 v246, 0
v_mov_b32 v247, 0
v_mov_b32 v248, 0
v_mov_b32 v249, 0
v_mov_b32 v250, 0
v_mov_b32 v251, 0
v_mov_b32 v252, 0
v_mov_b32 v253, 0
v_mov_b32 v254, 0
v_mov_b32 v255, 0
s_mov_b32 s56, 0
Lfb1:
buffer_load_dwordx4 a[192:195], v14, s[20:23], s56 offen offset:0
buffer_load_dwordx4 a[196:199], v14, s[20:23], s56 offen offset:32
buffer_load_dwordx4 a[200:203], v14, s[20:23], s56 offen offset:64
buffer_load_dwordx4 a[204:207], v14, s[20:23], s56 offen offset:96
buffer_load_dwordx4 a[208:211], v14, s[20:23], s56 offen offset:128
buffer_load_dwordx4 a[212:215], v14, s[20:23], s56 offen offset:160
buffer_load_dwordx4 a[216:219], v14, s[20:23], s56 offen offset:192
buffer_load_dwordx4 a[220:223], v14, s[20:23], s56 offen offset:224
s_waitcnt vmcnt(0)
v_mfma_f32_32x32x16_bf16 v[64:79], a[192:195], a[64:67], 0
v_mfma_f32_32x32x16_bf16 v[80:95], a[192:195], a[68:71], 0
v_mfma_f32_32x32x16_bf16 v[64:79], a[196:199], a[72:75], v[64:79]
v_mfma_f32_32x32x16_bf16 v[80:95], a[196:199], a[76:79], v[80:95]
v_mfma_f32_32x32x16_bf16 v[64:79], a[200:203], a[80:83], v[64:79]
v_mfma_f32_32x32x16_bf16 v[80:95], a[200:203], a[84:87], v[80:95]
v_mfma_f32_32x32x16_bf16 v[64:79], a[204:207], a[88:91], v[64:79]
v_mfma_f32_32x32x16_bf16 v[80:95], a[204:207], a[92:95], v[80:95]
v_mfma_f32_32x32x16_bf16 v[64:79], a[208:211], a[96:99], v[64:79]
v_mfma_f32_32x32x16_bf16 v[80:95], a[208:211], a[100:103], v[80:95]
v_mfma_f32_32x32x16_bf16 v[64:79], a[212:215], a[104:107], v[64:79]
v_mfma_f32_32x32x16_bf16 v[80:95], a[212:215], a[108:111], v[80:95]
v_mfma_f32_32x32x16_bf16 v[64:79], a[216:219], a[112:115], v[64:79]
v_mfma_f32_32x32x16_bf16 v[80:95], a[216:219], a[116:119], v[80:95]
v_mfma_f32_32x32x16_bf16 v[64:79], a[220:223], a[120:123], v[64:79]
v_mfma_f32_32x32x16_bf16 v[80:95], a[220:223], a[124:127], v[80:95]
s_nop 10
v_max3_f32 v32, v32, v64, v65
v_max3_f32 v33, v33, v66, v67
v_max3_f32 v32, v32, v68, v69
v_max3_f32 v33, v33, v70, v71
v_max3_f32 v32, v32, v72, v73
v_max3_f32 v33, v33, v74, v75
v_max3_f32 v32, v32, v76, v77
v_max3_f32 v33, v33, v78, v79
v_max3_f32 v48, v48, v80, v81
v_max3_f32 v49, v49, v82, v83
v_max3_f32 v48, v48, v84, v85
v_max3_f32 v49, v49, v86, v87
v_max3_f32 v48, v48, v88, v89
v_max3_f32 v49, v49, v90, v91
v_max3_f32 v48, v48, v92, v93
v_max3_f32 v49, v49, v94, v95
s_add_u32 s56, s56, 8192
s_cmp_lt_u32 s56, 131072
s_cbranch_scc1 Lfb1
v_max_f32 v32, v32, v33
v_mov_b32 v33, v32
v_max_f32 v48, v48, v49
v_mov_b32 v49, v48
v_permlane32_swap_b32 v32, v33
s_nop 0
v_permlane32_swap_b32 v48, v49
v_max_f32 v32, v32, v33
v_sub_f32 v32, 0, v32
v_max_f32 v48, v48, v49
v_sub_f32 v48, 0, v48
v_mov_b32 v33, v32
v_mov_b32 v34, v32
v_mov_b32 v35, v32
v_mov_b32 v36, v32
v_mov_b32 v37, v32
v_mov_b32 v38, v32
v_mov_b32 v39, v32
v_mov_b32 v40, v32
v_mov_b32 v41, v32
v_mov_b32 v42, v32
v_mov_b32 v43, v32
v_mov_b32 v44, v32
v_mov_b32 v45, v32
v_mov_b32 v46, v32
v_mov_b32 v47, v32
v_mov_b32 v49, v48
v_mov_b32 v50, v48
v_mov_b32 v51, v48
v_mov_b32 v52, v48
v_mov_b32 v53, v48
v_mov_b32 v54, v48
v_mov_b32 v55, v48
v_mov_b32 v56, v48
v_mov_b32 v57, v48
v_mov_b32 v58, v48
v_mov_b32 v59, v48
v_mov_b32 v60, v48
v_mov_b32 v61, v48
v_mov_b32 v62, v48
v_mov_b32 v63, v48
s_mov_b32 s56, 0
Lfb2:
buffer_load_dwordx4 a[192:195], v14, s[20:23], s56 offen offset:0
buffer_load_dwordx4 a[196:199], v14, s[20:23], s56 offen offset:32
buffer_load_dwordx4 a[200:203], v14, s[20:23], s56 offen offset:64
buffer_load_dwordx4 a[204:207], v14, s[20:23], s56 offen offset:96
buffer_load_dwordx4 a[208:211], v14, s[20:23], s56 offen offset:128
buffer_load_dwordx4 a[212:215], v14, s[20:23], s56 offen offset:160
buffer_load_dwordx4 a[216:219], v14, s[20:23], s56 offen offset:192
buffer_load_dwordx4 a[220:223], v14, s[20:23], s56 offen offset:224
s_add_u32 s57, s56, 4096
s_add_u32 m0, s52, 0
s_nop 0
buffer_load_dwordx4 v15, s[24:27], s56 offen offset:0 lds
buffer_load_dwordx4 v15, s[24:27], s56 offen offset:1024 lds
buffer_load_dwordx4 v15, s[24:27], s56 offen offset:2048 lds
buffer_load_dwordx4 v15, s[24:27], s56 offen offset:3072 lds
s_add_u32 m0, s52, 4096
s_nop 0
buffer_load_dwordx4 v15, s[24:27], s57 offen offset:0 lds
buffer_load_dwordx4 v15, s[24:27], s57 offen offset:1024 lds
buffer_load_dwordx4 v15, s[24:27], s57 offen offset:2048 lds
buffer_load_dwordx4 v15, s[24:27], s57 offen offset:3072 lds
s_waitcnt vmcnt(8)
v_mfma_f32_32x32x16_bf16 v[64:79], a[192:195], a[64:67], v[32:47]
v_mfma_f32_32x32x16_bf16 v[80:95], a[192:195], a[68:71], v[48:63]
v_mfma_f32_32x32x16_bf16 v[64:79], a[196:199], a[72:75], v[64:79]
v_mfma_f32_32x32x16_bf16 v[80:95], a[196:199], a[76:79], v[80:95]
v_mfma_f32_32x32x16_bf16 v[64:79], a[200:203], a[80:83], v[64:79]
v_mfma_f32_32x32x16_bf16 v[80:95], a[200:203], a[84:87], v[80:95]
v_mfma_f32_32x32x16_bf16 v[64:79], a[204:207], a[88:91], v[64:79]
v_mfma_f32_32x32x16_bf16 v[80:95], a[204:207], a[92:95], v[80:95]
v_mfma_f32_32x32x16_bf16 v[64:79], a[208:211], a[96:99], v[64:79]
v_mfma_f32_32x32x16_bf16 v[80:95], a[208:211], a[100:103], v[80:95]
v_mfma_f32_32x32x16_bf16 v[64:79], a[212:215], a[104:107], v[64:79]
v_mfma_f32_32x32x16_bf16 v[80:95], a[212:215], a[108:111], v[80:95]
v_mfma_f32_32x32x16_bf16 v[64:79], a[216:219], a[112:115], v[64:79]
v_mfma_f32_32x32x16_bf16 v[80:95], a[216:219], a[116:119], v[80:95]
v_mfma_f32_32x32x16_bf16 v[64:79], a[220:223], a[120:123], v[64:79]
v_mfma_f32_32x32x16_bf16 v[80:95], a[220:223], a[124:127], v[80:95]
s_waitcnt vmcnt(0)
ds_read_b64_tr_b16 a[224:225], v17 offset:0
ds_read_b64_tr_b16 a[226:227], v17 offset:2048
ds_read_b64_tr_b16 a[228:229], v18 offset:0
ds_read_b64_tr_b16 a[230:231], v18 offset:2048
ds_read_b64_tr_b16 a[232:233], v19 offset:0
ds_read_b64_tr_b16 a[234:235], v19 offset:2048
ds_read_b64_tr_b16 a[236:237], v20 offset:0
ds_read_b64_tr_b16 a[238:239], v20 offset:2048
ds_read_b64_tr_b16 a[240:241], v17 offset:4096
ds_read_b64_tr_b16 a[242:243], v17 offset:6144
ds_read_b64_tr_b16 a[244:245], v18 offset:4096
ds_read_b64_tr_b16 a[246:247], v18 offset:6144
ds_read_b64_tr_b16 a[248:249], v19 offset:4096
ds_read_b64_tr_b16 a[250:251], v19 offset:6144
ds_read_b64_tr_b16 a[252:253], v20 offset:4096
s_waitcnt lgkmcnt(14)
ds_read_b64_tr_b16 a[254:255], v20 offset:6144
v_exp_f32 v64, v64
v_exp_f32 v65, v65
v_add_f32 v26, v26, v64
v_exp_f32 v66, v66
v_add_f32 v26, v26, v65
v_cvt_pk_bf16_f32 v64, v64, v65
v_exp_f32 v67, v67
v_add_f32 v26, v26, v66
v_exp_f32 v68, v68
v_add_f32 v26, v26, v67
v_cvt_pk_bf16_f32 v65, v66, v67
v_exp_f32 v69, v69
v_add_f32 v26, v26, v68
v_exp_f32 v70, v70
v_add_f32 v26, v26, v69
v_cvt_pk_bf16_f32 v66, v68, v69
v_exp_f32 v71, v71
v_add_f32 v26, v26, v70
v_add_f32 v26, v26, v71
v_cvt_pk_bf16_f32 v67, v70, v71
v_exp_f32 v72, v72
v_exp_f32 v73, v73
v_add_f32 v26, v26, v72
v_exp_f32 v74, v74
v_add_f32 v26, v26, v73
v_cvt_pk_bf16_f32 v72, v72, v73
v_exp_f32 v75, v75
v_add_f32 v26, v26, v74
v_exp_f32 v76, v76
v_add_f32 v26, v26, v75
v_cvt_pk_bf16_f32 v73, v74, v75
v_exp_f32 v77, v77
v_add_f32 v26, v26, v76
v_exp_f32 v78, v78
v_add_f32 v26, v26, v77
v_cvt_pk_bf16_f32 v74, v76, v77
v_exp_f32 v79, v79
v_add_f32 v26, v26, v78
v_add_f32 v26, v26, v79
v_cvt_pk_bf16_f32 v75, v78, v79
v_exp_f32 v80, v80
v_exp_f32 v81, v81
v_add_f32 v28, v28, v80
v_exp_f32 v82, v82
v_add_f32 v28, v28, v81
v_cvt_pk_bf16_f32 v80, v80, v81
v_exp_f32 v83, v83
v_add_f32 v28, v28, v82
v_exp_f32 v84, v84
v_add_f32 v28, v28, v83
v_cvt_pk_bf16_f32 v81, v82, v83
v_exp_f32 v85, v85
v_add_f32 v28, v28, v84
v_exp_f32 v86, v86
v_add_f32 v28, v28, v85
v_cvt_pk_bf16_f32 v82, v84, v85
v_exp_f32 v87, v87
v_add_f32 v28, v28, v86
v_add_f32 v28, v28, v87
v_cvt_pk_bf16_f32 v83, v86, v87
v_exp_f32 v88, v88
v_exp_f32 v89, v89
v_add_f32 v28, v28, v88
v_exp_f32 v90, v90
v_add_f32 v28, v28, v89
v_cvt_pk_bf16_f32 v88, v88, v89
v_exp_f32 v91, v91
v_add_f32 v28, v28, v90
v_exp_f32 v92, v92
v_add_f32 v28, v28, v91
v_cvt_pk_bf16_f32 v89, v90, v91
v_exp_f32 v93, v93
v_add_f32 v28, v28, v92
v_exp_f32 v94, v94
v_add_f32 v28, v28, v93
v_cvt_pk_bf16_f32 v90, v92, v93
v_exp_f32 v95, v95
v_add_f32 v28, v28, v94
v_add_f32 v28, v28, v95
v_cvt_pk_bf16_f32 v91, v94, v95
s_waitcnt lgkmcnt(0)
s_add_u32 s56, s56, 8192
s_cmp_ge_u32 s56, 131072
s_cbranch_scc1 Lfb3
v_mfma_f32_32x32x16_bf16 v[128:143], a[224:227], v[64:67], v[128:143]
v_mfma_f32_32x32x16_bf16 v[192:207], a[224:227], v[80:83], v[192:207]
v_mfma_f32_32x32x16_bf16 v[144:159], a[228:231], v[64:67], v[144:159]
v_mfma_f32_32x32x16_bf16 v[208:223], a[228:231], v[80:83], v[208:223]
v_mfma_f32_32x32x16_bf16 v[160:175], a[232:235], v[64:67], v[160:175]
v_mfma_f32_32x32x16_bf16 v[224:239], a[232:235], v[80:83], v[224:239]
v_mfma_f32_32x32x16_bf16 v[176:191], a[236:239], v[64:67], v[176:191]
v_mfma_f32_32x32x16_bf16 v[240:255], a[236:239], v[80:83], v[240:255]
v_mfma_f32_32x32x16_bf16 v[128:143], a[240:243], v[72:75], v[128:143]
v_mfma_f32_32x32x16_bf16 v[192:207], a[240:243], v[88:91], v[192:207]
v_mfma_f32_32x32x16_bf16 v[144:159], a[244:247], v[72:75], v[144:159]
v_mfma_f32_32x32x16_bf16 v[208:223], a[244:247], v[88:91], v[208:223]
v_mfma_f32_32x32x16_bf16 v[160:175], a[248:251], v[72:75], v[160:175]
v_mfma_f32_32x32x16_bf16 v[224:239], a[248:251], v[88:91], v[224:239]
v_mfma_f32_32x32x16_bf16 v[176:191], a[252:255], v[72:75], v[176:191]
v_mfma_f32_32x32x16_bf16 v[240:255], a[252:255], v[88:91], v[240:255]
s_branch Lfb2
Lfb3:
v_mov_b32 v29, v26
v_mov_b32 v30, v28
s_nop 0
v_permlane32_swap_b32 v26, v29
v_permlane32_swap_b32 v28, v30
v_add_f32 v26, v26, v29
v_add_f32 v28, v28, v30
s_nop 7
s_branch Lfb_r
Ltouch:
v_and_b32 v40, 63, v0
v_lshrrev_b32 v41, 2, v40
v_and_b32 v42, 3, v0
v_lshlrev_b32 v41, 13, v41
v_lshl_add_u32 v41, v42, 7, v41
s_sub_u32 s92, s8, 256
s_subb_u32 s93, s9, 0
s_add_u32 s94, s10, 256
s_mov_b32 s95, 0x20000
s_lshl_b32 s41, s61, 2
s_add_u32 s41, s41, s36
s_mul_i32 s40, s41, 163840
v_min_u32 v43, 0x6180, v41
buffer_load_dword v64, v41, s[92:95], s40 offen
s_add_u32 s40, s40, 131072
buffer_load_dword v65, v43, s[92:95], s40 offen
s_branch Lln_skip
Lp_ln:
s_mov_b32 s55, 0
Lq_ln:
s_sleep 16
buffer_load_dwordx2 v[38:39], v35, s[4:7], s59 offen sc1
s_add_u32 s55, s55, 1
s_waitcnt vmcnt(0)
v_cmp_ne_u64 vcc, s[68:69], v[38:39]
s_cmp_gt_u32 s55, 400000
s_cbranch_scc1 Lr_ln
s_nop 1
s_cbranch_vccnz Lq_ln
s_branch Lr_ln
Lp_gF:
s_mov_b32 s55, 0
Lq_gF:
s_sleep 16
buffer_load_dwordx2 v[24:25], v30, s[4:7], s59 offen sc1
s_add_u32 s55, s55, 1
s_waitcnt vmcnt(0)
v_cmp_ne_u64 vcc, s[68:69], v[24:25]
s_cmp_gt_u32 s55, 400000
s_cbranch_scc1 Lr_gF
s_nop 1
s_cbranch_vccnz Lq_gF
s_branch Lr_gF
Lp_oF:
s_mov_b32 s55, 0
Lq_oF:
s_sleep 16
buffer_load_dwordx2 v[24:25], v22, s[4:7], s85 offen sc1
s_add_u32 s55, s55, 1
s_waitcnt vmcnt(0)
v_cmp_ne_u64 vcc, s[68:69], v[24:25]
s_cmp_gt_u32 s55, 400000
s_cbranch_scc1 Lr_oF
s_nop 1
s_cbranch_vccnz Lq_oF
s_branch Lr_oF
Lp_gN:
s_mov_b32 s55, 0
Lq_gN:
s_sleep 16
buffer_load_dwordx2 v[24:25], v30, s[4:7], s59 offen sc1
s_add_u32 s55, s55, 1
s_waitcnt vmcnt(0)
v_cmp_ne_u64 vcc, s[68:69], v[24:25]
s_cmp_gt_u32 s55, 400000
s_cbranch_scc1 Lr_gN
s_nop 1
s_cbranch_vccnz Lq_gN
s_branch Lr_gN
Lp_oN:
s_mov_b32 s55, 0
Lq_oN:
s_sleep 16
buffer_load_dwordx2 v[24:25], v22, s[4:7], s85 offen sc1
s_add_u32 s55, s55, 1
s_waitcnt vmcnt(0)
v_cmp_ne_u64 vcc, s[68:69], v[24:25]
s_cmp_gt_u32 s55, 400000
s_cbranch_scc1 Lr_oN
s_nop 1
s_cbranch_vccnz Lq_oN
s_branch Lr_oN
Lp_h:
s_mov_b32 s55, 0
Lq_h:
s_sleep 16
buffer_load_dwordx2 v[24:25], v23, s[4:7], s86 offen sc1
s_add_u32 s55, s55, 1
s_waitcnt vmcnt(0)
v_cmp_ne_u64 vcc, s[68:69], v[24:25]
s_cmp_gt_u32 s55, 400000
s_cbranch_scc1 Lr_h
s_nop 1
s_cbranch_vccnz Lq_h
s_branch Lr_h
Lp_p:
s_mov_b32 s55, 0
Lq_p:
s_sleep 16
buffer_load_dwordx2 v[24:25], v3, s[4:7], s87 offen sc1
s_add_u32 s55, s55, 1
s_waitcnt vmcnt(0)
v_cmp_ne_u64 vcc, s[68:69], v[24:25]
s_cmp_gt_u32 s55, 400000
s_cbranch_scc1 Lr_p
s_nop 1
s_cbranch_vccnz Lq_p
s_branch Lr_p
.fill 256, 4, 0xbf810000
Lcode1:
s_endpgm
.section .rodata,"a"
.p2align 6
.amdhsa_kernel recurrent_scan__sliding_block_cached__glu_gated_swiglu__prompt_kernel
  .amdhsa_next_free_vgpr 512
  .amdhsa_next_free_sgpr 102
  .amdhsa_accum_offset 256
  .amdhsa_group_segment_fixed_size 0
  .amdhsa_kernarg_size 96
  .amdhsa_user_sgpr_count 2
  .amdhsa_user_sgpr_kernarg_segment_ptr 1
  .amdhsa_system_sgpr_workgroup_id_x 1
.end_amdhsa_kernel
```
